```python
import torch

def _softmax(x, axis=-1):
    return torch.softmax(x, dim=axis)
def _gelu(x):
    return torch.nn.functional.gelu(x, approximate="tanh")
def _silu(x):
    return torch.nn.functional.silu(x)
def _sigmoid(x):
    return torch.sigmoid(x)
def _layernorm(x, axis=-1, eps=1e-5):
    m = x.mean(dim=axis, keepdim=True)
    v = x.var(dim=axis, keepdim=True, unbiased=False)
    return (x - m) / torch.sqrt(v + eps)
def _scatter_add(tgt, idx, src, axis=0):
    return tgt.clone().index_add_(axis, idx, src)
def _segment_sum(src, seg, n):
    out = torch.zeros((n,) + src.shape[1:], dtype=src.dtype)
    return out.index_add_(0, seg, src)
def _pad(x, pw):
    flat = tuple(v for pair in reversed(pw) for v in pair)
    return torch.nn.functional.pad(x, flat)

kernel_name = 'standalone__gqa_block_cached__near_ridge'

def setup_inputs():

    _w = (lambda a: (lambda t: t.to(torch.bfloat16) if t.is_floating_point() else t)(torch.as_tensor(a)))
    B, Sq, D = 16, 128, 640
    Hq, Hkv, Sk, Dh = 32, 32, 1024, 192
    assert Hq % Hkv == 0, (Hq, Hkv)
    return {
        "x": _w((lambda *s: torch.randn(*s, dtype=torch.bfloat16) * 0.8)(B, Sq, D)),
        "k_cache": _w((lambda *s: torch.randn(*s, dtype=torch.bfloat16) * 0.8)(B, Hkv, Sk, Dh)),
        "v_cache": _w((lambda *s: torch.randn(*s, dtype=torch.bfloat16) * 0.05)(B, Hkv, Sk, Dh)),
        "wq": _w((lambda *s: torch.randn(*s, dtype=torch.bfloat16) * 0.8)(D, Hq * Dh) * (D ** -0.5)),
        "wo": _w((lambda *s: torch.randn(*s, dtype=torch.bfloat16) * 0.05)(Hq * Dh, D) * ((Hq * Dh) ** -0.5)),
    }

def reference(x, k_cache, v_cache, wq, wo):
    B, Sq, D = x.shape
    Hq, Dh = 32, 192
    Hkv = k_cache.shape[1]
    rep = Hq // Hkv
    q = (lambda x, *d: x.permute(*d))((x @ wq).reshape(B, Sq, Hq, Dh), 0, 2, 1, 3)
    k = (lambda x, n, axis: torch.repeat_interleave(x, n, dim=axis))(k_cache, rep, axis=1)
    v = (lambda x, n, axis: torch.repeat_interleave(x, n, dim=axis))(v_cache, rep, axis=1)
    scores = torch.einsum("bhqd,bhkd->bhqk", q, k) * (Dh ** -0.5)
    p = _softmax(scores, axis=-1)
    o = torch.einsum("bhqk,bhkd->bhqd", p, v)
    return (lambda x, *d: x.permute(*d))(o, 0, 2, 1, 3).reshape(B, Sq, Hq * Dh) @ wo
```

```asm
; @launch grid=(256,1,1) block=(512,1,1) lds=163840
.amdgcn_target "amdgcn-amd-amdhsa--gfx950"
.text
.globl standalone__gqa_block_cached__near_ridge_kernel
.p2align 8
.type standalone__gqa_block_cached__near_ridge_kernel,@function
standalone__gqa_block_cached__near_ridge_kernel:
    s_cmp_ge_u32 s2, 256
    s_cbranch_scc1 L_END
    s_load_dwordx4 s[28:31], s[0:1], 0
    s_load_dwordx4 s[32:35], s[0:1], 16
    s_load_dwordx2 s[36:37], s[0:1], 32
    s_load_dwordx2 s[38:39], s[0:1], 56
    s_load_dwordx2 s[100:101], s[0:1], 48
    v_lshrrev_b32 v1, 6, v0
    v_and_b32 v0, 63, v0
    v_readfirstlane_b32 s40, v1
    v_mov_b32 v2, 0
    v_mov_b32 v3, 0
    v_mov_b32 v4, 0
    v_mov_b32 v10, 0
    v_mov_b32 v11, 0
    v_mov_b32 v12, 0
    v_mov_b32 v13, 0
    s_and_b32 s41, s40, 3
    s_lshr_b32 s52, s40, 2
    s_lshl_b32 s42, s41, 11
    s_cmp_eq_u32 s41, 3
    s_cselect_b32 s42, 0, s42
    s_lshr_b32 s48, s2, 3
    s_and_b32 s48, s48, 7
    s_mul_i32 s56, s48, 5
    s_lshr_b32 s56, s56, 2
    s_and_b32 s54, s2, 1
    s_lshl_b32 s54, s54, 3
    s_add_u32 s54, s54, s48
    s_lshr_b32 s48, s2, 6
    s_and_b32 s57, s2, 6
    s_lshl_b32 s57, s57, 1
    s_add_u32 s57, s57, s48
    s_mul_i32 s48, s48, 5
    s_lshr_b32 s48, s48, 1
    s_add_u32 s56, s56, s48
    s_sub_u32 s48, s56, 10
    s_cmp_ge_u32 s56, 10
    s_cselect_b32 s56, s48, s56
    s_bfe_u32 s59, s2, 0x30003
    s_lshr_b32 s48, s2, 6
    s_add_u32 s59, s59, s48
    s_mul_i32 s48, s59, 86
    s_lshr_b32 s48, s48, 8
    s_mul_i32 s48, s48, 3
    s_sub_u32 s59, s59, s48
    s_mul_i32 s59, s59, 854
    s_lshr_b32 s59, s59, 8
    s_lshl_b32 s55, s54, 4
    s_add_u32 s55, s55, s57
    s_mul_i32 s43, s55, 786432
    s_mul_i32 s44, s57, 768
    s_mul_i32 s45, s57, 491520
    s_mul_i32 s46, s54, 163840
    s_mul_i32 s47, s55, 163840
    s_lshl_b32 s48, s41, 12
    s_add_u32 s47, s47, s48
    s_mov_b32 s49, 0x40004000
    s_mov_b32 s53, 0xffff0000
    s_mov_b32 s3, 0
    s_cmp_eq_u32 s52, 1
    s_cbranch_scc0 L_A
L_B:
    s_setprio 1
    s_cmp_eq_u32 s41, 3
    s_cbranch_scc1 L_1
    s_lshr_b32 s48, s42, 7
    s_add_u32 s48, s48, 0
    v_lshrrev_b32 v24, 3, v0
    v_add_u32 v24, s48, v24
    v_mul_u32_u24 v25, 43, v24
    v_lshrrev_b32 v25, 7, v25
    v_mul_u32_u24 v26, 3, v25
    v_sub_u32 v26, v24, v26
    v_lshlrev_b32 v26, 7, v26
    v_mul_u32_u24 v27, 12288, v25
    v_add_u32 v26, v26, v27
    v_and_b32 v25, 6, v25
    v_xor_b32 v25, v25, v0
    v_and_b32 v25, 7, v25
    v_lshlrev_b32 v25, 4, v25
    v_add_u32 v26, v26, v25
    v_subrev_u32 v2, 0, v26
    s_lshr_b32 s48, s42, 7
    s_add_u32 s48, s48, 8
    v_lshrrev_b32 v24, 3, v0
    v_add_u32 v24, s48, v24
    v_mul_u32_u24 v25, 43, v24
    v_lshrrev_b32 v25, 7, v25
    v_mul_u32_u24 v26, 3, v25
    v_sub_u32 v26, v24, v26
    v_lshlrev_b32 v26, 7, v26
    v_mul_u32_u24 v27, 12288, v25
    v_add_u32 v26, v26, v27
    v_and_b32 v25, 6, v25
    v_xor_b32 v25, v25, v0
    v_and_b32 v25, 7, v25
    v_lshlrev_b32 v25, 4, v25
    v_add_u32 v26, v26, v25
    v_subrev_u32 v3, 1024, v26
    s_waitcnt lgkmcnt(0)
    s_mov_b32 s12, s34
    s_and_b32 s13, s35, 0xffff
    s_mov_b32 s14, 7864320
    s_mov_b32 s15, 0x20000
    s_mov_b32 s20, s28
    s_and_b32 s21, s29, 0xffff
    s_mov_b32 s22, 2621440
    s_mov_b32 s23, 0x20000
    s_mov_b32 s4, s30
    s_and_b32 s5, s31, 0xffff
    s_mov_b32 s6, 201326592
    s_mov_b32 s7, 0x20000
    s_mov_b32 s8, s32
    s_and_b32 s9, s33, 0xffff
    s_mov_b32 s10, 201326592
    s_mov_b32 s11, 0x20000
    s_mov_b32 s16, s36
    s_and_b32 s17, s37, 0xffff
    s_mov_b32 s18, 7864320
    s_mov_b32 s19, 0x20000
    s_mov_b32 s24, s38
    s_and_b32 s25, s39, 0xffff
    s_mov_b32 s26, 805306368
    s_mov_b32 s27, 0x20000
    s_add_u32 s57, s59, 0
    s_sub_u32 s48, s57, 10
    s_cmp_ge_u32 s57, 10
    s_cselect_b32 s57, s48, s57
    s_mul_i32 s57, s57, 786432
    s_add_u32 s57, s57, s44
    s_add_u32 m0, s42, 49152
    s_add_u32 s48, s57, 0
    buffer_load_dwordx4 v2, s[12:15], s48 offen lds
    buffer_load_dwordx4 v3, s[12:15], s48 offen offset:1024 lds
    s_add_u32 m0, s42, 55296
    s_add_u32 s48, s57, 196608
    buffer_load_dwordx4 v2, s[12:15], s48 offen lds
    buffer_load_dwordx4 v3, s[12:15], s48 offen offset:1024 lds
    s_add_u32 m0, s42, 61440
    s_add_u32 s48, s57, 393216
    buffer_load_dwordx4 v2, s[12:15], s48 offen lds
    buffer_load_dwordx4 v3, s[12:15], s48 offen offset:1024 lds
    s_add_u32 m0, s42, 67584
    s_add_u32 s48, s57, 589824
    buffer_load_dwordx4 v2, s[12:15], s48 offen lds
    buffer_load_dwordx4 v3, s[12:15], s48 offen offset:1024 lds
    s_add_u32 s57, s59, 1
    s_sub_u32 s48, s57, 10
    s_cmp_ge_u32 s57, 10
    s_cselect_b32 s57, s48, s57
    s_mul_i32 s57, s57, 786432
    s_add_u32 s57, s57, s44
    s_add_u32 m0, s42, 73728
    s_add_u32 s48, s57, 0
    buffer_load_dwordx4 v2, s[12:15], s48 offen lds
    buffer_load_dwordx4 v3, s[12:15], s48 offen offset:1024 lds
    s_add_u32 m0, s42, 79872
    s_add_u32 s48, s57, 196608
    buffer_load_dwordx4 v2, s[12:15], s48 offen lds
    buffer_load_dwordx4 v3, s[12:15], s48 offen offset:1024 lds
    s_add_u32 m0, s42, 86016
    s_add_u32 s48, s57, 393216
    buffer_load_dwordx4 v2, s[12:15], s48 offen lds
    buffer_load_dwordx4 v3, s[12:15], s48 offen offset:1024 lds
    s_add_u32 m0, s42, 92160
    s_add_u32 s48, s57, 589824
    buffer_load_dwordx4 v2, s[12:15], s48 offen lds
    buffer_load_dwordx4 v3, s[12:15], s48 offen offset:1024 lds
    s_branch L_2
L_1:
    v_lshrrev_b32 v24, 3, v0
    v_add_u32 v24, 0, v24
    v_lshrrev_b32 v25, 1, v24
    v_xor_b32 v25, v25, v0
    v_and_b32 v25, 7, v25
    v_mul_u32_u24 v24, 1280, v24
    v_lshl_add_u32 v24, v25, 4, v24
    v_subrev_u32 v10, 0, v24
    v_lshrrev_b32 v24, 3, v0
    v_add_u32 v24, 8, v24
    v_lshrrev_b32 v25, 1, v24
    v_xor_b32 v25, v25, v0
    v_and_b32 v25, 7, v25
    v_mul_u32_u24 v24, 1280, v24
    v_lshl_add_u32 v24, v25, 4, v24
    v_subrev_u32 v11, 1024, v24
    s_waitcnt lgkmcnt(0)
    s_mov_b32 s12, s34
    s_and_b32 s13, s35, 0xffff
    s_mov_b32 s14, 7864320
    s_mov_b32 s15, 0x20000
    s_mov_b32 s20, s28
    s_and_b32 s21, s29, 0xffff
    s_mov_b32 s22, 2621440
    s_mov_b32 s23, 0x20000
    s_mov_b32 s4, s30
    s_and_b32 s5, s31, 0xffff
    s_mov_b32 s6, 201326592
    s_mov_b32 s7, 0x20000
    s_mov_b32 s8, s32
    s_and_b32 s9, s33, 0xffff
    s_mov_b32 s10, 201326592
    s_mov_b32 s11, 0x20000
    s_mov_b32 s16, s36
    s_and_b32 s17, s37, 0xffff
    s_mov_b32 s18, 7864320
    s_mov_b32 s19, 0x20000
    s_mov_b32 s24, s38
    s_and_b32 s25, s39, 0xffff
    s_mov_b32 s26, 805306368
    s_mov_b32 s27, 0x20000
    s_add_u32 s57, s59, 0
    s_sub_u32 s48, s57, 10
    s_cmp_ge_u32 s57, 10
    s_cselect_b32 s57, s48, s57
    s_mul_i32 s57, s57, 128
    s_add_u32 s57, s57, s46
    s_mov_b32 m0, 131072
    s_add_u32 s48, s57, 0
    buffer_load_dwordx4 v10, s[20:23], s48 offen offset:0 lds
    buffer_load_dwordx4 v11, s[20:23], s48 offen offset:1024 lds
    s_mov_b32 m0, 133120
    s_add_u32 s48, s57, 20480
    buffer_load_dwordx4 v10, s[20:23], s48 offen offset:0 lds
    buffer_load_dwordx4 v11, s[20:23], s48 offen offset:1024 lds
    s_mov_b32 m0, 135168
    s_add_u32 s48, s57, 40960
    buffer_load_dwordx4 v10, s[20:23], s48 offen offset:0 lds
    buffer_load_dwordx4 v11, s[20:23], s48 offen offset:1024 lds
    s_mov_b32 m0, 137216
    s_add_u32 s48, s57, 61440
    buffer_load_dwordx4 v10, s[20:23], s48 offen offset:0 lds
    buffer_load_dwordx4 v11, s[20:23], s48 offen offset:1024 lds
    s_mov_b32 m0, 139264
    s_add_u32 s48, s57, 81920
    buffer_load_dwordx4 v10, s[20:23], s48 offen offset:0 lds
    buffer_load_dwordx4 v11, s[20:23], s48 offen offset:1024 lds
    s_mov_b32 m0, 141312
    s_add_u32 s48, s57, 102400
    buffer_load_dwordx4 v10, s[20:23], s48 offen offset:0 lds
    buffer_load_dwordx4 v11, s[20:23], s48 offen offset:1024 lds
    s_mov_b32 m0, 143360
    s_add_u32 s48, s57, 122880
    buffer_load_dwordx4 v10, s[20:23], s48 offen offset:0 lds
    buffer_load_dwordx4 v11, s[20:23], s48 offen offset:1024 lds
    s_mov_b32 m0, 145408
    s_add_u32 s48, s57, 143360
    buffer_load_dwordx4 v10, s[20:23], s48 offen offset:0 lds
    buffer_load_dwordx4 v11, s[20:23], s48 offen offset:1024 lds
    s_add_u32 s57, s59, 1
    s_sub_u32 s48, s57, 10
    s_cmp_ge_u32 s57, 10
    s_cselect_b32 s57, s48, s57
    s_mul_i32 s57, s57, 128
    s_add_u32 s57, s57, s46
    s_mov_b32 m0, 114688
    s_add_u32 s48, s57, 0
    buffer_load_dwordx4 v10, s[20:23], s48 offen offset:0 lds
    buffer_load_dwordx4 v11, s[20:23], s48 offen offset:1024 lds
    s_mov_b32 m0, 116736
    s_add_u32 s48, s57, 20480
    buffer_load_dwordx4 v10, s[20:23], s48 offen offset:0 lds
    buffer_load_dwordx4 v11, s[20:23], s48 offen offset:1024 lds
    s_mov_b32 m0, 118784
    s_add_u32 s48, s57, 40960
    buffer_load_dwordx4 v10, s[20:23], s48 offen offset:0 lds
    buffer_load_dwordx4 v11, s[20:23], s48 offen offset:1024 lds
    s_mov_b32 m0, 120832
    s_add_u32 s48, s57, 61440
    buffer_load_dwordx4 v10, s[20:23], s48 offen offset:0 lds
    buffer_load_dwordx4 v11, s[20:23], s48 offen offset:1024 lds
    s_mov_b32 m0, 122880
    s_add_u32 s48, s57, 81920
    buffer_load_dwordx4 v10, s[20:23], s48 offen offset:0 lds
    buffer_load_dwordx4 v11, s[20:23], s48 offen offset:1024 lds
    s_mov_b32 m0, 124928
    s_add_u32 s48, s57, 102400
    buffer_load_dwordx4 v10, s[20:23], s48 offen offset:0 lds
    buffer_load_dwordx4 v11, s[20:23], s48 offen offset:1024 lds
    s_mov_b32 m0, 126976
    s_add_u32 s48, s57, 122880
    buffer_load_dwordx4 v10, s[20:23], s48 offen offset:0 lds
    buffer_load_dwordx4 v11, s[20:23], s48 offen offset:1024 lds
    s_mov_b32 m0, 129024
    s_add_u32 s48, s57, 143360
    buffer_load_dwordx4 v10, s[20:23], s48 offen offset:0 lds
    buffer_load_dwordx4 v11, s[20:23], s48 offen offset:1024 lds
L_2:
    s_cmp_eq_u32 s41, 3
    s_cbranch_scc1 L_3
    s_lshr_b32 s48, s42, 7
    s_add_u32 s48, s48, 0
    v_lshrrev_b32 v24, 3, v0
    v_add_u32 v24, s48, v24
    v_mul_u32_u24 v25, 43, v24
    v_lshrrev_b32 v25, 7, v25
    v_lshrrev_b32 v25, 1, v25
    v_xor_b32 v26, v25, v0
    v_lshlrev_b32 v26, 4, v26
    v_add_u32 v10, s42, v26
    v_and_b32 v25, 3, v25
    v_lshlrev_b32 v25, 1, v25
    v_xor_b32 v26, v25, v0
    v_lshlrev_b32 v26, 4, v26
    v_add_u32 v12, s42, v26
    s_lshr_b32 s48, s42, 7
    s_add_u32 s48, s48, 8
    v_lshrrev_b32 v24, 3, v0
    v_add_u32 v24, s48, v24
    v_mul_u32_u24 v25, 43, v24
    v_lshrrev_b32 v25, 7, v25
    v_lshrrev_b32 v25, 1, v25
    v_xor_b32 v26, v25, v0
    v_lshlrev_b32 v26, 4, v26
    v_add_u32 v11, s42, v26
    v_and_b32 v25, 3, v25
    v_lshlrev_b32 v25, 1, v25
    v_xor_b32 v26, v25, v0
    v_lshlrev_b32 v26, 4, v26
    v_add_u32 v13, s42, v26
    s_branch L_4
L_3:
    s_lshr_b32 s48, s42, 7
    s_add_u32 s48, s48, 0
    v_lshrrev_b32 v24, 3, v0
    v_add_u32 v24, s48, v24
    v_mul_u32_u24 v25, 43, v24
    v_lshrrev_b32 v25, 7, v25
    v_mul_u32_u24 v26, 3, v25
    v_sub_u32 v26, v24, v26
    v_lshlrev_b32 v26, 7, v26
    v_mul_u32_u24 v27, 12288, v25
    v_add_u32 v26, v26, v27
    v_and_b32 v25, 6, v25
    v_xor_b32 v25, v25, v0
    v_and_b32 v25, 7, v25
    v_lshlrev_b32 v25, 4, v25
    v_add_u32 v26, v26, v25
    v_subrev_u32 v12, 0, v26
    s_lshr_b32 s48, s42, 7
    s_add_u32 s48, s48, 8
    v_lshrrev_b32 v24, 3, v0
    v_add_u32 v24, s48, v24
    v_mul_u32_u24 v25, 43, v24
    v_lshrrev_b32 v25, 7, v25
    v_mul_u32_u24 v26, 3, v25
    v_sub_u32 v26, v24, v26
    v_lshlrev_b32 v26, 7, v26
    v_mul_u32_u24 v27, 12288, v25
    v_add_u32 v26, v26, v27
    v_and_b32 v25, 6, v25
    v_xor_b32 v25, v25, v0
    v_and_b32 v25, 7, v25
    v_lshlrev_b32 v25, 4, v25
    v_add_u32 v26, v26, v25
    v_subrev_u32 v13, 1024, v26
    s_lshr_b32 s48, s42, 7
    s_add_u32 s48, s48, 16
    v_lshrrev_b32 v24, 3, v0
    v_add_u32 v24, s48, v24
    v_mul_u32_u24 v25, 43, v24
    v_lshrrev_b32 v25, 7, v25
    v_mul_u32_u24 v26, 3, v25
    v_sub_u32 v26, v24, v26
    v_lshlrev_b32 v26, 7, v26
    v_mul_u32_u24 v27, 12288, v25
    v_add_u32 v26, v26, v27
    v_and_b32 v25, 6, v25
    v_xor_b32 v25, v25, v0
    v_and_b32 v25, 7, v25
    v_lshlrev_b32 v25, 4, v25
    v_add_u32 v26, v26, v25
    v_subrev_u32 v4, 2048, v26
L_4:
    v_lshlrev_b32 v15, 4, v0
    v_and_b32 v24, 15, v0
    v_lshrrev_b32 v25, 4, v0
    v_bfe_u32 v26, v0, 1, 3
    v_xor_b32 v27, v26, v25
    v_mul_u32_u24 v1, 384, v24
    v_lshl_add_u32 v1, v27, 4, v1
    v_lshrrev_b32 v27, 1, v25
    v_xor_b32 v27, v27, v26
    v_lshlrev_b32 v27, 4, v27
    v_lshl_add_u32 v14, v24, 7, v27
    v_and_b32 v25, 1, v25
    v_lshl_add_u32 v14, v25, 3, v14
    s_lshl_b32 s48, s41, 12
    v_add_u32 v14, s48, v14
    v_lshrrev_b32 v24, 2, v0
    v_mul_u32_u24 v9, 384, v24
    v_bfe_u32 v24, v0, 3, 2
    v_lshl_add_u32 v9, v24, 5, v9
    v_and_b32 v24, 3, v0
    v_lshl_add_u32 v9, v24, 3, v9
    s_add_u32 s28, s42, 73728
    s_add_u32 s29, s42, 122880
    s_add_u32 s30, s43, 49152
    s_mov_b32 s36, 1
    s_lshl_b32 s31, 0x09249249, s36
    s_lshl_b32 s32, s31, 2
    s_lshl_b32 s37, 0x02492492, s36
    s_mov_b32 s33, 0
    s_mov_b32 s34, 0
    s_mov_b32 s35, 0
    v_mov_b64 v[128:129], 0
    v_mov_b64 v[130:131], 0
    v_mov_b64 v[132:133], 0
    v_mov_b64 v[134:135], 0
    v_mov_b64 v[136:137], 0
    v_mov_b64 v[138:139], 0
    v_mov_b64 v[140:141], 0
    v_mov_b64 v[142:143], 0
    v_mov_b64 v[144:145], 0
    v_mov_b64 v[146:147], 0
    v_mov_b64 v[148:149], 0
    v_mov_b64 v[150:151], 0
    v_mov_b64 v[152:153], 0
    v_mov_b64 v[154:155], 0
    v_mov_b64 v[156:157], 0
    v_mov_b64 v[158:159], 0
    v_mov_b64 v[160:161], 0
    v_mov_b64 v[162:163], 0
    v_mov_b64 v[164:165], 0
    v_mov_b64 v[166:167], 0
    v_mov_b64 v[168:169], 0
    v_mov_b64 v[170:171], 0
    v_mov_b64 v[172:173], 0
    v_mov_b64 v[174:175], 0
    v_mov_b64 v[176:177], 0
    v_mov_b64 v[178:179], 0
    v_mov_b64 v[180:181], 0
    v_mov_b64 v[182:183], 0
    v_mov_b64 v[184:185], 0
    v_mov_b64 v[186:187], 0
    v_mov_b64 v[188:189], 0
    v_mov_b64 v[190:191], 0
    v_mov_b64 v[192:193], 0
    v_mov_b64 v[194:195], 0
    v_mov_b64 v[196:197], 0
    v_mov_b64 v[198:199], 0
    v_mov_b64 v[200:201], 0
    v_mov_b64 v[202:203], 0
    v_mov_b64 v[204:205], 0
    v_mov_b64 v[206:207], 0
    v_mov_b64 v[208:209], 0
    v_mov_b64 v[210:211], 0
    v_mov_b64 v[212:213], 0
    v_mov_b64 v[214:215], 0
    v_mov_b64 v[216:217], 0
    v_mov_b64 v[218:219], 0
    v_mov_b64 v[220:221], 0
    v_mov_b64 v[222:223], 0
    s_cmp_eq_u32 s41, 3
    s_cbranch_scc1 L_5
    s_waitcnt vmcnt(8)
    s_branch L_6
L_5:
    s_waitcnt vmcnt(16)
L_6:
    s_barrier
    s_cmp_eq_u32 s41, 3
    s_cbranch_scc1 L_7
    s_add_u32 s57, s59, 2
    s_sub_u32 s48, s57, 10
    s_cmp_ge_u32 s57, 10
    s_cselect_b32 s57, s48, s57
    s_mul_i32 s57, s57, 786432
    s_add_u32 s57, s57, s44
    s_add_u32 m0, s42, 0
    s_add_u32 s48, s57, 0
    buffer_load_dwordx4 v2, s[12:15], s48 offen lds
    buffer_load_dwordx4 v3, s[12:15], s48 offen offset:1024 lds
    s_add_u32 m0, s42, 6144
    s_add_u32 s48, s57, 196608
    buffer_load_dwordx4 v2, s[12:15], s48 offen lds
    buffer_load_dwordx4 v3, s[12:15], s48 offen offset:1024 lds
    s_add_u32 m0, s42, 12288
    s_add_u32 s48, s57, 393216
    buffer_load_dwordx4 v2, s[12:15], s48 offen lds
    buffer_load_dwordx4 v3, s[12:15], s48 offen offset:1024 lds
    s_add_u32 m0, s42, 18432
    s_add_u32 s48, s57, 589824
    buffer_load_dwordx4 v2, s[12:15], s48 offen lds
    buffer_load_dwordx4 v3, s[12:15], s48 offen offset:1024 lds
    s_branch L_8
L_7:
    s_add_u32 s57, s59, 2
    s_sub_u32 s48, s57, 10
    s_cmp_ge_u32 s57, 10
    s_cselect_b32 s57, s48, s57
    s_mul_i32 s57, s57, 128
    s_add_u32 s57, s57, s46
    s_mov_b32 m0, 147456
    s_add_u32 s48, s57, 0
    buffer_load_dwordx4 v10, s[20:23], s48 offen offset:0 lds
    buffer_load_dwordx4 v11, s[20:23], s48 offen offset:1024 lds
    s_mov_b32 m0, 149504
    s_add_u32 s48, s57, 20480
    buffer_load_dwordx4 v10, s[20:23], s48 offen offset:0 lds
    buffer_load_dwordx4 v11, s[20:23], s48 offen offset:1024 lds
    s_mov_b32 m0, 151552
    s_add_u32 s48, s57, 40960
    buffer_load_dwordx4 v10, s[20:23], s48 offen offset:0 lds
    buffer_load_dwordx4 v11, s[20:23], s48 offen offset:1024 lds
    s_mov_b32 m0, 153600
    s_add_u32 s48, s57, 61440
    buffer_load_dwordx4 v10, s[20:23], s48 offen offset:0 lds
    buffer_load_dwordx4 v11, s[20:23], s48 offen offset:1024 lds
    s_mov_b32 m0, 155648
    s_add_u32 s48, s57, 81920
    buffer_load_dwordx4 v10, s[20:23], s48 offen offset:0 lds
    buffer_load_dwordx4 v11, s[20:23], s48 offen offset:1024 lds
    s_mov_b32 m0, 157696
    s_add_u32 s48, s57, 102400
    buffer_load_dwordx4 v10, s[20:23], s48 offen offset:0 lds
    buffer_load_dwordx4 v11, s[20:23], s48 offen offset:1024 lds
    s_mov_b32 m0, 159744
    s_add_u32 s48, s57, 122880
    buffer_load_dwordx4 v10, s[20:23], s48 offen offset:0 lds
    buffer_load_dwordx4 v11, s[20:23], s48 offen offset:1024 lds
    s_mov_b32 m0, 161792
    s_add_u32 s48, s57, 143360
    buffer_load_dwordx4 v10, s[20:23], s48 offen offset:0 lds
    buffer_load_dwordx4 v11, s[20:23], s48 offen offset:1024 lds
L_8:
    s_cmp_eq_u32 s41, 3
    s_cbranch_scc1 L_9
    s_waitcnt vmcnt(8)
    s_branch L_10
L_9:
    s_waitcnt vmcnt(16)
L_10:
    s_barrier
    s_cmp_eq_u32 s41, 3
    s_cbranch_scc1 L_11
    s_add_u32 s57, s59, 3
    s_sub_u32 s48, s57, 10
    s_cmp_ge_u32 s57, 10
    s_cselect_b32 s57, s48, s57
    s_mul_i32 s57, s57, 786432
    s_add_u32 s57, s57, s44
    s_add_u32 m0, s42, 24576
    s_add_u32 s48, s57, 0
    buffer_load_dwordx4 v2, s[12:15], s48 offen lds
    buffer_load_dwordx4 v3, s[12:15], s48 offen offset:1024 lds
    s_add_u32 m0, s42, 30720
    s_add_u32 s48, s57, 196608
    buffer_load_dwordx4 v2, s[12:15], s48 offen lds
    buffer_load_dwordx4 v3, s[12:15], s48 offen offset:1024 lds
    s_add_u32 m0, s42, 36864
    s_add_u32 s48, s57, 393216
    buffer_load_dwordx4 v2, s[12:15], s48 offen lds
    buffer_load_dwordx4 v3, s[12:15], s48 offen offset:1024 lds
    s_add_u32 m0, s42, 43008
    s_add_u32 s48, s57, 589824
    buffer_load_dwordx4 v2, s[12:15], s48 offen lds
    buffer_load_dwordx4 v3, s[12:15], s48 offen offset:1024 lds
    s_branch L_12
L_11:
    s_add_u32 s57, s59, 3
    s_sub_u32 s48, s57, 10
    s_cmp_ge_u32 s57, 10
    s_cselect_b32 s57, s48, s57
    s_mul_i32 s57, s57, 128
    s_add_u32 s57, s57, s46
    s_mov_b32 m0, 131072
    s_add_u32 s48, s57, 0
    buffer_load_dwordx4 v10, s[20:23], s48 offen offset:0 lds
    buffer_load_dwordx4 v11, s[20:23], s48 offen offset:1024 lds
    s_mov_b32 m0, 133120
    s_add_u32 s48, s57, 20480
    buffer_load_dwordx4 v10, s[20:23], s48 offen offset:0 lds
    buffer_load_dwordx4 v11, s[20:23], s48 offen offset:1024 lds
    s_mov_b32 m0, 135168
    s_add_u32 s48, s57, 40960
    buffer_load_dwordx4 v10, s[20:23], s48 offen offset:0 lds
    buffer_load_dwordx4 v11, s[20:23], s48 offen offset:1024 lds
    s_mov_b32 m0, 137216
    s_add_u32 s48, s57, 61440
    buffer_load_dwordx4 v10, s[20:23], s48 offen offset:0 lds
    buffer_load_dwordx4 v11, s[20:23], s48 offen offset:1024 lds
    s_mov_b32 m0, 139264
    s_add_u32 s48, s57, 81920
    buffer_load_dwordx4 v10, s[20:23], s48 offen offset:0 lds
    buffer_load_dwordx4 v11, s[20:23], s48 offen offset:1024 lds
    s_mov_b32 m0, 141312
    s_add_u32 s48, s57, 102400
    buffer_load_dwordx4 v10, s[20:23], s48 offen offset:0 lds
    buffer_load_dwordx4 v11, s[20:23], s48 offen offset:1024 lds
    s_mov_b32 m0, 143360
    s_add_u32 s48, s57, 122880
    buffer_load_dwordx4 v10, s[20:23], s48 offen offset:0 lds
    buffer_load_dwordx4 v11, s[20:23], s48 offen offset:1024 lds
    s_mov_b32 m0, 145408
    s_add_u32 s48, s57, 143360
    buffer_load_dwordx4 v10, s[20:23], s48 offen offset:0 lds
    buffer_load_dwordx4 v11, s[20:23], s48 offen offset:1024 lds
L_12:
    s_cmp_eq_u32 s41, 3
    s_cbranch_scc1 L_13
    s_waitcnt vmcnt(8)
    s_branch L_14
L_13:
    s_waitcnt vmcnt(16)
L_14:
    s_barrier
    s_cmp_eq_u32 s41, 3
    s_cbranch_scc1 L_15
    s_add_u32 s57, s59, 4
    s_sub_u32 s48, s57, 10
    s_cmp_ge_u32 s57, 10
    s_cselect_b32 s57, s48, s57
    s_mul_i32 s57, s57, 786432
    s_add_u32 s57, s57, s44
    s_add_u32 m0, s42, 49152
    s_add_u32 s48, s57, 0
    buffer_load_dwordx4 v2, s[12:15], s48 offen lds
    buffer_load_dwordx4 v3, s[12:15], s48 offen offset:1024 lds
    s_add_u32 m0, s42, 55296
    s_add_u32 s48, s57, 196608
    buffer_load_dwordx4 v2, s[12:15], s48 offen lds
    buffer_load_dwordx4 v3, s[12:15], s48 offen offset:1024 lds
    s_add_u32 m0, s42, 61440
    s_add_u32 s48, s57, 393216
    buffer_load_dwordx4 v2, s[12:15], s48 offen lds
    buffer_load_dwordx4 v3, s[12:15], s48 offen offset:1024 lds
    s_add_u32 m0, s42, 67584
    s_add_u32 s48, s57, 589824
    buffer_load_dwordx4 v2, s[12:15], s48 offen lds
    buffer_load_dwordx4 v3, s[12:15], s48 offen offset:1024 lds
    s_branch L_16
L_15:
    s_add_u32 s57, s59, 4
    s_sub_u32 s48, s57, 10
    s_cmp_ge_u32 s57, 10
    s_cselect_b32 s57, s48, s57
    s_mul_i32 s57, s57, 128
    s_add_u32 s57, s57, s46
    s_mov_b32 m0, 114688
    s_add_u32 s48, s57, 0
    buffer_load_dwordx4 v10, s[20:23], s48 offen offset:0 lds
    buffer_load_dwordx4 v11, s[20:23], s48 offen offset:1024 lds
    s_mov_b32 m0, 116736
    s_add_u32 s48, s57, 20480
    buffer_load_dwordx4 v10, s[20:23], s48 offen offset:0 lds
    buffer_load_dwordx4 v11, s[20:23], s48 offen offset:1024 lds
    s_mov_b32 m0, 118784
    s_add_u32 s48, s57, 40960
    buffer_load_dwordx4 v10, s[20:23], s48 offen offset:0 lds
    buffer_load_dwordx4 v11, s[20:23], s48 offen offset:1024 lds
    s_mov_b32 m0, 120832
    s_add_u32 s48, s57, 61440
    buffer_load_dwordx4 v10, s[20:23], s48 offen offset:0 lds
    buffer_load_dwordx4 v11, s[20:23], s48 offen offset:1024 lds
    s_mov_b32 m0, 122880
    s_add_u32 s48, s57, 81920
    buffer_load_dwordx4 v10, s[20:23], s48 offen offset:0 lds
    buffer_load_dwordx4 v11, s[20:23], s48 offen offset:1024 lds
    s_mov_b32 m0, 124928
    s_add_u32 s48, s57, 102400
    buffer_load_dwordx4 v10, s[20:23], s48 offen offset:0 lds
    buffer_load_dwordx4 v11, s[20:23], s48 offen offset:1024 lds
    s_mov_b32 m0, 126976
    s_add_u32 s48, s57, 122880
    buffer_load_dwordx4 v10, s[20:23], s48 offen offset:0 lds
    buffer_load_dwordx4 v11, s[20:23], s48 offen offset:1024 lds
    s_mov_b32 m0, 129024
    s_add_u32 s48, s57, 143360
    buffer_load_dwordx4 v10, s[20:23], s48 offen offset:0 lds
    buffer_load_dwordx4 v11, s[20:23], s48 offen offset:1024 lds
L_16:
    s_cmp_eq_u32 s41, 3
    s_cbranch_scc1 L_17
    s_waitcnt vmcnt(8)
    s_branch L_18
L_17:
    s_waitcnt vmcnt(16)
L_18:
    s_barrier
    s_cmp_eq_u32 s41, 3
    s_cbranch_scc1 L_19
    s_add_u32 s57, s59, 5
    s_sub_u32 s48, s57, 10
    s_cmp_ge_u32 s57, 10
    s_cselect_b32 s57, s48, s57
    s_mul_i32 s57, s57, 786432
    s_add_u32 s57, s57, s44
    s_add_u32 m0, s42, 73728
    s_add_u32 s48, s57, 0
    buffer_load_dwordx4 v2, s[12:15], s48 offen lds
    buffer_load_dwordx4 v3, s[12:15], s48 offen offset:1024 lds
    s_add_u32 m0, s42, 79872
    s_add_u32 s48, s57, 196608
    buffer_load_dwordx4 v2, s[12:15], s48 offen lds
    buffer_load_dwordx4 v3, s[12:15], s48 offen offset:1024 lds
    s_add_u32 m0, s42, 86016
    s_add_u32 s48, s57, 393216
    buffer_load_dwordx4 v2, s[12:15], s48 offen lds
    buffer_load_dwordx4 v3, s[12:15], s48 offen offset:1024 lds
    s_add_u32 m0, s42, 92160
    s_add_u32 s48, s57, 589824
    buffer_load_dwordx4 v2, s[12:15], s48 offen lds
    buffer_load_dwordx4 v3, s[12:15], s48 offen offset:1024 lds
    s_branch L_20
L_19:
    s_add_u32 s57, s59, 5
    s_sub_u32 s48, s57, 10
    s_cmp_ge_u32 s57, 10
    s_cselect_b32 s57, s48, s57
    s_mul_i32 s57, s57, 128
    s_add_u32 s57, s57, s46
    s_mov_b32 m0, 147456
    s_add_u32 s48, s57, 0
    buffer_load_dwordx4 v10, s[20:23], s48 offen offset:0 lds
    buffer_load_dwordx4 v11, s[20:23], s48 offen offset:1024 lds
    s_mov_b32 m0, 149504
    s_add_u32 s48, s57, 20480
    buffer_load_dwordx4 v10, s[20:23], s48 offen offset:0 lds
    buffer_load_dwordx4 v11, s[20:23], s48 offen offset:1024 lds
    s_mov_b32 m0, 151552
    s_add_u32 s48, s57, 40960
    buffer_load_dwordx4 v10, s[20:23], s48 offen offset:0 lds
    buffer_load_dwordx4 v11, s[20:23], s48 offen offset:1024 lds
    s_mov_b32 m0, 153600
    s_add_u32 s48, s57, 61440
    buffer_load_dwordx4 v10, s[20:23], s48 offen offset:0 lds
    buffer_load_dwordx4 v11, s[20:23], s48 offen offset:1024 lds
    s_mov_b32 m0, 155648
    s_add_u32 s48, s57, 81920
    buffer_load_dwordx4 v10, s[20:23], s48 offen offset:0 lds
    buffer_load_dwordx4 v11, s[20:23], s48 offen offset:1024 lds
    s_mov_b32 m0, 157696
    s_add_u32 s48, s57, 102400
    buffer_load_dwordx4 v10, s[20:23], s48 offen offset:0 lds
    buffer_load_dwordx4 v11, s[20:23], s48 offen offset:1024 lds
    s_mov_b32 m0, 159744
    s_add_u32 s48, s57, 122880
    buffer_load_dwordx4 v10, s[20:23], s48 offen offset:0 lds
    buffer_load_dwordx4 v11, s[20:23], s48 offen offset:1024 lds
    s_mov_b32 m0, 161792
    s_add_u32 s48, s57, 143360
    buffer_load_dwordx4 v10, s[20:23], s48 offen offset:0 lds
    buffer_load_dwordx4 v11, s[20:23], s48 offen offset:1024 lds
L_20:
    s_cmp_eq_u32 s41, 3
    s_cbranch_scc1 L_21
    s_waitcnt vmcnt(8)
    s_branch L_22
L_21:
    s_waitcnt vmcnt(16)
L_22:
    s_barrier
    s_cmp_eq_u32 s41, 3
    s_cbranch_scc1 L_23
    s_add_u32 s57, s59, 6
    s_sub_u32 s48, s57, 10
    s_cmp_ge_u32 s57, 10
    s_cselect_b32 s57, s48, s57
    s_mul_i32 s57, s57, 786432
    s_add_u32 s57, s57, s44
    s_add_u32 m0, s42, 0
    s_add_u32 s48, s57, 0
    buffer_load_dwordx4 v2, s[12:15], s48 offen lds
    buffer_load_dwordx4 v3, s[12:15], s48 offen offset:1024 lds
    s_add_u32 m0, s42, 6144
    s_add_u32 s48, s57, 196608
    buffer_load_dwordx4 v2, s[12:15], s48 offen lds
    buffer_load_dwordx4 v3, s[12:15], s48 offen offset:1024 lds
    s_add_u32 m0, s42, 12288
    s_add_u32 s48, s57, 393216
    buffer_load_dwordx4 v2, s[12:15], s48 offen lds
    buffer_load_dwordx4 v3, s[12:15], s48 offen offset:1024 lds
    s_add_u32 m0, s42, 18432
    s_add_u32 s48, s57, 589824
    buffer_load_dwordx4 v2, s[12:15], s48 offen lds
    buffer_load_dwordx4 v3, s[12:15], s48 offen offset:1024 lds
    s_branch L_24
L_23:
    s_add_u32 s57, s59, 6
    s_sub_u32 s48, s57, 10
    s_cmp_ge_u32 s57, 10
    s_cselect_b32 s57, s48, s57
    s_mul_i32 s57, s57, 128
    s_add_u32 s57, s57, s46
    s_mov_b32 m0, 131072
    s_add_u32 s48, s57, 0
    buffer_load_dwordx4 v10, s[20:23], s48 offen offset:0 lds
    buffer_load_dwordx4 v11, s[20:23], s48 offen offset:1024 lds
    s_mov_b32 m0, 133120
    s_add_u32 s48, s57, 20480
    buffer_load_dwordx4 v10, s[20:23], s48 offen offset:0 lds
    buffer_load_dwordx4 v11, s[20:23], s48 offen offset:1024 lds
    s_mov_b32 m0, 135168
    s_add_u32 s48, s57, 40960
    buffer_load_dwordx4 v10, s[20:23], s48 offen offset:0 lds
    buffer_load_dwordx4 v11, s[20:23], s48 offen offset:1024 lds
    s_mov_b32 m0, 137216
    s_add_u32 s48, s57, 61440
    buffer_load_dwordx4 v10, s[20:23], s48 offen offset:0 lds
    buffer_load_dwordx4 v11, s[20:23], s48 offen offset:1024 lds
    s_mov_b32 m0, 139264
    s_add_u32 s48, s57, 81920
    buffer_load_dwordx4 v10, s[20:23], s48 offen offset:0 lds
    buffer_load_dwordx4 v11, s[20:23], s48 offen offset:1024 lds
    s_mov_b32 m0, 141312
    s_add_u32 s48, s57, 102400
    buffer_load_dwordx4 v10, s[20:23], s48 offen offset:0 lds
    buffer_load_dwordx4 v11, s[20:23], s48 offen offset:1024 lds
    s_mov_b32 m0, 143360
    s_add_u32 s48, s57, 122880
    buffer_load_dwordx4 v10, s[20:23], s48 offen offset:0 lds
    buffer_load_dwordx4 v11, s[20:23], s48 offen offset:1024 lds
    s_mov_b32 m0, 145408
    s_add_u32 s48, s57, 143360
    buffer_load_dwordx4 v10, s[20:23], s48 offen offset:0 lds
    buffer_load_dwordx4 v11, s[20:23], s48 offen offset:1024 lds
L_24:
    s_cmp_eq_u32 s41, 3
    s_cbranch_scc1 L_25
    s_waitcnt vmcnt(8)
    s_branch L_26
L_25:
    s_waitcnt vmcnt(16)
L_26:
    s_barrier
    s_cmp_eq_u32 s41, 3
    s_cbranch_scc1 L_27
    s_add_u32 s57, s59, 7
    s_sub_u32 s48, s57, 10
    s_cmp_ge_u32 s57, 10
    s_cselect_b32 s57, s48, s57
    s_mul_i32 s57, s57, 786432
    s_add_u32 s57, s57, s44
    s_add_u32 m0, s42, 24576
    s_add_u32 s48, s57, 0
    buffer_load_dwordx4 v2, s[12:15], s48 offen lds
    buffer_load_dwordx4 v3, s[12:15], s48 offen offset:1024 lds
    s_add_u32 m0, s42, 30720
    s_add_u32 s48, s57, 196608
    buffer_load_dwordx4 v2, s[12:15], s48 offen lds
    buffer_load_dwordx4 v3, s[12:15], s48 offen offset:1024 lds
    s_add_u32 m0, s42, 36864
    s_add_u32 s48, s57, 393216
    buffer_load_dwordx4 v2, s[12:15], s48 offen lds
    buffer_load_dwordx4 v3, s[12:15], s48 offen offset:1024 lds
    s_add_u32 m0, s42, 43008
    s_add_u32 s48, s57, 589824
    buffer_load_dwordx4 v2, s[12:15], s48 offen lds
    buffer_load_dwordx4 v3, s[12:15], s48 offen offset:1024 lds
    s_branch L_28
L_27:
    s_add_u32 s57, s59, 7
    s_sub_u32 s48, s57, 10
    s_cmp_ge_u32 s57, 10
    s_cselect_b32 s57, s48, s57
    s_mul_i32 s57, s57, 128
    s_add_u32 s57, s57, s46
    s_mov_b32 m0, 114688
    s_add_u32 s48, s57, 0
    buffer_load_dwordx4 v10, s[20:23], s48 offen offset:0 lds
    buffer_load_dwordx4 v11, s[20:23], s48 offen offset:1024 lds
    s_mov_b32 m0, 116736
    s_add_u32 s48, s57, 20480
    buffer_load_dwordx4 v10, s[20:23], s48 offen offset:0 lds
    buffer_load_dwordx4 v11, s[20:23], s48 offen offset:1024 lds
    s_mov_b32 m0, 118784
    s_add_u32 s48, s57, 40960
    buffer_load_dwordx4 v10, s[20:23], s48 offen offset:0 lds
    buffer_load_dwordx4 v11, s[20:23], s48 offen offset:1024 lds
    s_mov_b32 m0, 120832
    s_add_u32 s48, s57, 61440
    buffer_load_dwordx4 v10, s[20:23], s48 offen offset:0 lds
    buffer_load_dwordx4 v11, s[20:23], s48 offen offset:1024 lds
    s_mov_b32 m0, 122880
    s_add_u32 s48, s57, 81920
    buffer_load_dwordx4 v10, s[20:23], s48 offen offset:0 lds
    buffer_load_dwordx4 v11, s[20:23], s48 offen offset:1024 lds
    s_mov_b32 m0, 124928
    s_add_u32 s48, s57, 102400
    buffer_load_dwordx4 v10, s[20:23], s48 offen offset:0 lds
    buffer_load_dwordx4 v11, s[20:23], s48 offen offset:1024 lds
    s_mov_b32 m0, 126976
    s_add_u32 s48, s57, 122880
    buffer_load_dwordx4 v10, s[20:23], s48 offen offset:0 lds
    buffer_load_dwordx4 v11, s[20:23], s48 offen offset:1024 lds
    s_mov_b32 m0, 129024
    s_add_u32 s48, s57, 143360
    buffer_load_dwordx4 v10, s[20:23], s48 offen offset:0 lds
    buffer_load_dwordx4 v11, s[20:23], s48 offen offset:1024 lds
L_28:
    s_cmp_eq_u32 s41, 3
    s_cbranch_scc1 L_29
    s_add_u32 m0, s42, 98304
    s_add_u32 s48, s43, 0
    buffer_load_dwordx4 v10, s[4:7], s48 offen nt lds
    buffer_load_dwordx4 v11, s[4:7], s48 offen offset:1024 nt lds
    s_add_u32 m0, s42, 104448
    s_add_u32 s48, s43, 6144
    buffer_load_dwordx4 v10, s[4:7], s48 offen nt lds
    buffer_load_dwordx4 v11, s[4:7], s48 offen offset:1024 nt lds
L_29:
    s_cmp_eq_u32 s41, 3
    s_cbranch_scc1 L_31
    s_waitcnt vmcnt(12)
    s_branch L_32
L_31:
    s_waitcnt vmcnt(16)
L_32:
    s_barrier
    s_cmp_eq_u32 s41, 3
    s_cbranch_scc1 L_33
    s_add_u32 s57, s59, 8
    s_sub_u32 s48, s57, 10
    s_cmp_ge_u32 s57, 10
    s_cselect_b32 s57, s48, s57
    s_mul_i32 s57, s57, 786432
    s_add_u32 s57, s57, s44
    s_add_u32 m0, s42, 49152
    s_add_u32 s48, s57, 0
    buffer_load_dwordx4 v2, s[12:15], s48 offen lds
    buffer_load_dwordx4 v3, s[12:15], s48 offen offset:1024 lds
    s_add_u32 m0, s42, 55296
    s_add_u32 s48, s57, 196608
    buffer_load_dwordx4 v2, s[12:15], s48 offen lds
    buffer_load_dwordx4 v3, s[12:15], s48 offen offset:1024 lds
    s_add_u32 m0, s42, 61440
    s_add_u32 s48, s57, 393216
    buffer_load_dwordx4 v2, s[12:15], s48 offen lds
    buffer_load_dwordx4 v3, s[12:15], s48 offen offset:1024 lds
    s_add_u32 m0, s42, 67584
    s_add_u32 s48, s57, 589824
    buffer_load_dwordx4 v2, s[12:15], s48 offen lds
    buffer_load_dwordx4 v3, s[12:15], s48 offen offset:1024 lds
    s_branch L_34
L_33:
    s_add_u32 s57, s59, 8
    s_sub_u32 s48, s57, 10
    s_cmp_ge_u32 s57, 10
    s_cselect_b32 s57, s48, s57
    s_mul_i32 s57, s57, 128
    s_add_u32 s57, s57, s46
    s_mov_b32 m0, 147456
    s_add_u32 s48, s57, 0
    buffer_load_dwordx4 v10, s[20:23], s48 offen offset:0 lds
    buffer_load_dwordx4 v11, s[20:23], s48 offen offset:1024 lds
    s_mov_b32 m0, 149504
    s_add_u32 s48, s57, 20480
    buffer_load_dwordx4 v10, s[20:23], s48 offen offset:0 lds
    buffer_load_dwordx4 v11, s[20:23], s48 offen offset:1024 lds
    s_mov_b32 m0, 151552
    s_add_u32 s48, s57, 40960
    buffer_load_dwordx4 v10, s[20:23], s48 offen offset:0 lds
    buffer_load_dwordx4 v11, s[20:23], s48 offen offset:1024 lds
    s_mov_b32 m0, 153600
    s_add_u32 s48, s57, 61440
    buffer_load_dwordx4 v10, s[20:23], s48 offen offset:0 lds
    buffer_load_dwordx4 v11, s[20:23], s48 offen offset:1024 lds
    s_mov_b32 m0, 155648
    s_add_u32 s48, s57, 81920
    buffer_load_dwordx4 v10, s[20:23], s48 offen offset:0 lds
    buffer_load_dwordx4 v11, s[20:23], s48 offen offset:1024 lds
    s_mov_b32 m0, 157696
    s_add_u32 s48, s57, 102400
    buffer_load_dwordx4 v10, s[20:23], s48 offen offset:0 lds
    buffer_load_dwordx4 v11, s[20:23], s48 offen offset:1024 lds
    s_mov_b32 m0, 159744
    s_add_u32 s48, s57, 122880
    buffer_load_dwordx4 v10, s[20:23], s48 offen offset:0 lds
    buffer_load_dwordx4 v11, s[20:23], s48 offen offset:1024 lds
    s_mov_b32 m0, 161792
    s_add_u32 s48, s57, 143360
    buffer_load_dwordx4 v10, s[20:23], s48 offen offset:0 lds
    buffer_load_dwordx4 v11, s[20:23], s48 offen offset:1024 lds
L_34:
    s_cmp_eq_u32 s41, 3
    s_cbranch_scc1 L_35
    s_waitcnt vmcnt(12)
    s_branch L_36
L_35:
    s_waitcnt vmcnt(16)
L_36:
    s_barrier
    s_cmp_eq_u32 s41, 3
    s_cbranch_scc1 L_37
    s_add_u32 s57, s59, 9
    s_sub_u32 s48, s57, 10
    s_cmp_ge_u32 s57, 10
    s_cselect_b32 s57, s48, s57
    s_mul_i32 s57, s57, 786432
    s_add_u32 s57, s57, s44
    s_add_u32 m0, s42, 73728
    s_add_u32 s48, s57, 0
    buffer_load_dwordx4 v2, s[12:15], s48 offen lds
    buffer_load_dwordx4 v3, s[12:15], s48 offen offset:1024 lds
    s_add_u32 m0, s42, 79872
    s_add_u32 s48, s57, 196608
    buffer_load_dwordx4 v2, s[12:15], s48 offen lds
    buffer_load_dwordx4 v3, s[12:15], s48 offen offset:1024 lds
    s_add_u32 m0, s42, 86016
    s_add_u32 s48, s57, 393216
    buffer_load_dwordx4 v2, s[12:15], s48 offen lds
    buffer_load_dwordx4 v3, s[12:15], s48 offen offset:1024 lds
    s_add_u32 m0, s42, 92160
    s_add_u32 s48, s57, 589824
    buffer_load_dwordx4 v2, s[12:15], s48 offen lds
    buffer_load_dwordx4 v3, s[12:15], s48 offen offset:1024 lds
    s_branch L_38
L_37:
    s_add_u32 s57, s59, 9
    s_sub_u32 s48, s57, 10
    s_cmp_ge_u32 s57, 10
    s_cselect_b32 s57, s48, s57
    s_mul_i32 s57, s57, 128
    s_add_u32 s57, s57, s46
    s_mov_b32 m0, 131072
    s_add_u32 s48, s57, 0
    buffer_load_dwordx4 v10, s[20:23], s48 offen offset:0 lds
    buffer_load_dwordx4 v11, s[20:23], s48 offen offset:1024 lds
    s_mov_b32 m0, 133120
    s_add_u32 s48, s57, 20480
    buffer_load_dwordx4 v10, s[20:23], s48 offen offset:0 lds
    buffer_load_dwordx4 v11, s[20:23], s48 offen offset:1024 lds
    s_mov_b32 m0, 135168
    s_add_u32 s48, s57, 40960
    buffer_load_dwordx4 v10, s[20:23], s48 offen offset:0 lds
    buffer_load_dwordx4 v11, s[20:23], s48 offen offset:1024 lds
    s_mov_b32 m0, 137216
    s_add_u32 s48, s57, 61440
    buffer_load_dwordx4 v10, s[20:23], s48 offen offset:0 lds
    buffer_load_dwordx4 v11, s[20:23], s48 offen offset:1024 lds
    s_mov_b32 m0, 139264
    s_add_u32 s48, s57, 81920
    buffer_load_dwordx4 v10, s[20:23], s48 offen offset:0 lds
    buffer_load_dwordx4 v11, s[20:23], s48 offen offset:1024 lds
    s_mov_b32 m0, 141312
    s_add_u32 s48, s57, 102400
    buffer_load_dwordx4 v10, s[20:23], s48 offen offset:0 lds
    buffer_load_dwordx4 v11, s[20:23], s48 offen offset:1024 lds
    s_mov_b32 m0, 143360
    s_add_u32 s48, s57, 122880
    buffer_load_dwordx4 v10, s[20:23], s48 offen offset:0 lds
    buffer_load_dwordx4 v11, s[20:23], s48 offen offset:1024 lds
    s_mov_b32 m0, 145408
    s_add_u32 s48, s57, 143360
    buffer_load_dwordx4 v10, s[20:23], s48 offen offset:0 lds
    buffer_load_dwordx4 v11, s[20:23], s48 offen offset:1024 lds
L_38:
    s_cmp_eq_u32 s41, 3
    s_cbranch_scc1 L_39
    s_waitcnt vmcnt(8)
    s_branch L_40
L_39:
    s_waitcnt vmcnt(16)
L_40:
    s_barrier
    s_cmp_eq_u32 s41, 3
    s_cbranch_scc1 L_41
    s_add_u32 m0, s42, 110592
    s_add_u32 s48, s43, 12288
    buffer_load_dwordx4 v10, s[4:7], s48 offen nt lds
    buffer_load_dwordx4 v11, s[4:7], s48 offen offset:1024 nt lds
    s_add_u32 m0, s42, 116736
    s_add_u32 s48, s43, 18432
    buffer_load_dwordx4 v10, s[4:7], s48 offen nt lds
    buffer_load_dwordx4 v11, s[4:7], s48 offen offset:1024 nt lds
    s_add_u32 m0, s42, 0
    s_add_u32 s48, s43, 0
    buffer_load_dwordx4 v12, s[8:11], s48 offen nt lds
    buffer_load_dwordx4 v13, s[8:11], s48 offen offset:1024 nt lds
    s_add_u32 m0, s42, 6144
    s_add_u32 s48, s43, 6144
    buffer_load_dwordx4 v12, s[8:11], s48 offen nt lds
    buffer_load_dwordx4 v13, s[8:11], s48 offen offset:1024 nt lds
    s_add_u32 m0, s42, 12288
    s_add_u32 s48, s43, 12288
    buffer_load_dwordx4 v12, s[8:11], s48 offen nt lds
    buffer_load_dwordx4 v13, s[8:11], s48 offen offset:1024 nt lds
    s_add_u32 m0, s42, 18432
    s_add_u32 s48, s43, 18432
    buffer_load_dwordx4 v12, s[8:11], s48 offen nt lds
    buffer_load_dwordx4 v13, s[8:11], s48 offen offset:1024 nt lds
L_41:
    s_add_u32 s59, s59, 8
    s_sub_u32 s48, s59, 10
    s_cmp_ge_u32 s59, 10
    s_cselect_b32 s59, s48, s59
    s_cmp_eq_u32 s41, 3
    s_cbranch_scc1 L_43
    s_waitcnt vmcnt(12)
    s_branch L_44
L_43:
    s_waitcnt vmcnt(0)
L_44:
    s_barrier
    s_cmp_eq_u32 s41, 3
    s_cbranch_scc1 L_45
    s_add_u32 m0, s42, 24576
    s_add_u32 s48, s43, 24576
    buffer_load_dwordx4 v10, s[4:7], s48 offen nt lds
    buffer_load_dwordx4 v11, s[4:7], s48 offen offset:1024 nt lds
    s_add_u32 m0, s42, 30720
    s_add_u32 s48, s43, 30720
    buffer_load_dwordx4 v10, s[4:7], s48 offen nt lds
    buffer_load_dwordx4 v11, s[4:7], s48 offen offset:1024 nt lds
    s_add_u32 m0, s42, 36864
    s_add_u32 s48, s43, 36864
    buffer_load_dwordx4 v10, s[4:7], s48 offen nt lds
    buffer_load_dwordx4 v11, s[4:7], s48 offen offset:1024 nt lds
    s_add_u32 m0, s42, 43008
    s_add_u32 s48, s43, 43008
    buffer_load_dwordx4 v10, s[4:7], s48 offen nt lds
    buffer_load_dwordx4 v11, s[4:7], s48 offen offset:1024 nt lds
L_45:
    s_barrier
    s_cmp_eq_u32 s41, 3
    s_cbranch_scc1 L_47
    s_add_u32 m0, s42, 49152
    s_add_u32 s48, s43, 24576
    buffer_load_dwordx4 v12, s[8:11], s48 offen nt lds
    buffer_load_dwordx4 v13, s[8:11], s48 offen offset:1024 nt lds
    s_add_u32 m0, s42, 55296
    s_add_u32 s48, s43, 30720
    buffer_load_dwordx4 v12, s[8:11], s48 offen nt lds
    buffer_load_dwordx4 v13, s[8:11], s48 offen offset:1024 nt lds
    s_add_u32 m0, s42, 61440
    s_add_u32 s48, s43, 36864
    buffer_load_dwordx4 v12, s[8:11], s48 offen nt lds
    buffer_load_dwordx4 v13, s[8:11], s48 offen offset:1024 nt lds
    s_add_u32 m0, s42, 67584
    s_add_u32 s48, s43, 43008
    buffer_load_dwordx4 v12, s[8:11], s48 offen nt lds
    buffer_load_dwordx4 v13, s[8:11], s48 offen offset:1024 nt lds
L_47:
    s_barrier
    s_cmp_eq_u32 s41, 3
    s_cbranch_scc1 L_49
    s_waitcnt vmcnt(24)
L_49:
    s_barrier
L_SIDE_B:
    s_bitcmp1_b32 s31, 0
    s_cbranch_scc0 L_51
    v_add_u32 v16, 147456, v14
    v_xor_b32 v17, 32, v16
    v_xor_b32 v18, 64, v16
    v_xor_b32 v19, 96, v16
    ds_read_b64 v[96:97], v16 offset:0
    ds_read_b64 v[98:99], v17 offset:0
    ds_read_b64 v[100:101], v16 offset:2048
    ds_read_b64 v[102:103], v17 offset:2048
    ds_read_b64 v[112:113], v18 offset:0
    ds_read_b64 v[114:115], v19 offset:0
    ds_read_b64 v[116:117], v18 offset:2048
    ds_read_b64 v[118:119], v19 offset:2048
    v_xor_b32 v16, 4096, v16
    v_xor_b32 v17, 4096, v17
    v_xor_b32 v18, 4096, v18
    v_xor_b32 v19, 4096, v19
    ds_read_b64 v[104:105], v16 offset:0
    ds_read_b64 v[106:107], v17 offset:0
    ds_read_b64 v[108:109], v16 offset:2048
    ds_read_b64 v[110:111], v17 offset:2048
    ds_read_b64 v[120:121], v18 offset:0
    ds_read_b64 v[122:123], v19 offset:0
    ds_read_b64 v[124:125], v18 offset:2048
    s_waitcnt lgkmcnt(14)
    ds_read_b64 v[126:127], v19 offset:2048
L_51:
    s_cmp_eq_u32 s41, 3
    s_cbranch_scc1 L_53
    s_bitcmp1_b32 s35, 0
    s_cbranch_scc1 L_55
    s_add_u32 m0, s28, 0
    s_add_u32 s48, s30, 0
    buffer_load_dwordx4 v10, s[4:7], s48 offen nt lds
    buffer_load_dwordx4 v11, s[4:7], s48 offen offset:1024 nt lds
    s_add_u32 m0, s28, 6144
    s_add_u32 s48, s30, 6144
    buffer_load_dwordx4 v10, s[4:7], s48 offen nt lds
    buffer_load_dwordx4 v11, s[4:7], s48 offen offset:1024 nt lds
    s_add_u32 m0, s28, 12288
    s_add_u32 s48, s30, 12288
    buffer_load_dwordx4 v10, s[4:7], s48 offen nt lds
    buffer_load_dwordx4 v11, s[4:7], s48 offen offset:1024 nt lds
    s_add_u32 m0, s28, 18432
    s_add_u32 s48, s30, 18432
    buffer_load_dwordx4 v10, s[4:7], s48 offen nt lds
    buffer_load_dwordx4 v11, s[4:7], s48 offen offset:1024 nt lds
    s_branch L_56
L_55:
    s_add_u32 m0, s28, 0
    s_add_u32 s48, s30, 0
    buffer_load_dwordx4 v12, s[8:11], s48 offen nt lds
    buffer_load_dwordx4 v13, s[8:11], s48 offen offset:1024 nt lds
    s_add_u32 m0, s28, 6144
    s_add_u32 s48, s30, 6144
    buffer_load_dwordx4 v12, s[8:11], s48 offen nt lds
    buffer_load_dwordx4 v13, s[8:11], s48 offen offset:1024 nt lds
    s_add_u32 m0, s28, 12288
    s_add_u32 s48, s30, 12288
    buffer_load_dwordx4 v12, s[8:11], s48 offen nt lds
    buffer_load_dwordx4 v13, s[8:11], s48 offen offset:1024 nt lds
    s_add_u32 m0, s28, 18432
    s_add_u32 s48, s30, 18432
    buffer_load_dwordx4 v12, s[8:11], s48 offen nt lds
    buffer_load_dwordx4 v13, s[8:11], s48 offen offset:1024 nt lds
    s_add_u32 s30, s30, 24576
L_56:
    s_add_u32 s28, s28, 24576
    s_cmp_eq_u32 s28, s29
    s_cselect_b32 s28, s42, s28
    s_branch L_54
L_53:
    s_bitcmp1_b32 s31, 0
    s_cbranch_scc0 L_57
    s_add_u32 s57, s59, s33
    s_sub_u32 s48, s57, 10
    s_cmp_ge_u32 s57, 10
    s_cselect_b32 s57, s48, s57
    s_mul_i32 s57, s57, 786432
    s_add_u32 s57, s57, s44
    s_mov_b32 m0, 122880
    s_add_u32 s48, s57, 384
    buffer_load_dwordx4 v12, s[12:15], s48 offen offset:0 lds
    buffer_load_dwordx4 v13, s[12:15], s48 offen offset:1024 lds
    buffer_load_dwordx4 v4, s[12:15], s48 offen offset:2048 lds
    s_mov_b32 m0, 125952
    s_add_u32 s48, s57, 98688
    buffer_load_dwordx4 v12, s[12:15], s48 offen offset:0 lds
    buffer_load_dwordx4 v13, s[12:15], s48 offen offset:1024 lds
    buffer_load_dwordx4 v4, s[12:15], s48 offen offset:2048 lds
    s_mov_b32 m0, 129024
    s_add_u32 s48, s57, 196992
    buffer_load_dwordx4 v12, s[12:15], s48 offen offset:0 lds
    buffer_load_dwordx4 v13, s[12:15], s48 offen offset:1024 lds
    buffer_load_dwordx4 v4, s[12:15], s48 offen offset:2048 lds
    s_mov_b32 m0, 132096
    s_add_u32 s48, s57, 295296
    buffer_load_dwordx4 v12, s[12:15], s48 offen offset:0 lds
    buffer_load_dwordx4 v13, s[12:15], s48 offen offset:1024 lds
    buffer_load_dwordx4 v4, s[12:15], s48 offen offset:2048 lds
    s_mov_b32 m0, 135168
    s_add_u32 s48, s57, 393600
    buffer_load_dwordx4 v12, s[12:15], s48 offen offset:0 lds
    buffer_load_dwordx4 v13, s[12:15], s48 offen offset:1024 lds
    buffer_load_dwordx4 v4, s[12:15], s48 offen offset:2048 lds
    s_mov_b32 m0, 138240
    s_add_u32 s48, s57, 491904
    buffer_load_dwordx4 v12, s[12:15], s48 offen offset:0 lds
    buffer_load_dwordx4 v13, s[12:15], s48 offen offset:1024 lds
    buffer_load_dwordx4 v4, s[12:15], s48 offen offset:2048 lds
    s_mov_b32 m0, 141312
    s_add_u32 s48, s57, 590208
    buffer_load_dwordx4 v12, s[12:15], s48 offen offset:0 lds
    buffer_load_dwordx4 v13, s[12:15], s48 offen offset:1024 lds
    buffer_load_dwordx4 v4, s[12:15], s48 offen offset:2048 lds
    s_mov_b32 m0, 144384
    s_add_u32 s48, s57, 688512
    buffer_load_dwordx4 v12, s[12:15], s48 offen offset:0 lds
    buffer_load_dwordx4 v13, s[12:15], s48 offen offset:1024 lds
    buffer_load_dwordx4 v4, s[12:15], s48 offen offset:2048 lds
    s_add_u32 s33, s33, 1
L_57:
    s_bitcmp1_b32 s37, 0
    s_cbranch_scc0 L_59
    s_add_u32 s57, s59, s33
    s_sub_u32 s48, s57, 10
    s_cmp_ge_u32 s57, 10
    s_cselect_b32 s57, s48, s57
    s_mul_i32 s57, s57, 128
    s_add_u32 s57, s57, s46
    s_mov_b32 m0, 147456
    s_add_u32 s48, s57, 0
    buffer_load_dwordx4 v10, s[20:23], s48 offen offset:0 lds
    buffer_load_dwordx4 v11, s[20:23], s48 offen offset:1024 lds
    s_mov_b32 m0, 149504
    s_add_u32 s48, s57, 20480
    buffer_load_dwordx4 v10, s[20:23], s48 offen offset:0 lds
    buffer_load_dwordx4 v11, s[20:23], s48 offen offset:1024 lds
    s_mov_b32 m0, 151552
    s_add_u32 s48, s57, 40960
    buffer_load_dwordx4 v10, s[20:23], s48 offen offset:0 lds
    buffer_load_dwordx4 v11, s[20:23], s48 offen offset:1024 lds
    s_mov_b32 m0, 153600
    s_add_u32 s48, s57, 61440
    buffer_load_dwordx4 v10, s[20:23], s48 offen offset:0 lds
    buffer_load_dwordx4 v11, s[20:23], s48 offen offset:1024 lds
    s_mov_b32 m0, 155648
    s_add_u32 s48, s57, 81920
    buffer_load_dwordx4 v10, s[20:23], s48 offen offset:0 lds
    buffer_load_dwordx4 v11, s[20:23], s48 offen offset:1024 lds
    s_mov_b32 m0, 157696
    s_add_u32 s48, s57, 102400
    buffer_load_dwordx4 v10, s[20:23], s48 offen offset:0 lds
    buffer_load_dwordx4 v11, s[20:23], s48 offen offset:1024 lds
    s_mov_b32 m0, 159744
    s_add_u32 s48, s57, 122880
    buffer_load_dwordx4 v10, s[20:23], s48 offen offset:0 lds
    buffer_load_dwordx4 v11, s[20:23], s48 offen offset:1024 lds
    s_mov_b32 m0, 161792
    s_add_u32 s48, s57, 143360
    buffer_load_dwordx4 v10, s[20:23], s48 offen offset:0 lds
    buffer_load_dwordx4 v11, s[20:23], s48 offen offset:1024 lds
L_59:
L_54:
    s_sub_u32 s48, s35, s36
    s_cmp_eq_u32 s48, 30
    s_cbranch_scc0 L_61
    s_mov_b32 s38, 0x3dd53b95
    s_mov_b32 s39, 0x3dd53b95
    s_mul_i32 s48, s41, 6144
    s_add_u32 s48, s48, 131072
    v_add_u32 v44, s48, v15
    v_pk_mul_f32 v[176:177], v[176:177], s[38:39]
    v_cvt_pk_bf16_f32 v56, v176, v177
    v_pk_mul_f32 v[178:179], v[178:179], s[38:39]
    v_cvt_pk_bf16_f32 v57, v178, v179
    v_pk_mul_f32 v[180:181], v[180:181], s[38:39]
    v_cvt_pk_bf16_f32 v58, v180, v181
    v_pk_mul_f32 v[182:183], v[182:183], s[38:39]
    v_cvt_pk_bf16_f32 v59, v182, v183
    v_pk_mul_f32 v[184:185], v[184:185], s[38:39]
    v_cvt_pk_bf16_f32 v60, v184, v185
    v_pk_mul_f32 v[186:187], v[186:187], s[38:39]
    v_cvt_pk_bf16_f32 v61, v186, v187
    v_pk_mul_f32 v[188:189], v[188:189], s[38:39]
    v_cvt_pk_bf16_f32 v62, v188, v189
    v_pk_mul_f32 v[190:191], v[190:191], s[38:39]
    v_cvt_pk_bf16_f32 v63, v190, v191
    v_pk_mul_f32 v[192:193], v[192:193], s[38:39]
    v_cvt_pk_bf16_f32 v72, v192, v193
    v_pk_mul_f32 v[194:195], v[194:195], s[38:39]
    v_cvt_pk_bf16_f32 v73, v194, v195
    v_pk_mul_f32 v[196:197], v[196:197], s[38:39]
    v_cvt_pk_bf16_f32 v74, v196, v197
    v_pk_mul_f32 v[198:199], v[198:199], s[38:39]
    v_cvt_pk_bf16_f32 v75, v198, v199
    v_pk_mul_f32 v[200:201], v[200:201], s[38:39]
    v_cvt_pk_bf16_f32 v76, v200, v201
    v_pk_mul_f32 v[202:203], v[202:203], s[38:39]
    v_cvt_pk_bf16_f32 v77, v202, v203
    v_pk_mul_f32 v[204:205], v[204:205], s[38:39]
    v_cvt_pk_bf16_f32 v78, v204, v205
    v_pk_mul_f32 v[206:207], v[206:207], s[38:39]
    v_cvt_pk_bf16_f32 v79, v206, v207
    v_pk_mul_f32 v[208:209], v[208:209], s[38:39]
    v_cvt_pk_bf16_f32 v88, v208, v209
    v_pk_mul_f32 v[210:211], v[210:211], s[38:39]
    v_cvt_pk_bf16_f32 v89, v210, v211
    v_pk_mul_f32 v[212:213], v[212:213], s[38:39]
    v_cvt_pk_bf16_f32 v90, v212, v213
    v_pk_mul_f32 v[214:215], v[214:215], s[38:39]
    v_cvt_pk_bf16_f32 v91, v214, v215
    v_pk_mul_f32 v[216:217], v[216:217], s[38:39]
    v_cvt_pk_bf16_f32 v92, v216, v217
    v_pk_mul_f32 v[218:219], v[218:219], s[38:39]
    v_cvt_pk_bf16_f32 v93, v218, v219
    v_pk_mul_f32 v[220:221], v[220:221], s[38:39]
    v_cvt_pk_bf16_f32 v94, v220, v221
    v_pk_mul_f32 v[222:223], v[222:223], s[38:39]
    v_cvt_pk_bf16_f32 v95, v222, v223
    v_permlane32_swap_b32 v56, v58
    v_permlane32_swap_b32 v57, v59
    v_permlane32_swap_b32 v60, v62
    v_permlane32_swap_b32 v61, v63
    v_permlane32_swap_b32 v72, v74
    v_permlane32_swap_b32 v73, v75
    v_permlane32_swap_b32 v76, v78
    v_permlane32_swap_b32 v77, v79
    v_permlane32_swap_b32 v88, v90
    v_permlane32_swap_b32 v89, v91
    v_permlane32_swap_b32 v92, v94
    v_permlane32_swap_b32 v93, v95
    v_permlane16_swap_b32 v56, v58
    v_permlane16_swap_b32 v57, v59
    v_permlane16_swap_b32 v60, v62
    v_permlane16_swap_b32 v61, v63
    v_permlane16_swap_b32 v72, v74
    v_permlane16_swap_b32 v73, v75
    v_permlane16_swap_b32 v76, v78
    v_permlane16_swap_b32 v77, v79
    v_permlane16_swap_b32 v88, v90
    v_permlane16_swap_b32 v89, v91
    v_permlane16_swap_b32 v92, v94
    v_permlane16_swap_b32 v93, v95
    ds_write_b128 v44, v[56:59] offset:0
    ds_write_b128 v44, v[60:63] offset:1024
    ds_write_b128 v44, v[72:75] offset:2048
    ds_write_b128 v44, v[76:79] offset:3072
    ds_write_b128 v44, v[88:91] offset:4096
    ds_write_b128 v44, v[92:95] offset:5120
    v_pk_mul_f32 v[128:129], v[128:129], s[38:39]
    v_cvt_pk_bf16_f32 v48, v128, v129
    v_pk_mul_f32 v[130:131], v[130:131], s[38:39]
    v_cvt_pk_bf16_f32 v49, v130, v131
    v_pk_mul_f32 v[132:133], v[132:133], s[38:39]
    v_cvt_pk_bf16_f32 v50, v132, v133
    v_pk_mul_f32 v[134:135], v[134:135], s[38:39]
    v_cvt_pk_bf16_f32 v51, v134, v135
    v_pk_mul_f32 v[136:137], v[136:137], s[38:39]
    v_cvt_pk_bf16_f32 v52, v136, v137
    v_pk_mul_f32 v[138:139], v[138:139], s[38:39]
    v_cvt_pk_bf16_f32 v53, v138, v139
    v_pk_mul_f32 v[140:141], v[140:141], s[38:39]
    v_cvt_pk_bf16_f32 v54, v140, v141
    v_pk_mul_f32 v[142:143], v[142:143], s[38:39]
    v_cvt_pk_bf16_f32 v55, v142, v143
    v_pk_mul_f32 v[144:145], v[144:145], s[38:39]
    v_cvt_pk_bf16_f32 v64, v144, v145
    v_pk_mul_f32 v[146:147], v[146:147], s[38:39]
    v_cvt_pk_bf16_f32 v65, v146, v147
    v_pk_mul_f32 v[148:149], v[148:149], s[38:39]
    v_cvt_pk_bf16_f32 v66, v148, v149
    v_pk_mul_f32 v[150:151], v[150:151], s[38:39]
    v_cvt_pk_bf16_f32 v67, v150, v151
    v_pk_mul_f32 v[152:153], v[152:153], s[38:39]
    v_cvt_pk_bf16_f32 v68, v152, v153
    v_pk_mul_f32 v[154:155], v[154:155], s[38:39]
    v_cvt_pk_bf16_f32 v69, v154, v155
    v_pk_mul_f32 v[156:157], v[156:157], s[38:39]
    v_cvt_pk_bf16_f32 v70, v156, v157
    v_pk_mul_f32 v[158:159], v[158:159], s[38:39]
    v_cvt_pk_bf16_f32 v71, v158, v159
    v_pk_mul_f32 v[160:161], v[160:161], s[38:39]
    v_cvt_pk_bf16_f32 v80, v160, v161
    v_pk_mul_f32 v[162:163], v[162:163], s[38:39]
    v_cvt_pk_bf16_f32 v81, v162, v163
    v_pk_mul_f32 v[164:165], v[164:165], s[38:39]
    v_cvt_pk_bf16_f32 v82, v164, v165
    v_pk_mul_f32 v[166:167], v[166:167], s[38:39]
    v_cvt_pk_bf16_f32 v83, v166, v167
    v_pk_mul_f32 v[168:169], v[168:169], s[38:39]
    v_cvt_pk_bf16_f32 v84, v168, v169
    v_pk_mul_f32 v[170:171], v[170:171], s[38:39]
    v_cvt_pk_bf16_f32 v85, v170, v171
    v_pk_mul_f32 v[172:173], v[172:173], s[38:39]
    v_cvt_pk_bf16_f32 v86, v172, v173
    v_pk_mul_f32 v[174:175], v[174:175], s[38:39]
    v_cvt_pk_bf16_f32 v87, v174, v175
    v_permlane32_swap_b32 v48, v50
    v_permlane32_swap_b32 v49, v51
    v_permlane32_swap_b32 v52, v54
    v_permlane32_swap_b32 v53, v55
    v_permlane32_swap_b32 v64, v66
    v_permlane32_swap_b32 v65, v67
    v_permlane32_swap_b32 v68, v70
    v_permlane32_swap_b32 v69, v71
    v_permlane32_swap_b32 v80, v82
    v_permlane32_swap_b32 v81, v83
    v_permlane32_swap_b32 v84, v86
    v_permlane32_swap_b32 v85, v87
    v_permlane16_swap_b32 v48, v50
    v_permlane16_swap_b32 v49, v51
    v_permlane16_swap_b32 v52, v54
    v_permlane16_swap_b32 v53, v55
    v_permlane16_swap_b32 v64, v66
    v_permlane16_swap_b32 v65, v67
    v_permlane16_swap_b32 v68, v70
    v_permlane16_swap_b32 v69, v71
    v_permlane16_swap_b32 v80, v82
    v_permlane16_swap_b32 v81, v83
    v_permlane16_swap_b32 v84, v86
    v_permlane16_swap_b32 v85, v87
    s_and_b32 s48, s41, 1
    s_lshl_b32 s48, s48, 6
    v_xor_b32 v1, s48, v1
    v_mov_b64 v[240:241], 0
    v_mov_b64 v[242:243], 0
    v_mov_b64 v[244:245], 0
    v_mov_b64 v[246:247], 0
    v_mov_b64 v[248:249], 0
    v_mov_b64 v[250:251], 0
    v_mov_b64 v[252:253], 0
    v_mov_b64 v[254:255], 0
    v_mov_b64 v[128:129], 0
    v_mov_b64 v[130:131], 0
    v_mov_b64 v[132:133], 0
    v_mov_b64 v[134:135], 0
    v_mov_b64 v[136:137], 0
    v_mov_b64 v[138:139], 0
    v_mov_b64 v[140:141], 0
    v_mov_b64 v[142:143], 0
    v_mov_b64 v[144:145], 0
    v_mov_b64 v[146:147], 0
    v_mov_b64 v[148:149], 0
    v_mov_b64 v[150:151], 0
    v_mov_b64 v[152:153], 0
    v_mov_b64 v[154:155], 0
    v_mov_b64 v[156:157], 0
    v_mov_b64 v[158:159], 0
    v_mov_b64 v[160:161], 0
    v_mov_b64 v[162:163], 0
    v_mov_b64 v[164:165], 0
    v_mov_b64 v[166:167], 0
    v_mov_b64 v[168:169], 0
    v_mov_b64 v[170:171], 0
    v_mov_b64 v[172:173], 0
    v_mov_b64 v[174:175], 0
    v_mov_b64 v[176:177], 0
    v_mov_b64 v[178:179], 0
    v_mov_b64 v[180:181], 0
    v_mov_b64 v[182:183], 0
    v_mov_b64 v[184:185], 0
    v_mov_b64 v[186:187], 0
    v_mov_b64 v[188:189], 0
    v_mov_b64 v[190:191], 0
    v_mov_b64 v[192:193], 0
    v_mov_b64 v[194:195], 0
    v_mov_b64 v[196:197], 0
    v_mov_b64 v[198:199], 0
    v_mov_b64 v[200:201], 0
    v_mov_b64 v[202:203], 0
    v_mov_b64 v[204:205], 0
    v_mov_b64 v[206:207], 0
    v_mov_b64 v[208:209], 0
    v_mov_b64 v[210:211], 0
    v_mov_b64 v[212:213], 0
    v_mov_b64 v[214:215], 0
    v_mov_b64 v[216:217], 0
    v_mov_b64 v[218:219], 0
    v_mov_b64 v[220:221], 0
    v_mov_b64 v[222:223], 0
    v_mov_b32 v16, 0x3f803f80
    v_mov_b32 v17, 0x3f803f80
    v_mov_b32 v18, 0x3f803f80
    v_mov_b32 v19, 0x3f803f80
    s_mov_b32 s58, 0xff800000
    v_lshrrev_b32 v24, 2, v0
    v_mul_u32_u24 v14, 128, v24
    v_bfe_u32 v24, v0, 3, 2
    v_lshl_add_u32 v14, v24, 5, v14
    v_and_b32 v24, 3, v0
    v_lshl_add_u32 v14, v24, 3, v14
    s_waitcnt lgkmcnt(0)
L_61:
    s_sub_u32 s48, s35, s36
    s_cmp_eq_u32 s48, 31
    s_cbranch_scc0 L_63
    s_xor_b32 s54, s41, 1
    s_mul_i32 s48, s54, 6144
    s_add_u32 s48, s48, 131072
    v_add_u32 v44, s48, v15
    ds_read_b128 v[56:59], v44 offset:0
    ds_read_b128 v[60:63], v44 offset:1024
    ds_read_b128 v[72:75], v44 offset:2048
    ds_read_b128 v[76:79], v44 offset:3072
    ds_read_b128 v[88:91], v44 offset:4096
    ds_read_b128 v[92:95], v44 offset:5120
    s_waitcnt lgkmcnt(0)
L_63:
    s_bitcmp1_b32 s32, 0
    s_cbranch_scc0 L_65
    s_and_b32 s48, s41, 1
    s_lshl_b32 s48, s48, 6
    v_xor_b32 v5, s48, v9
    v_add_u32 v5, 122880, v5
    v_xor_b32 v6, 32, v5
    ds_read_b64_tr_b16 v[24:25], v5 offset:0
    ds_read_b64_tr_b16 v[26:27], v5 offset:6144
    ds_read_b64_tr_b16 v[28:29], v5 offset:12288
    ds_read_b64_tr_b16 v[30:31], v5 offset:18432
    s_waitcnt lgkmcnt(2)
    v_mfma_f32_16x16x32_bf16 v[128:131], v[24:27], v[96:99], v[128:131]
    ds_read_b64_tr_b16 v[32:33], v6 offset:0
    s_waitcnt lgkmcnt(1)
    v_mfma_f32_16x16x32_bf16 v[128:131], v[28:31], v[112:115], v[128:131]
    ds_read_b64_tr_b16 v[34:35], v6 offset:6144
    v_mfma_f32_16x16x32_bf16 v[136:139], v[28:31], v[116:119], v[136:139]
    ds_read_b64_tr_b16 v[36:37], v6 offset:12288
    v_mfma_f32_16x16x32_bf16 v[136:139], v[24:27], v[100:103], v[136:139]
    ds_read_b64_tr_b16 v[38:39], v6 offset:18432
    v_mfma_f32_16x16x32_bf16 v[176:179], v[24:27], v[104:107], v[176:179]
    v_mfma_f32_16x16x32_bf16 v[176:179], v[28:31], v[120:123], v[176:179]
    v_mfma_f32_16x16x32_bf16 v[184:187], v[28:31], v[124:127], v[184:187]
    v_mfma_f32_16x16x32_bf16 v[184:187], v[24:27], v[108:111], v[184:187]
    s_waitcnt lgkmcnt(2)
    v_mfma_f32_16x16x32_bf16 v[188:191], v[32:35], v[108:111], v[188:191]
    ds_read_b64_tr_b16 v[24:25], v5 offset:128
    s_waitcnt lgkmcnt(1)
    v_mfma_f32_16x16x32_bf16 v[188:191], v[36:39], v[124:127], v[188:191]
    ds_read_b64_tr_b16 v[26:27], v5 offset:6272
    v_mfma_f32_16x16x32_bf16 v[180:183], v[36:39], v[120:123], v[180:183]
    ds_read_b64_tr_b16 v[28:29], v5 offset:12416
    v_mfma_f32_16x16x32_bf16 v[180:183], v[32:35], v[104:107], v[180:183]
    ds_read_b64_tr_b16 v[30:31], v5 offset:18560
    v_mfma_f32_16x16x32_bf16 v[140:143], v[32:35], v[100:103], v[140:143]
    v_mfma_f32_16x16x32_bf16 v[140:143], v[36:39], v[116:119], v[140:143]
    v_mfma_f32_16x16x32_bf16 v[132:135], v[36:39], v[112:115], v[132:135]
    v_mfma_f32_16x16x32_bf16 v[132:135], v[32:35], v[96:99], v[132:135]
    s_waitcnt lgkmcnt(2)
    v_mfma_f32_16x16x32_bf16 v[144:147], v[24:27], v[96:99], v[144:147]
    ds_read_b64_tr_b16 v[32:33], v6 offset:128
    s_waitcnt lgkmcnt(1)
    v_mfma_f32_16x16x32_bf16 v[144:147], v[28:31], v[112:115], v[144:147]
    ds_read_b64_tr_b16 v[34:35], v6 offset:6272
    v_mfma_f32_16x16x32_bf16 v[152:155], v[28:31], v[116:119], v[152:155]
    ds_read_b64_tr_b16 v[36:37], v6 offset:12416
    v_mfma_f32_16x16x32_bf16 v[152:155], v[24:27], v[100:103], v[152:155]
    ds_read_b64_tr_b16 v[38:39], v6 offset:18560
    v_mfma_f32_16x16x32_bf16 v[192:195], v[24:27], v[104:107], v[192:195]
    v_mfma_f32_16x16x32_bf16 v[192:195], v[28:31], v[120:123], v[192:195]
    v_mfma_f32_16x16x32_bf16 v[200:203], v[28:31], v[124:127], v[200:203]
    v_mfma_f32_16x16x32_bf16 v[200:203], v[24:27], v[108:111], v[200:203]
    s_waitcnt lgkmcnt(2)
    v_mfma_f32_16x16x32_bf16 v[204:207], v[32:35], v[108:111], v[204:207]
    ds_read_b64_tr_b16 v[24:25], v5 offset:256
    s_waitcnt lgkmcnt(1)
    v_mfma_f32_16x16x32_bf16 v[204:207], v[36:39], v[124:127], v[204:207]
    ds_read_b64_tr_b16 v[26:27], v5 offset:6400
    v_mfma_f32_16x16x32_bf16 v[196:199], v[36:39], v[120:123], v[196:199]
    ds_read_b64_tr_b16 v[28:29], v5 offset:12544
    v_mfma_f32_16x16x32_bf16 v[196:199], v[32:35], v[104:107], v[196:199]
    ds_read_b64_tr_b16 v[30:31], v5 offset:18688
    v_mfma_f32_16x16x32_bf16 v[156:159], v[32:35], v[100:103], v[156:159]
    v_mfma_f32_16x16x32_bf16 v[156:159], v[36:39], v[116:119], v[156:159]
    v_mfma_f32_16x16x32_bf16 v[148:151], v[36:39], v[112:115], v[148:151]
    v_mfma_f32_16x16x32_bf16 v[148:151], v[32:35], v[96:99], v[148:151]
    s_waitcnt lgkmcnt(2)
    v_mfma_f32_16x16x32_bf16 v[160:163], v[24:27], v[96:99], v[160:163]
    ds_read_b64_tr_b16 v[32:33], v6 offset:256
    s_waitcnt lgkmcnt(1)
    v_mfma_f32_16x16x32_bf16 v[160:163], v[28:31], v[112:115], v[160:163]
    ds_read_b64_tr_b16 v[34:35], v6 offset:6400
    v_mfma_f32_16x16x32_bf16 v[168:171], v[28:31], v[116:119], v[168:171]
    ds_read_b64_tr_b16 v[36:37], v6 offset:12544
    v_mfma_f32_16x16x32_bf16 v[168:171], v[24:27], v[100:103], v[168:171]
    ds_read_b64_tr_b16 v[38:39], v6 offset:18688
    v_mfma_f32_16x16x32_bf16 v[208:211], v[24:27], v[104:107], v[208:211]
    v_mfma_f32_16x16x32_bf16 v[208:211], v[28:31], v[120:123], v[208:211]
    v_mfma_f32_16x16x32_bf16 v[216:219], v[28:31], v[124:127], v[216:219]
    v_mfma_f32_16x16x32_bf16 v[216:219], v[24:27], v[108:111], v[216:219]
    s_waitcnt lgkmcnt(2)
    v_mfma_f32_16x16x32_bf16 v[220:223], v[32:35], v[108:111], v[220:223]
    s_waitcnt lgkmcnt(0)
    v_mfma_f32_16x16x32_bf16 v[220:223], v[36:39], v[124:127], v[220:223]
    v_mfma_f32_16x16x32_bf16 v[212:215], v[36:39], v[120:123], v[212:215]
    v_mfma_f32_16x16x32_bf16 v[212:215], v[32:35], v[104:107], v[212:215]
    v_mfma_f32_16x16x32_bf16 v[172:175], v[32:35], v[100:103], v[172:175]
    v_mfma_f32_16x16x32_bf16 v[172:175], v[36:39], v[116:119], v[172:175]
    v_mfma_f32_16x16x32_bf16 v[164:167], v[36:39], v[112:115], v[164:167]
    v_mfma_f32_16x16x32_bf16 v[164:167], v[32:35], v[96:99], v[164:167]
L_65:
    s_cmp_eq_u32 s41, 3
    s_cbranch_scc1 L_67
    s_waitcnt vmcnt(24)
    s_branch L_68
L_67:
    s_bitcmp1_b32 s37, 0
    s_cbranch_scc1 L_69
    s_or_b32 s48, s32, s31
    s_bitcmp1_b32 s48, 1
    s_cbranch_scc0 L_71
    s_waitcnt vmcnt(0)
L_71:
    s_branch L_70
L_69:
    s_waitcnt vmcnt(16)
L_70:
L_68:
    s_lshr_b32 s31, s31, 1
    s_lshr_b32 s32, s32, 1
    s_lshr_b32 s37, s37, 1
    s_add_u32 s35, s35, 1
    s_cmp_lt_u32 s35, 32
    s_waitcnt lgkmcnt(0)
    s_barrier
    s_cbranch_scc1 L_SIDE_B
    s_cmp_eq_u32 s36, 1
    s_cbranch_scc0 L_73
    s_xor_b32 s54, s41, 1
    s_mul_i32 s48, s54, 6144
    s_add_u32 s48, s48, 131072
    v_add_u32 v44, s48, v15
    ds_read_b128 v[56:59], v44 offset:0
    ds_read_b128 v[60:63], v44 offset:1024
    ds_read_b128 v[72:75], v44 offset:2048
    ds_read_b128 v[76:79], v44 offset:3072
    ds_read_b128 v[88:91], v44 offset:4096
    ds_read_b128 v[92:95], v44 offset:5120
    s_waitcnt lgkmcnt(0)
L_73:
    s_mov_b32 s50, 24576
L_ATT:
    s_setprio 0
    s_mov_b32 s51, 0
L_ATT_LOOP:
    v_add_u32 v2, s50, v1
    v_xor_b32 v3, 64, v2
    ds_read_b128 v[24:27], v2 offset:0
    ds_read_b128 v[28:31], v3 offset:0
    ds_read_b128 v[32:35], v2 offset:128
    s_waitcnt lgkmcnt(2)
    v_mfma_f32_16x16x32_bf16 v[96:99], v[24:27], v[48:51], v[240:243]
    ds_read_b128 v[36:39], v3 offset:128
    s_waitcnt lgkmcnt(2)
    v_mfma_f32_16x16x32_bf16 v[96:99], v[28:31], v[56:59], v[96:99]
    v_mfma_f32_16x16x32_bf16 v[104:107], v[28:31], v[60:63], v[244:247]
    ds_read_b128 v[40:43], v2 offset:256
    v_mfma_f32_16x16x32_bf16 v[104:107], v[24:27], v[52:55], v[104:107]
    s_waitcnt lgkmcnt(2)
    v_mfma_f32_16x16x32_bf16 v[104:107], v[32:35], v[68:71], v[104:107]
    ds_read_b128 v[24:27], v3 offset:256
    s_waitcnt lgkmcnt(2)
    v_mfma_f32_16x16x32_bf16 v[104:107], v[36:39], v[76:79], v[104:107]
    v_mfma_f32_16x16x32_bf16 v[96:99], v[36:39], v[72:75], v[96:99]
    ds_read_b128 v[28:31], v2 offset:6144
    v_mfma_f32_16x16x32_bf16 v[96:99], v[32:35], v[64:67], v[96:99]
    s_waitcnt lgkmcnt(2)
    v_mfma_f32_16x16x32_bf16 v[96:99], v[40:43], v[80:83], v[96:99]
    ds_read_b128 v[32:35], v3 offset:6144
    s_waitcnt lgkmcnt(2)
    v_mfma_f32_16x16x32_bf16 v[96:99], v[24:27], v[88:91], v[96:99]
    v_mfma_f32_16x16x32_bf16 v[104:107], v[24:27], v[92:95], v[104:107]
    ds_read_b128 v[36:39], v2 offset:6272
    v_mfma_f32_16x16x32_bf16 v[104:107], v[40:43], v[84:87], v[104:107]
    s_waitcnt lgkmcnt(2)
    v_mfma_f32_16x16x32_bf16 v[108:111], v[28:31], v[52:55], v[244:247]
    ds_read_b128 v[40:43], v3 offset:6272
    s_waitcnt lgkmcnt(2)
    v_mfma_f32_16x16x32_bf16 v[108:111], v[32:35], v[60:63], v[108:111]
    v_mfma_f32_16x16x32_bf16 v[100:103], v[32:35], v[56:59], v[240:243]
    ds_read_b128 v[24:27], v2 offset:6400
    v_mfma_f32_16x16x32_bf16 v[100:103], v[28:31], v[48:51], v[100:103]
    v_exp_f32 v44, v96
    v_exp_f32 v45, v97
    s_waitcnt lgkmcnt(2)
    v_mfma_f32_16x16x32_bf16 v[100:103], v[36:39], v[64:67], v[100:103]
    ds_read_b128 v[28:31], v3 offset:6400
    v_exp_f32 v46, v98
    s_waitcnt lgkmcnt(2)
    v_mfma_f32_16x16x32_bf16 v[100:103], v[40:43], v[72:75], v[100:103]
    v_cvt_pk_bf16_f32 v224, v44, v45
    v_mfma_f32_16x16x32_bf16 v[108:111], v[40:43], v[76:79], v[108:111]
    ds_read_b128 v[32:35], v2 offset:12288
    v_exp_f32 v47, v99
    v_mfma_f32_16x16x32_bf16 v[108:111], v[36:39], v[68:71], v[108:111]
    v_exp_f32 v44, v104
    s_waitcnt lgkmcnt(2)
    v_mfma_f32_16x16x32_bf16 v[108:111], v[24:27], v[84:87], v[108:111]
    ds_read_b128 v[36:39], v3 offset:12288
    v_cvt_pk_bf16_f32 v225, v46, v47
    s_waitcnt lgkmcnt(2)
    v_mfma_f32_16x16x32_bf16 v[108:111], v[28:31], v[92:95], v[108:111]
    v_exp_f32 v45, v105
    v_or3_b32 v20, v224, v225, 0
    v_mfma_f32_16x16x32_bf16 v[100:103], v[28:31], v[88:91], v[100:103]
    ds_read_b128 v[40:43], v2 offset:12416
    v_exp_f32 v46, v106
    v_mfma_f32_16x16x32_bf16 v[100:103], v[24:27], v[80:83], v[100:103]
    v_cvt_pk_bf16_f32 v228, v44, v45
    s_waitcnt lgkmcnt(2)
    v_mfma_f32_16x16x32_bf16 v[112:115], v[32:35], v[48:51], v[240:243]
    ds_read_b128 v[24:27], v3 offset:12416
    v_exp_f32 v47, v107
    s_waitcnt lgkmcnt(2)
    v_mfma_f32_16x16x32_bf16 v[112:115], v[36:39], v[56:59], v[112:115]
    v_cvt_pk_bf16_f32 v229, v46, v47
    v_mfma_f32_16x16x32_bf16 v[120:123], v[36:39], v[60:63], v[244:247]
    ds_read_b128 v[28:31], v2 offset:12544
    v_or3_b32 v20, v228, v229, v20
    v_mfma_f32_16x16x32_bf16 v[120:123], v[32:35], v[52:55], v[120:123]
    v_exp_f32 v44, v100
    v_exp_f32 v45, v101
    s_waitcnt lgkmcnt(2)
    v_mfma_f32_16x16x32_bf16 v[120:123], v[40:43], v[68:71], v[120:123]
    ds_read_b128 v[32:35], v3 offset:12544
    v_exp_f32 v46, v102
    s_waitcnt lgkmcnt(2)
    v_mfma_f32_16x16x32_bf16 v[120:123], v[24:27], v[76:79], v[120:123]
    v_cvt_pk_bf16_f32 v226, v44, v45
    v_mfma_f32_16x16x32_bf16 v[112:115], v[24:27], v[72:75], v[112:115]
    ds_read_b128 v[36:39], v2 offset:18432
    v_exp_f32 v47, v103
    v_mfma_f32_16x16x32_bf16 v[112:115], v[40:43], v[64:67], v[112:115]
    v_exp_f32 v44, v108
    s_waitcnt lgkmcnt(2)
    v_mfma_f32_16x16x32_bf16 v[112:115], v[28:31], v[80:83], v[112:115]
    ds_read_b128 v[40:43], v3 offset:18432
    v_cvt_pk_bf16_f32 v227, v46, v47
    s_waitcnt lgkmcnt(2)
    v_mfma_f32_16x16x32_bf16 v[112:115], v[32:35], v[88:91], v[112:115]
    v_exp_f32 v45, v109
    v_or3_b32 v20, v226, v227, v20
    v_mfma_f32_16x16x32_bf16 v[120:123], v[32:35], v[92:95], v[120:123]
    ds_read_b128 v[24:27], v2 offset:18560
    v_exp_f32 v46, v110
    v_mfma_f32_16x16x32_bf16 v[120:123], v[28:31], v[84:87], v[120:123]
    v_cvt_pk_bf16_f32 v230, v44, v45
    s_waitcnt lgkmcnt(2)
    v_mfma_f32_16x16x32_bf16 v[124:127], v[36:39], v[52:55], v[244:247]
    ds_read_b128 v[28:31], v3 offset:18560
    v_exp_f32 v47, v111
    s_waitcnt lgkmcnt(2)
    v_mfma_f32_16x16x32_bf16 v[124:127], v[40:43], v[60:63], v[124:127]
    v_cvt_pk_bf16_f32 v231, v46, v47
    v_mfma_f32_16x16x32_bf16 v[116:119], v[40:43], v[56:59], v[240:243]
    ds_read_b128 v[32:35], v2 offset:18688
    v_or3_b32 v20, v230, v231, v20
    v_mfma_f32_16x16x32_bf16 v[116:119], v[36:39], v[48:51], v[116:119]
    v_exp_f32 v44, v112
    v_exp_f32 v45, v113
    s_waitcnt lgkmcnt(2)
    v_mfma_f32_16x16x32_bf16 v[116:119], v[24:27], v[64:67], v[116:119]
    ds_read_b128 v[36:39], v3 offset:18688
    v_exp_f32 v46, v114
    v_cvt_pk_bf16_f32 v232, v44, v45
    s_waitcnt lgkmcnt(2)
    v_mfma_f32_16x16x32_bf16 v[116:119], v[28:31], v[72:75], v[116:119]
    v_exp_f32 v47, v115
    v_mfma_f32_16x16x32_bf16 v[124:127], v[28:31], v[76:79], v[124:127]
    v_exp_f32 v44, v120
    v_cvt_pk_bf16_f32 v233, v46, v47
    v_mfma_f32_16x16x32_bf16 v[124:127], v[24:27], v[68:71], v[124:127]
    v_exp_f32 v45, v121
    s_waitcnt lgkmcnt(1)
    v_mfma_f32_16x16x32_bf16 v[124:127], v[32:35], v[84:87], v[124:127]
    v_or3_b32 v20, v232, v233, v20
    v_exp_f32 v46, v122
    s_waitcnt lgkmcnt(0)
    v_mfma_f32_16x16x32_bf16 v[124:127], v[36:39], v[92:95], v[124:127]
    v_cvt_pk_bf16_f32 v236, v44, v45
    v_mfma_f32_16x16x32_bf16 v[116:119], v[36:39], v[88:91], v[116:119]
    v_exp_f32 v47, v123
    s_nop 0
    v_cvt_pk_bf16_f32 v237, v46, v47
    v_mfma_f32_16x16x32_bf16 v[116:119], v[32:35], v[80:83], v[116:119]
    v_or3_b32 v20, v236, v237, v20
    s_cmp_eq_u32 s51, 0
    s_waitcnt vmcnt(16)
    s_cbranch_scc1 L_75
    s_waitcnt vmcnt(0)
L_75:
    s_barrier
    s_add_u32 s50, s50, 24576
    s_cmp_eq_u32 s50, 122880
    s_cselect_b32 s50, 0, s50
    v_add_u32 v5, s50, v9
    v_xor_b32 v6, 32, v5
    v_xor_b32 v7, 64, v5
    v_xor_b32 v8, 96, v5
    ds_read_b64_tr_b16 v[24:25], v5 offset:0
    ds_read_b64_tr_b16 v[26:27], v5 offset:6144
    ds_read_b64_tr_b16 v[28:29], v6 offset:0
    ds_read_b64_tr_b16 v[30:31], v6 offset:6144
    ds_read_b64_tr_b16 v[32:33], v7 offset:0
    ds_read_b64_tr_b16 v[34:35], v7 offset:6144
    ds_read_b64_tr_b16 v[36:37], v8 offset:0
    ds_read_b64_tr_b16 v[38:39], v8 offset:6144
    v_and_b32 v20, s49, v20
    v_cmp_ne_u32 vcc, s58, v20
    s_cbranch_vccnz L_R0
L_R0_BACK:
    s_waitcnt lgkmcnt(6)
    v_mfma_f32_16x16x32_bf16 v[128:131], v[24:27], v[224:227], v[128:131]
    ds_read_b64_tr_b16 v[40:41], v5 offset:128
    v_exp_f32 v44, v116
    v_mfma_f32_16x16x32_bf16 v[136:139], v[24:27], v[228:231], v[136:139]
    ds_read_b64_tr_b16 v[42:43], v5 offset:6272
    v_exp_f32 v45, v117
    s_waitcnt lgkmcnt(6)
    v_mfma_f32_16x16x32_bf16 v[140:143], v[28:31], v[228:231], v[140:143]
    ds_read_b64_tr_b16 v[24:25], v6 offset:128
    v_exp_f32 v46, v118
    v_mfma_f32_16x16x32_bf16 v[132:135], v[28:31], v[224:227], v[132:135]
    ds_read_b64_tr_b16 v[26:27], v6 offset:6272
    s_waitcnt lgkmcnt(6)
    v_mfma_f32_16x16x32_bf16 v[144:147], v[32:35], v[224:227], v[144:147]
    ds_read_b64_tr_b16 v[28:29], v7 offset:128
    v_cvt_pk_bf16_f32 v234, v44, v45
    v_mfma_f32_16x16x32_bf16 v[152:155], v[32:35], v[228:231], v[152:155]
    ds_read_b64_tr_b16 v[30:31], v7 offset:6272
    v_exp_f32 v47, v119
    s_waitcnt lgkmcnt(6)
    v_mfma_f32_16x16x32_bf16 v[156:159], v[36:39], v[228:231], v[156:159]
    ds_read_b64_tr_b16 v[32:33], v8 offset:128
    v_mfma_f32_16x16x32_bf16 v[148:151], v[36:39], v[224:227], v[148:151]
    ds_read_b64_tr_b16 v[34:35], v8 offset:6272
    v_exp_f32 v44, v124
    s_waitcnt lgkmcnt(6)
    v_mfma_f32_16x16x32_bf16 v[160:163], v[40:43], v[224:227], v[160:163]
    ds_read_b64_tr_b16 v[36:37], v5 offset:256
    v_cvt_pk_bf16_f32 v235, v46, v47
    v_mfma_f32_16x16x32_bf16 v[168:171], v[40:43], v[228:231], v[168:171]
    ds_read_b64_tr_b16 v[38:39], v5 offset:6400
    s_waitcnt lgkmcnt(6)
    v_mfma_f32_16x16x32_bf16 v[172:175], v[24:27], v[228:231], v[172:175]
    ds_read_b64_tr_b16 v[40:41], v6 offset:256
    v_exp_f32 v45, v125
    v_mfma_f32_16x16x32_bf16 v[164:167], v[24:27], v[224:227], v[164:167]
    ds_read_b64_tr_b16 v[42:43], v6 offset:6400
    v_or3_b32 v20, v234, v235, 0
    s_waitcnt lgkmcnt(6)
    v_mfma_f32_16x16x32_bf16 v[176:179], v[28:31], v[224:227], v[176:179]
    ds_read_b64_tr_b16 v[24:25], v7 offset:256
    v_exp_f32 v46, v126
    v_mfma_f32_16x16x32_bf16 v[184:187], v[28:31], v[228:231], v[184:187]
    ds_read_b64_tr_b16 v[26:27], v7 offset:6400
    s_waitcnt lgkmcnt(6)
    v_mfma_f32_16x16x32_bf16 v[188:191], v[32:35], v[228:231], v[188:191]
    ds_read_b64_tr_b16 v[28:29], v8 offset:256
    v_cvt_pk_bf16_f32 v238, v44, v45
    v_mfma_f32_16x16x32_bf16 v[180:183], v[32:35], v[224:227], v[180:183]
    ds_read_b64_tr_b16 v[30:31], v8 offset:6400
    v_exp_f32 v47, v127
    s_waitcnt lgkmcnt(6)
    v_mfma_f32_16x16x32_bf16 v[192:195], v[36:39], v[224:227], v[192:195]
    ds_read_b64_tr_b16 v[32:33], v5 offset:12288
    v_mfma_f32_16x16x32_bf16 v[200:203], v[36:39], v[228:231], v[200:203]
    ds_read_b64_tr_b16 v[34:35], v5 offset:18432
    v_cvt_pk_bf16_f32 v239, v46, v47
    s_waitcnt lgkmcnt(6)
    v_mfma_f32_16x16x32_bf16 v[204:207], v[40:43], v[228:231], v[204:207]
    ds_read_b64_tr_b16 v[36:37], v6 offset:12288
    v_or3_b32 v20, v238, v239, v20
    v_mfma_f32_16x16x32_bf16 v[196:199], v[40:43], v[224:227], v[196:199]
    ds_read_b64_tr_b16 v[38:39], v6 offset:18432
    s_waitcnt lgkmcnt(6)
    v_mfma_f32_16x16x32_bf16 v[208:211], v[24:27], v[224:227], v[208:211]
    ds_read_b64_tr_b16 v[40:41], v7 offset:12288
    v_dot2c_f32_bf16 v248, v16, v224
    v_dot2c_f32_bf16 v252, v16, v228
    v_dot2c_f32_bf16 v249, v16, v225
    v_mfma_f32_16x16x32_bf16 v[216:219], v[24:27], v[228:231], v[216:219]
    ds_read_b64_tr_b16 v[42:43], v7 offset:18432
    v_dot2c_f32_bf16 v253, v16, v229
    v_dot2c_f32_bf16 v248, v16, v226
    v_dot2c_f32_bf16 v252, v16, v230
    s_waitcnt lgkmcnt(6)
    v_mfma_f32_16x16x32_bf16 v[220:223], v[28:31], v[228:231], v[220:223]
    ds_read_b64_tr_b16 v[24:25], v8 offset:12288
    v_dot2c_f32_bf16 v249, v16, v227
    v_dot2c_f32_bf16 v253, v16, v231
    v_mfma_f32_16x16x32_bf16 v[212:215], v[28:31], v[224:227], v[212:215]
    ds_read_b64_tr_b16 v[26:27], v8 offset:18432
    v_and_b32 v20, s49, v20
    v_cmp_ne_u32 vcc, s58, v20
    s_cbranch_vccnz L_R1
L_R1_BACK:
    s_waitcnt lgkmcnt(6)
    v_mfma_f32_16x16x32_bf16 v[128:131], v[32:35], v[232:235], v[128:131]
    ds_read_b64_tr_b16 v[28:29], v5 offset:12416
    v_mfma_f32_16x16x32_bf16 v[136:139], v[32:35], v[236:239], v[136:139]
    ds_read_b64_tr_b16 v[30:31], v5 offset:18560
    s_waitcnt lgkmcnt(6)
    v_mfma_f32_16x16x32_bf16 v[140:143], v[36:39], v[236:239], v[140:143]
    ds_read_b64_tr_b16 v[32:33], v6 offset:12416
    v_dot2c_f32_bf16 v248, v16, v232
    v_mfma_f32_16x16x32_bf16 v[132:135], v[36:39], v[232:235], v[132:135]
    ds_read_b64_tr_b16 v[34:35], v6 offset:18560
    s_waitcnt lgkmcnt(6)
    v_mfma_f32_16x16x32_bf16 v[144:147], v[40:43], v[232:235], v[144:147]
    ds_read_b64_tr_b16 v[36:37], v7 offset:12416
    v_dot2c_f32_bf16 v252, v16, v236
    v_mfma_f32_16x16x32_bf16 v[152:155], v[40:43], v[236:239], v[152:155]
    ds_read_b64_tr_b16 v[38:39], v7 offset:18560
    s_waitcnt lgkmcnt(6)
    v_mfma_f32_16x16x32_bf16 v[156:159], v[24:27], v[236:239], v[156:159]
    ds_read_b64_tr_b16 v[40:41], v8 offset:12416
    v_dot2c_f32_bf16 v249, v16, v233
    v_mfma_f32_16x16x32_bf16 v[148:151], v[24:27], v[232:235], v[148:151]
    ds_read_b64_tr_b16 v[42:43], v8 offset:18560
    s_waitcnt lgkmcnt(6)
    v_mfma_f32_16x16x32_bf16 v[160:163], v[28:31], v[232:235], v[160:163]
    ds_read_b64_tr_b16 v[24:25], v5 offset:12544
    v_dot2c_f32_bf16 v253, v16, v237
    v_mfma_f32_16x16x32_bf16 v[168:171], v[28:31], v[236:239], v[168:171]
    ds_read_b64_tr_b16 v[26:27], v5 offset:18688
    s_waitcnt lgkmcnt(6)
    v_mfma_f32_16x16x32_bf16 v[172:175], v[32:35], v[236:239], v[172:175]
    ds_read_b64_tr_b16 v[28:29], v6 offset:12544
    v_dot2c_f32_bf16 v248, v16, v234
    v_mfma_f32_16x16x32_bf16 v[164:167], v[32:35], v[232:235], v[164:167]
    ds_read_b64_tr_b16 v[30:31], v6 offset:18688
    s_waitcnt lgkmcnt(6)
    v_mfma_f32_16x16x32_bf16 v[176:179], v[36:39], v[232:235], v[176:179]
    ds_read_b64_tr_b16 v[32:33], v7 offset:12544
    v_dot2c_f32_bf16 v252, v16, v238
    v_mfma_f32_16x16x32_bf16 v[184:187], v[36:39], v[236:239], v[184:187]
    ds_read_b64_tr_b16 v[34:35], v7 offset:18688
    s_waitcnt lgkmcnt(6)
    v_mfma_f32_16x16x32_bf16 v[188:191], v[40:43], v[236:239], v[188:191]
    ds_read_b64_tr_b16 v[36:37], v8 offset:12544
    v_dot2c_f32_bf16 v249, v16, v235
    v_mfma_f32_16x16x32_bf16 v[180:183], v[40:43], v[232:235], v[180:183]
    ds_read_b64_tr_b16 v[38:39], v8 offset:18688
    s_waitcnt lgkmcnt(6)
    v_mfma_f32_16x16x32_bf16 v[192:195], v[24:27], v[232:235], v[192:195]
    v_dot2c_f32_bf16 v253, v16, v239
    v_mfma_f32_16x16x32_bf16 v[200:203], v[24:27], v[236:239], v[200:203]
    s_waitcnt lgkmcnt(4)
    v_mfma_f32_16x16x32_bf16 v[204:207], v[28:31], v[236:239], v[204:207]
    v_mfma_f32_16x16x32_bf16 v[196:199], v[28:31], v[232:235], v[196:199]
    s_waitcnt lgkmcnt(2)
    v_mfma_f32_16x16x32_bf16 v[208:211], v[32:35], v[232:235], v[208:211]
    v_mfma_f32_16x16x32_bf16 v[216:219], v[32:35], v[236:239], v[216:219]
    s_waitcnt lgkmcnt(0)
    v_mfma_f32_16x16x32_bf16 v[220:223], v[36:39], v[236:239], v[220:223]
    v_mfma_f32_16x16x32_bf16 v[212:215], v[36:39], v[232:235], v[212:215]
    s_cmp_eq_u32 s51, 0
    s_waitcnt vmcnt(8)
    s_cbranch_scc1 L_76
    s_waitcnt vmcnt(0)
L_76:
    s_barrier
    s_add_u32 s50, s50, 24576
    s_cmp_eq_u32 s50, 122880
    s_cselect_b32 s50, 0, s50
    s_add_u32 s51, s51, 1
    s_cmp_lt_u32 s51, 16
    s_cbranch_scc1 L_ATT_LOOP
    s_setprio 1
    s_cmp_eq_u32 s52, 1
    s_cbranch_scc1 L_B3
    s_branch L_SIDE_A
L_R0:
    v_max3_f32 v224, v96, v97, v98
    v_max3_f32 v224, v224, v99, v100
    v_max3_f32 v224, v224, v101, v102
    v_max3_f32 v224, v224, v103, v112
    v_max3_f32 v224, v224, v113, v114
    v_max3_f32 v224, v224, v115, v116
    v_max3_f32 v224, v224, v117, v118
    v_max_f32 v224, v224, v119
    v_max3_f32 v225, v104, v105, v106
    v_max3_f32 v225, v225, v107, v108
    v_max3_f32 v225, v225, v109, v110
    v_max3_f32 v225, v225, v111, v120
    v_max3_f32 v225, v225, v121, v122
    v_max3_f32 v225, v225, v123, v124
    v_max3_f32 v225, v225, v125, v126
    v_max_f32 v225, v225, v127
    v_mov_b32 v228, v224
    v_mov_b32 v229, v225
    s_nop 0
    v_permlane32_swap_b32 v224, v228
    v_permlane32_swap_b32 v225, v229
    v_max_f32 v224, v224, v228
    v_max_f32 v225, v225, v229
    v_mov_b32 v228, v224
    v_mov_b32 v229, v225
    s_nop 0
    v_permlane16_swap_b32 v224, v228
    v_permlane16_swap_b32 v225, v229
    v_max_f32 v224, v224, v228
    v_max_f32 v225, v225, v229
    v_add_f32 v224, 0x40e00000, v224
    v_max_f32 v224, s58, v224
    v_sub_f32 v44, s58, v224
    v_exp_f32 v44, v44
    v_sub_f32 v240, v240, v224
    v_sub_f32 v241, v241, v224
    v_sub_f32 v242, v242, v224
    v_sub_f32 v243, v243, v224
    v_mov_b32 v45, v44
    v_sub_f32 v96, v96, v224
    v_sub_f32 v97, v97, v224
    v_sub_f32 v98, v98, v224
    v_sub_f32 v99, v99, v224
    v_sub_f32 v100, v100, v224
    v_sub_f32 v101, v101, v224
    v_sub_f32 v102, v102, v224
    v_sub_f32 v103, v103, v224
    v_sub_f32 v112, v112, v224
    v_sub_f32 v113, v113, v224
    v_sub_f32 v114, v114, v224
    v_sub_f32 v115, v115, v224
    v_sub_f32 v116, v116, v224
    v_sub_f32 v117, v117, v224
    v_sub_f32 v118, v118, v224
    v_sub_f32 v119, v119, v224
    v_add_f32 v225, 0x40e00000, v225
    v_max_f32 v225, s58, v225
    v_sub_f32 v46, s58, v225
    v_exp_f32 v46, v46
    v_sub_f32 v244, v244, v225
    v_sub_f32 v245, v245, v225
    v_sub_f32 v246, v246, v225
    v_sub_f32 v247, v247, v225
    v_mov_b32 v47, v46
    v_sub_f32 v104, v104, v225
    v_sub_f32 v105, v105, v225
    v_sub_f32 v106, v106, v225
    v_sub_f32 v107, v107, v225
    v_sub_f32 v108, v108, v225
    v_sub_f32 v109, v109, v225
    v_sub_f32 v110, v110, v225
    v_sub_f32 v111, v111, v225
    v_sub_f32 v120, v120, v225
    v_sub_f32 v121, v121, v225
    v_sub_f32 v122, v122, v225
    v_sub_f32 v123, v123, v225
    v_sub_f32 v124, v124, v225
    v_sub_f32 v125, v125, v225
    v_sub_f32 v126, v126, v225
    v_sub_f32 v127, v127, v225
    s_cmp_eq_u32 s58, 0
    s_cbranch_scc0 L_77
    v_pk_mul_f32 v[128:129], v[128:129], v[44:45]
    v_pk_mul_f32 v[130:131], v[130:131], v[44:45]
    v_pk_mul_f32 v[132:133], v[132:133], v[44:45]
    v_pk_mul_f32 v[134:135], v[134:135], v[44:45]
    v_pk_mul_f32 v[136:137], v[136:137], v[46:47]
    v_pk_mul_f32 v[138:139], v[138:139], v[46:47]
    v_pk_mul_f32 v[140:141], v[140:141], v[46:47]
    v_pk_mul_f32 v[142:143], v[142:143], v[46:47]
    v_pk_mul_f32 v[144:145], v[144:145], v[44:45]
    v_pk_mul_f32 v[146:147], v[146:147], v[44:45]
    v_pk_mul_f32 v[148:149], v[148:149], v[44:45]
    v_pk_mul_f32 v[150:151], v[150:151], v[44:45]
    v_pk_mul_f32 v[152:153], v[152:153], v[46:47]
    v_pk_mul_f32 v[154:155], v[154:155], v[46:47]
    v_pk_mul_f32 v[156:157], v[156:157], v[46:47]
    v_pk_mul_f32 v[158:159], v[158:159], v[46:47]
    v_pk_mul_f32 v[160:161], v[160:161], v[44:45]
    v_pk_mul_f32 v[162:163], v[162:163], v[44:45]
    v_pk_mul_f32 v[164:165], v[164:165], v[44:45]
    v_pk_mul_f32 v[166:167], v[166:167], v[44:45]
    v_pk_mul_f32 v[168:169], v[168:169], v[46:47]
    v_pk_mul_f32 v[170:171], v[170:171], v[46:47]
    v_pk_mul_f32 v[172:173], v[172:173], v[46:47]
    v_pk_mul_f32 v[174:175], v[174:175], v[46:47]
    v_pk_mul_f32 v[176:177], v[176:177], v[44:45]
    v_pk_mul_f32 v[178:179], v[178:179], v[44:45]
    v_pk_mul_f32 v[180:181], v[180:181], v[44:45]
    v_pk_mul_f32 v[182:183], v[182:183], v[44:45]
    v_pk_mul_f32 v[184:185], v[184:185], v[46:47]
    v_pk_mul_f32 v[186:187], v[186:187], v[46:47]
    v_pk_mul_f32 v[188:189], v[188:189], v[46:47]
    v_pk_mul_f32 v[190:191], v[190:191], v[46:47]
    v_pk_mul_f32 v[192:193], v[192:193], v[44:45]
    v_pk_mul_f32 v[194:195], v[194:195], v[44:45]
    v_pk_mul_f32 v[196:197], v[196:197], v[44:45]
    v_pk_mul_f32 v[198:199], v[198:199], v[44:45]
    v_pk_mul_f32 v[200:201], v[200:201], v[46:47]
    v_pk_mul_f32 v[202:203], v[202:203], v[46:47]
    v_pk_mul_f32 v[204:205], v[204:205], v[46:47]
    v_pk_mul_f32 v[206:207], v[206:207], v[46:47]
    v_pk_mul_f32 v[208:209], v[208:209], v[44:45]
    v_pk_mul_f32 v[210:211], v[210:211], v[44:45]
    v_pk_mul_f32 v[212:213], v[212:213], v[44:45]
    v_pk_mul_f32 v[214:215], v[214:215], v[44:45]
    v_pk_mul_f32 v[216:217], v[216:217], v[46:47]
    v_pk_mul_f32 v[218:219], v[218:219], v[46:47]
    v_pk_mul_f32 v[220:221], v[220:221], v[46:47]
    v_pk_mul_f32 v[222:223], v[222:223], v[46:47]
    v_pk_mul_f32 v[248:249], v[248:249], v[44:45]
    v_pk_mul_f32 v[250:251], v[250:251], v[44:45]
    v_pk_mul_f32 v[252:253], v[252:253], v[46:47]
    v_pk_mul_f32 v[254:255], v[254:255], v[46:47]
L_77:
    s_mov_b32 s58, 0
    v_exp_f32 v44, v96
    v_exp_f32 v45, v97
    v_exp_f32 v46, v98
    v_cvt_pk_bf16_f32 v224, v44, v45
    v_exp_f32 v47, v99
    v_exp_f32 v44, v104
    v_cvt_pk_bf16_f32 v225, v46, v47
    v_exp_f32 v45, v105
    v_exp_f32 v46, v106
    v_cvt_pk_bf16_f32 v228, v44, v45
    v_exp_f32 v47, v107
    v_exp_f32 v44, v100
    v_cvt_pk_bf16_f32 v229, v46, v47
    v_exp_f32 v45, v101
    v_exp_f32 v46, v102
    v_cvt_pk_bf16_f32 v226, v44, v45
    v_exp_f32 v47, v103
    v_exp_f32 v44, v108
    v_cvt_pk_bf16_f32 v227, v46, v47
    v_exp_f32 v45, v109
    v_exp_f32 v46, v110
    v_cvt_pk_bf16_f32 v230, v44, v45
    v_exp_f32 v47, v111
    v_exp_f32 v44, v112
    v_cvt_pk_bf16_f32 v231, v46, v47
    v_exp_f32 v45, v113
    v_exp_f32 v46, v114
    v_cvt_pk_bf16_f32 v232, v44, v45
    v_exp_f32 v47, v115
    v_exp_f32 v44, v120
    v_cvt_pk_bf16_f32 v233, v46, v47
    v_exp_f32 v45, v121
    v_exp_f32 v46, v122
    v_cvt_pk_bf16_f32 v236, v44, v45
    v_exp_f32 v47, v123
    s_nop 0
    v_cvt_pk_bf16_f32 v237, v46, v47
    s_branch L_R0_BACK
L_R1:
    v_max3_f32 v232, v112, v113, v114
    v_max3_f32 v232, v232, v115, v116
    v_max3_f32 v232, v232, v117, v118
    v_max_f32 v232, v232, v119
    v_max3_f32 v233, v120, v121, v122
    v_max3_f32 v233, v233, v123, v124
    v_max3_f32 v233, v233, v125, v126
    v_max_f32 v233, v233, v127
    v_mov_b32 v236, v232
    v_mov_b32 v237, v233
    s_nop 0
    v_permlane32_swap_b32 v232, v236
    v_permlane32_swap_b32 v233, v237
    v_max_f32 v232, v232, v236
    v_max_f32 v233, v233, v237
    v_mov_b32 v236, v232
    v_mov_b32 v237, v233
    s_nop 0
    v_permlane16_swap_b32 v232, v236
    v_permlane16_swap_b32 v233, v237
    v_max_f32 v232, v232, v236
    v_max_f32 v233, v233, v237
    v_add_f32 v232, 0x40e00000, v232
    v_max_f32 v232, s58, v232
    v_sub_f32 v44, s58, v232
    v_exp_f32 v44, v44
    v_sub_f32 v240, v240, v232
    v_sub_f32 v241, v241, v232
    v_sub_f32 v242, v242, v232
    v_sub_f32 v243, v243, v232
    v_mov_b32 v45, v44
    v_sub_f32 v112, v112, v232
    v_sub_f32 v113, v113, v232
    v_sub_f32 v114, v114, v232
    v_sub_f32 v115, v115, v232
    v_sub_f32 v116, v116, v232
    v_sub_f32 v117, v117, v232
    v_sub_f32 v118, v118, v232
    v_sub_f32 v119, v119, v232
    v_add_f32 v233, 0x40e00000, v233
    v_max_f32 v233, s58, v233
    v_sub_f32 v46, s58, v233
    v_exp_f32 v46, v46
    v_sub_f32 v244, v244, v233
    v_sub_f32 v245, v245, v233
    v_sub_f32 v246, v246, v233
    v_sub_f32 v247, v247, v233
    v_mov_b32 v47, v46
    v_sub_f32 v120, v120, v233
    v_sub_f32 v121, v121, v233
    v_sub_f32 v122, v122, v233
    v_sub_f32 v123, v123, v233
    v_sub_f32 v124, v124, v233
    v_sub_f32 v125, v125, v233
    v_sub_f32 v126, v126, v233
    v_sub_f32 v127, v127, v233
    v_pk_mul_f32 v[128:129], v[128:129], v[44:45]
    v_pk_mul_f32 v[130:131], v[130:131], v[44:45]
    v_pk_mul_f32 v[132:133], v[132:133], v[44:45]
    v_pk_mul_f32 v[134:135], v[134:135], v[44:45]
    v_pk_mul_f32 v[136:137], v[136:137], v[46:47]
    v_pk_mul_f32 v[138:139], v[138:139], v[46:47]
    v_pk_mul_f32 v[140:141], v[140:141], v[46:47]
    v_pk_mul_f32 v[142:143], v[142:143], v[46:47]
    v_pk_mul_f32 v[144:145], v[144:145], v[44:45]
    v_pk_mul_f32 v[146:147], v[146:147], v[44:45]
    v_pk_mul_f32 v[148:149], v[148:149], v[44:45]
    v_pk_mul_f32 v[150:151], v[150:151], v[44:45]
    v_pk_mul_f32 v[152:153], v[152:153], v[46:47]
    v_pk_mul_f32 v[154:155], v[154:155], v[46:47]
    v_pk_mul_f32 v[156:157], v[156:157], v[46:47]
    v_pk_mul_f32 v[158:159], v[158:159], v[46:47]
    v_pk_mul_f32 v[160:161], v[160:161], v[44:45]
    v_pk_mul_f32 v[162:163], v[162:163], v[44:45]
    v_pk_mul_f32 v[164:165], v[164:165], v[44:45]
    v_pk_mul_f32 v[166:167], v[166:167], v[44:45]
    v_pk_mul_f32 v[168:169], v[168:169], v[46:47]
    v_pk_mul_f32 v[170:171], v[170:171], v[46:47]
    v_pk_mul_f32 v[172:173], v[172:173], v[46:47]
    v_pk_mul_f32 v[174:175], v[174:175], v[46:47]
    v_pk_mul_f32 v[176:177], v[176:177], v[44:45]
    v_pk_mul_f32 v[178:179], v[178:179], v[44:45]
    v_pk_mul_f32 v[180:181], v[180:181], v[44:45]
    v_pk_mul_f32 v[182:183], v[182:183], v[44:45]
    v_pk_mul_f32 v[184:185], v[184:185], v[46:47]
    v_pk_mul_f32 v[186:187], v[186:187], v[46:47]
    v_pk_mul_f32 v[188:189], v[188:189], v[46:47]
    v_pk_mul_f32 v[190:191], v[190:191], v[46:47]
    v_pk_mul_f32 v[192:193], v[192:193], v[44:45]
    v_pk_mul_f32 v[194:195], v[194:195], v[44:45]
    v_pk_mul_f32 v[196:197], v[196:197], v[44:45]
    v_pk_mul_f32 v[198:199], v[198:199], v[44:45]
    v_pk_mul_f32 v[200:201], v[200:201], v[46:47]
    v_pk_mul_f32 v[202:203], v[202:203], v[46:47]
    v_pk_mul_f32 v[204:205], v[204:205], v[46:47]
    v_pk_mul_f32 v[206:207], v[206:207], v[46:47]
    v_pk_mul_f32 v[208:209], v[208:209], v[44:45]
    v_pk_mul_f32 v[210:211], v[210:211], v[44:45]
    v_pk_mul_f32 v[212:213], v[212:213], v[44:45]
    v_pk_mul_f32 v[214:215], v[214:215], v[44:45]
    v_pk_mul_f32 v[216:217], v[216:217], v[46:47]
    v_pk_mul_f32 v[218:219], v[218:219], v[46:47]
    v_pk_mul_f32 v[220:221], v[220:221], v[46:47]
    v_pk_mul_f32 v[222:223], v[222:223], v[46:47]
    v_pk_mul_f32 v[248:249], v[248:249], v[44:45]
    v_pk_mul_f32 v[250:251], v[250:251], v[44:45]
    v_pk_mul_f32 v[252:253], v[252:253], v[46:47]
    v_pk_mul_f32 v[254:255], v[254:255], v[46:47]
    s_mov_b32 s58, 0
    v_exp_f32 v44, v112
    v_exp_f32 v45, v113
    v_exp_f32 v46, v114
    v_cvt_pk_bf16_f32 v232, v44, v45
    v_exp_f32 v47, v115
    v_exp_f32 v44, v120
    v_cvt_pk_bf16_f32 v233, v46, v47
    v_exp_f32 v45, v121
    v_exp_f32 v46, v122
    v_cvt_pk_bf16_f32 v236, v44, v45
    v_exp_f32 v47, v123
    v_exp_f32 v44, v116
    v_cvt_pk_bf16_f32 v237, v46, v47
    v_exp_f32 v45, v117
    v_exp_f32 v46, v118
    v_cvt_pk_bf16_f32 v234, v44, v45
    v_exp_f32 v47, v119
    v_exp_f32 v44, v124
    v_cvt_pk_bf16_f32 v235, v46, v47
    v_exp_f32 v45, v125
    v_exp_f32 v46, v126
    v_cvt_pk_bf16_f32 v238, v44, v45
    v_exp_f32 v47, v127
    s_nop 0
    v_cvt_pk_bf16_f32 v239, v46, v47
    s_branch L_R1_BACK
L_A:
    s_waitcnt lgkmcnt(0)
    s_mov_b32 s12, s34
    s_and_b32 s13, s35, 0xffff
    s_mov_b32 s14, 7864320
    s_mov_b32 s15, 0x20000
    s_mov_b32 s20, s28
    s_and_b32 s21, s29, 0xffff
    s_mov_b32 s22, 2621440
    s_mov_b32 s23, 0x20000
    s_mov_b32 s4, s30
    s_and_b32 s5, s31, 0xffff
    s_mov_b32 s6, 201326592
    s_mov_b32 s7, 0x20000
    s_mov_b32 s8, s32
    s_and_b32 s9, s33, 0xffff
    s_mov_b32 s10, 201326592
    s_mov_b32 s11, 0x20000
    s_mov_b32 s16, s36
    s_and_b32 s17, s37, 0xffff
    s_mov_b32 s18, 7864320
    s_mov_b32 s19, 0x20000
    s_mov_b32 s24, s38
    s_and_b32 s25, s39, 0xffff
    s_mov_b32 s26, 805306368
    s_mov_b32 s27, 0x20000
    s_bfe_u32 s54, s2, 0x10003
    s_lshl_b32 s54, s54, 2
    s_add_u32 s54, s54, s41
    s_getpc_b64 s[38:39]
L_PC_79:
    s_add_u32 s38, s38, standalone__gqa_block_cached__near_ridge_kernel-L_PC_79
    s_addc_u32 s39, s39, -1
    s_lshl_b32 s48, s54, 13
    v_lshl_add_u32 v249, v0, 7, s48
    v_min_u32 v249, L_END-standalone__gqa_block_cached__near_ridge_kernel, v249
    global_load_dword v250, v249, s[38:39]
    s_mov_b32 s20, s100
    s_and_b32 s21, s101, 0xffff
    s_mov_b32 s22, 256
    s_mov_b32 s23, 0x20000
    s_and_b32 s48, s55, 15
    s_lshl_b32 s48, s48, 3
    s_add_u32 s48, s48, s40
    s_cmp_eq_u32 s48, 3
    s_cbranch_scc0 L_80
    s_memrealtime s[38:39]
    s_waitcnt lgkmcnt(0)
    s_or_b32 s38, s38, 1
    v_mov_b32 v252, s38
    v_mov_b32 v251, 0
    s_lshr_b32 s48, s55, 2
    s_mov_b64 exec, 1
    buffer_store_dword v252, v251, s[20:23], s48 offen offset:0 sc1
    s_mov_b64 exec, -1
L_80:
    v_lshlrev_b32 v15, 4, v0
    v_and_b32 v24, 15, v0
    v_lshrrev_b32 v25, 4, v0
    v_bfe_u32 v26, v0, 1, 3
    v_xor_b32 v27, v26, v25
    v_mul_u32_u24 v1, 384, v24
    v_lshl_add_u32 v1, v27, 4, v1
    v_lshrrev_b32 v27, 1, v25
    v_xor_b32 v27, v27, v26
    v_lshlrev_b32 v27, 4, v27
    v_lshl_add_u32 v14, v24, 7, v27
    v_and_b32 v25, 1, v25
    v_lshl_add_u32 v14, v25, 3, v14
    s_lshl_b32 s48, s41, 12
    v_add_u32 v14, s48, v14
    v_lshrrev_b32 v24, 2, v0
    v_mul_u32_u24 v9, 384, v24
    v_bfe_u32 v24, v0, 3, 2
    v_lshl_add_u32 v9, v24, 5, v9
    v_and_b32 v24, 3, v0
    v_lshl_add_u32 v9, v24, 3, v9
    s_cmp_eq_u32 s41, 3
    s_cbranch_scc1 L_82
    s_lshr_b32 s48, s42, 7
    s_add_u32 s48, s48, 0
    v_lshrrev_b32 v24, 3, v0
    v_add_u32 v24, s48, v24
    v_mul_u32_u24 v25, 43, v24
    v_lshrrev_b32 v25, 7, v25
    v_lshrrev_b32 v25, 1, v25
    v_xor_b32 v26, v25, v0
    v_lshlrev_b32 v26, 4, v26
    v_add_u32 v10, s42, v26
    v_and_b32 v25, 3, v25
    v_lshlrev_b32 v25, 1, v25
    v_xor_b32 v26, v25, v0
    v_lshlrev_b32 v26, 4, v26
    v_add_u32 v12, s42, v26
    s_lshr_b32 s48, s42, 7
    s_add_u32 s48, s48, 8
    v_lshrrev_b32 v24, 3, v0
    v_add_u32 v24, s48, v24
    v_mul_u32_u24 v25, 43, v24
    v_lshrrev_b32 v25, 7, v25
    v_lshrrev_b32 v25, 1, v25
    v_xor_b32 v26, v25, v0
    v_lshlrev_b32 v26, 4, v26
    v_add_u32 v11, s42, v26
    v_and_b32 v25, 3, v25
    v_lshlrev_b32 v25, 1, v25
    v_xor_b32 v26, v25, v0
    v_lshlrev_b32 v26, 4, v26
    v_add_u32 v13, s42, v26
    s_branch L_83
L_82:
    s_lshr_b32 s48, s42, 7
    s_add_u32 s48, s48, 0
    v_lshrrev_b32 v24, 3, v0
    v_add_u32 v24, s48, v24
    v_mul_u32_u24 v25, 43, v24
    v_lshrrev_b32 v25, 7, v25
    v_mul_u32_u24 v26, 1280, v24
    v_lshrrev_b32 v25, 3, v0
    v_and_b32 v25, 6, v25
    v_xor_b32 v25, v25, v0
    v_and_b32 v25, 7, v25
    v_lshlrev_b32 v25, 4, v25
    v_add_u32 v26, v26, v25
    v_subrev_u32 v12, 0, v26
    s_lshr_b32 s48, s42, 7
    s_add_u32 s48, s48, 8
    v_lshrrev_b32 v24, 3, v0
    v_add_u32 v24, s48, v24
    v_mul_u32_u24 v25, 43, v24
    v_lshrrev_b32 v25, 7, v25
    v_mul_u32_u24 v26, 1280, v24
    v_lshrrev_b32 v25, 3, v0
    v_and_b32 v25, 6, v25
    v_xor_b32 v25, v25, v0
    v_and_b32 v25, 7, v25
    v_lshlrev_b32 v25, 4, v25
    v_add_u32 v26, v26, v25
    v_subrev_u32 v13, 1024, v26
    s_lshr_b32 s48, s42, 7
    s_add_u32 s48, s48, 16
    v_lshrrev_b32 v24, 3, v0
    v_add_u32 v24, s48, v24
    v_mul_u32_u24 v25, 43, v24
    v_lshrrev_b32 v25, 7, v25
    v_mul_u32_u24 v26, 1280, v24
    v_lshrrev_b32 v25, 3, v0
    v_and_b32 v25, 6, v25
    v_xor_b32 v25, v25, v0
    v_and_b32 v25, 7, v25
    v_lshlrev_b32 v25, 4, v25
    v_add_u32 v26, v26, v25
    v_subrev_u32 v4, 2048, v26
L_83:
    s_add_u32 s28, s42, 0
    s_add_u32 s29, s42, 122880
    s_add_u32 s30, s43, 442368
    s_mov_b32 s36, 1
    s_lshl_b32 s31, 0x09249249, s36
    s_lshl_b32 s32, s31, 2
    s_lshl_b32 s37, 0x02492492, s36
    s_mov_b32 s33, 0
    s_mov_b32 s34, 0
    s_mov_b32 s35, 0
    s_and_b32 s48, s41, 1
    s_lshl_b32 s48, s48, 6
    v_xor_b32 v116, s48, v9
    v_xor_b32 v1, s48, v1
    v_add_u32 v5, 49152, v116
    v_xor_b32 v6, 32, v5
    v_add_u32 v16, 131072, v14
    v_xor_b32 v112, 4096, v16
    v_xor_b32 v17, 32, v16
    v_xor_b32 v113, 32, v112
    v_xor_b32 v18, 64, v16
    v_xor_b32 v114, 64, v112
    v_xor_b32 v19, 96, v16
    v_xor_b32 v115, 96, v112
    s_barrier
    ds_read_b64 v[48:49], v16 offset:0
    ds_read_b64 v[50:51], v17 offset:0
    ds_read_b64 v[52:53], v16 offset:2048
    ds_read_b64 v[54:55], v17 offset:2048
    ds_read_b64_tr_b16 v[24:25], v5 offset:0
    ds_read_b64_tr_b16 v[26:27], v5 offset:6144
    ds_read_b64 v[56:57], v112 offset:0
    ds_read_b64 v[58:59], v113 offset:0
    ds_read_b64 v[60:61], v112 offset:2048
    ds_read_b64 v[62:63], v113 offset:2048
    ds_read_b64 v[64:65], v18 offset:0
    ds_read_b64 v[66:67], v19 offset:0
    ds_read_b64 v[68:69], v18 offset:2048
    ds_read_b64 v[70:71], v19 offset:2048
    ds_read_b64 v[72:73], v114 offset:0
    s_waitcnt lgkmcnt(14)
    ds_read_b64 v[74:75], v115 offset:0
    s_waitcnt lgkmcnt(14)
    ds_read_b64 v[76:77], v114 offset:2048
    s_waitcnt lgkmcnt(14)
    ds_read_b64 v[78:79], v115 offset:2048
    s_waitcnt lgkmcnt(14)
    ds_read_b64_tr_b16 v[28:29], v5 offset:12288
    s_waitcnt lgkmcnt(14)
    ds_read_b64_tr_b16 v[30:31], v5 offset:18432
    s_waitcnt lgkmcnt(14)
    v_mfma_f32_16x16x32_bf16 v[128:131], v[24:27], v[48:51], 0
    ds_read_b64_tr_b16 v[32:33], v6 offset:0
    s_waitcnt lgkmcnt(1)
    v_mfma_f32_16x16x32_bf16 v[128:131], v[28:31], v[64:67], v[128:131]
    ds_read_b64_tr_b16 v[34:35], v6 offset:6144
    v_mfma_f32_16x16x32_bf16 v[136:139], v[28:31], v[68:71], 0
    v_mfma_f32_16x16x32_bf16 v[136:139], v[24:27], v[52:55], v[136:139]
    v_mfma_f32_16x16x32_bf16 v[176:179], v[24:27], v[56:59], 0
    ds_read_b64_tr_b16 v[36:37], v6 offset:12288
    v_mfma_f32_16x16x32_bf16 v[176:179], v[28:31], v[72:75], v[176:179]
    ds_read_b64_tr_b16 v[38:39], v6 offset:18432
    v_mfma_f32_16x16x32_bf16 v[184:187], v[28:31], v[76:79], 0
    v_add_u32 v16, 114688, v14
    v_xor_b32 v112, 4096, v16
    v_mfma_f32_16x16x32_bf16 v[184:187], v[24:27], v[60:63], v[184:187]
    v_xor_b32 v17, 32, v16
    v_xor_b32 v113, 32, v112
    s_waitcnt lgkmcnt(2)
    v_mfma_f32_16x16x32_bf16 v[188:191], v[32:35], v[60:63], 0
    ds_read_b64_tr_b16 v[24:25], v5 offset:128
    s_waitcnt lgkmcnt(1)
    v_mfma_f32_16x16x32_bf16 v[188:191], v[36:39], v[76:79], v[188:191]
    ds_read_b64_tr_b16 v[26:27], v5 offset:6272
    v_mfma_f32_16x16x32_bf16 v[180:183], v[36:39], v[72:75], 0
    v_xor_b32 v18, 64, v16
    v_xor_b32 v114, 64, v112
    v_mfma_f32_16x16x32_bf16 v[180:183], v[32:35], v[56:59], v[180:183]
    s_barrier
    v_xor_b32 v19, 96, v16
    v_xor_b32 v115, 96, v112
    v_mfma_f32_16x16x32_bf16 v[140:143], v[32:35], v[52:55], 0
    ds_read_b64_tr_b16 v[28:29], v5 offset:12416
    v_mfma_f32_16x16x32_bf16 v[140:143], v[36:39], v[68:71], v[140:143]
    ds_read_b64_tr_b16 v[30:31], v5 offset:18560
    v_mfma_f32_16x16x32_bf16 v[132:135], v[36:39], v[64:67], 0
    ds_read_b64 v[80:81], v16 offset:0
    v_mfma_f32_16x16x32_bf16 v[132:135], v[32:35], v[48:51], v[132:135]
    ds_read_b64 v[82:83], v17 offset:0
    s_waitcnt lgkmcnt(4)
    v_mfma_f32_16x16x32_bf16 v[144:147], v[24:27], v[48:51], 0
    ds_read_b64_tr_b16 v[32:33], v6 offset:128
    s_waitcnt lgkmcnt(3)
    v_mfma_f32_16x16x32_bf16 v[144:147], v[28:31], v[64:67], v[144:147]
    ds_read_b64_tr_b16 v[34:35], v6 offset:6272
    v_mfma_f32_16x16x32_bf16 v[152:155], v[28:31], v[68:71], 0
    ds_read_b64 v[84:85], v16 offset:2048
    v_mfma_f32_16x16x32_bf16 v[152:155], v[24:27], v[52:55], v[152:155]
    ds_read_b64 v[86:87], v17 offset:2048
    v_mfma_f32_16x16x32_bf16 v[192:195], v[24:27], v[56:59], 0
    ds_read_b64_tr_b16 v[36:37], v6 offset:12416
    v_mfma_f32_16x16x32_bf16 v[192:195], v[28:31], v[72:75], v[192:195]
    ds_read_b64_tr_b16 v[38:39], v6 offset:18560
    v_mfma_f32_16x16x32_bf16 v[200:203], v[28:31], v[76:79], 0
    ds_read_b64 v[88:89], v112 offset:0
    v_mfma_f32_16x16x32_bf16 v[200:203], v[24:27], v[60:63], v[200:203]
    ds_read_b64 v[90:91], v113 offset:0
    s_waitcnt lgkmcnt(6)
    v_mfma_f32_16x16x32_bf16 v[204:207], v[32:35], v[60:63], 0
    ds_read_b64_tr_b16 v[24:25], v5 offset:256
    s_waitcnt lgkmcnt(3)
    v_mfma_f32_16x16x32_bf16 v[204:207], v[36:39], v[76:79], v[204:207]
    ds_read_b64_tr_b16 v[26:27], v5 offset:6400
    v_mfma_f32_16x16x32_bf16 v[196:199], v[36:39], v[72:75], 0
    ds_read_b64 v[92:93], v112 offset:2048
    v_mfma_f32_16x16x32_bf16 v[196:199], v[32:35], v[56:59], v[196:199]
    ds_read_b64 v[94:95], v113 offset:2048
    v_mfma_f32_16x16x32_bf16 v[156:159], v[32:35], v[52:55], 0
    ds_read_b64_tr_b16 v[28:29], v5 offset:12544
    v_mfma_f32_16x16x32_bf16 v[156:159], v[36:39], v[68:71], v[156:159]
    ds_read_b64_tr_b16 v[30:31], v5 offset:18688
    v_mfma_f32_16x16x32_bf16 v[148:151], v[36:39], v[64:67], 0
    ds_read_b64 v[96:97], v18 offset:0
    v_mfma_f32_16x16x32_bf16 v[148:151], v[32:35], v[48:51], v[148:151]
    ds_read_b64 v[98:99], v19 offset:0
    s_waitcnt lgkmcnt(6)
    v_mfma_f32_16x16x32_bf16 v[160:163], v[24:27], v[48:51], 0
    ds_read_b64_tr_b16 v[32:33], v6 offset:256
    s_waitcnt lgkmcnt(3)
    v_mfma_f32_16x16x32_bf16 v[160:163], v[28:31], v[64:67], v[160:163]
    ds_read_b64_tr_b16 v[34:35], v6 offset:6400
    v_mfma_f32_16x16x32_bf16 v[168:171], v[28:31], v[68:71], 0
    ds_read_b64 v[100:101], v18 offset:2048
    v_mfma_f32_16x16x32_bf16 v[168:171], v[24:27], v[52:55], v[168:171]
    ds_read_b64 v[102:103], v19 offset:2048
    v_mfma_f32_16x16x32_bf16 v[208:211], v[24:27], v[56:59], 0
    ds_read_b64_tr_b16 v[36:37], v6 offset:12544
    v_mfma_f32_16x16x32_bf16 v[208:211], v[28:31], v[72:75], v[208:211]
    ds_read_b64_tr_b16 v[38:39], v6 offset:18688
    v_mfma_f32_16x16x32_bf16 v[216:219], v[28:31], v[76:79], 0
    ds_read_b64 v[104:105], v114 offset:0
    v_mfma_f32_16x16x32_bf16 v[216:219], v[24:27], v[60:63], v[216:219]
    ds_read_b64 v[106:107], v115 offset:0
    s_waitcnt lgkmcnt(6)
    v_mfma_f32_16x16x32_bf16 v[220:223], v[32:35], v[60:63], 0
    v_add_u32 v5, 73728, v116
    v_xor_b32 v6, 32, v5
    ds_read_b64_tr_b16 v[24:25], v5 offset:0
    s_waitcnt lgkmcnt(3)
    v_mfma_f32_16x16x32_bf16 v[220:223], v[36:39], v[76:79], v[220:223]
    ds_read_b64_tr_b16 v[26:27], v5 offset:6144
    v_mfma_f32_16x16x32_bf16 v[212:215], v[36:39], v[72:75], 0
    ds_read_b64 v[108:109], v114 offset:2048
    v_mfma_f32_16x16x32_bf16 v[212:215], v[32:35], v[56:59], v[212:215]
    ds_read_b64 v[110:111], v115 offset:2048
    v_mfma_f32_16x16x32_bf16 v[172:175], v[32:35], v[52:55], 0
    ds_read_b64_tr_b16 v[28:29], v5 offset:12288
    v_mfma_f32_16x16x32_bf16 v[172:175], v[36:39], v[68:71], v[172:175]
    ds_read_b64_tr_b16 v[30:31], v5 offset:18432
    v_mfma_f32_16x16x32_bf16 v[164:167], v[36:39], v[64:67], 0
    v_mfma_f32_16x16x32_bf16 v[164:167], v[32:35], v[48:51], v[164:167]
    s_waitcnt lgkmcnt(4)
    v_mfma_f32_16x16x32_bf16 v[128:131], v[24:27], v[80:83], v[128:131]
    ds_read_b64_tr_b16 v[32:33], v6 offset:0
    s_waitcnt lgkmcnt(1)
    v_mfma_f32_16x16x32_bf16 v[128:131], v[28:31], v[96:99], v[128:131]
    ds_read_b64_tr_b16 v[34:35], v6 offset:6144
    v_mfma_f32_16x16x32_bf16 v[136:139], v[28:31], v[100:103], v[136:139]
    v_mfma_f32_16x16x32_bf16 v[136:139], v[24:27], v[84:87], v[136:139]
    v_mfma_f32_16x16x32_bf16 v[176:179], v[24:27], v[88:91], v[176:179]
    ds_read_b64_tr_b16 v[36:37], v6 offset:12288
    v_mfma_f32_16x16x32_bf16 v[176:179], v[28:31], v[104:107], v[176:179]
    ds_read_b64_tr_b16 v[38:39], v6 offset:18432
    v_mfma_f32_16x16x32_bf16 v[184:187], v[28:31], v[108:111], v[184:187]
    v_add_u32 v16, 147456, v14
    v_xor_b32 v112, 4096, v16
    v_mfma_f32_16x16x32_bf16 v[184:187], v[24:27], v[92:95], v[184:187]
    v_xor_b32 v17, 32, v16
    v_xor_b32 v113, 32, v112
    s_waitcnt lgkmcnt(2)
    v_mfma_f32_16x16x32_bf16 v[188:191], v[32:35], v[92:95], v[188:191]
    ds_read_b64_tr_b16 v[24:25], v5 offset:128
    s_waitcnt lgkmcnt(1)
    v_mfma_f32_16x16x32_bf16 v[188:191], v[36:39], v[108:111], v[188:191]
    ds_read_b64_tr_b16 v[26:27], v5 offset:6272
    v_mfma_f32_16x16x32_bf16 v[180:183], v[36:39], v[104:107], v[180:183]
    v_xor_b32 v18, 64, v16
    v_xor_b32 v114, 64, v112
    v_mfma_f32_16x16x32_bf16 v[180:183], v[32:35], v[88:91], v[180:183]
    s_barrier
    v_xor_b32 v19, 96, v16
    v_xor_b32 v115, 96, v112
    v_mfma_f32_16x16x32_bf16 v[140:143], v[32:35], v[84:87], v[140:143]
    ds_read_b64_tr_b16 v[28:29], v5 offset:12416
    v_mfma_f32_16x16x32_bf16 v[140:143], v[36:39], v[100:103], v[140:143]
    ds_read_b64_tr_b16 v[30:31], v5 offset:18560
    v_mfma_f32_16x16x32_bf16 v[132:135], v[36:39], v[96:99], v[132:135]
    ds_read_b64 v[48:49], v16 offset:0
    v_mfma_f32_16x16x32_bf16 v[132:135], v[32:35], v[80:83], v[132:135]
    ds_read_b64 v[50:51], v17 offset:0
    s_waitcnt lgkmcnt(4)
    v_mfma_f32_16x16x32_bf16 v[144:147], v[24:27], v[80:83], v[144:147]
    ds_read_b64_tr_b16 v[32:33], v6 offset:128
    s_waitcnt lgkmcnt(3)
    v_mfma_f32_16x16x32_bf16 v[144:147], v[28:31], v[96:99], v[144:147]
    ds_read_b64_tr_b16 v[34:35], v6 offset:6272
    v_mfma_f32_16x16x32_bf16 v[152:155], v[28:31], v[100:103], v[152:155]
    ds_read_b64 v[52:53], v16 offset:2048
    v_mfma_f32_16x16x32_bf16 v[152:155], v[24:27], v[84:87], v[152:155]
    ds_read_b64 v[54:55], v17 offset:2048
    v_mfma_f32_16x16x32_bf16 v[192:195], v[24:27], v[88:91], v[192:195]
    ds_read_b64_tr_b16 v[36:37], v6 offset:12416
    v_mfma_f32_16x16x32_bf16 v[192:195], v[28:31], v[104:107], v[192:195]
    ds_read_b64_tr_b16 v[38:39], v6 offset:18560
    v_mfma_f32_16x16x32_bf16 v[200:203], v[28:31], v[108:111], v[200:203]
    ds_read_b64 v[56:57], v112 offset:0
    v_mfma_f32_16x16x32_bf16 v[200:203], v[24:27], v[92:95], v[200:203]
    ds_read_b64 v[58:59], v113 offset:0
    s_waitcnt lgkmcnt(6)
    v_mfma_f32_16x16x32_bf16 v[204:207], v[32:35], v[92:95], v[204:207]
    ds_read_b64_tr_b16 v[24:25], v5 offset:256
    s_waitcnt lgkmcnt(3)
    v_mfma_f32_16x16x32_bf16 v[204:207], v[36:39], v[108:111], v[204:207]
    ds_read_b64_tr_b16 v[26:27], v5 offset:6400
    v_mfma_f32_16x16x32_bf16 v[196:199], v[36:39], v[104:107], v[196:199]
    ds_read_b64 v[60:61], v112 offset:2048
    v_mfma_f32_16x16x32_bf16 v[196:199], v[32:35], v[88:91], v[196:199]
    ds_read_b64 v[62:63], v113 offset:2048
    v_mfma_f32_16x16x32_bf16 v[156:159], v[32:35], v[84:87], v[156:159]
    ds_read_b64_tr_b16 v[28:29], v5 offset:12544
    v_mfma_f32_16x16x32_bf16 v[156:159], v[36:39], v[100:103], v[156:159]
    ds_read_b64_tr_b16 v[30:31], v5 offset:18688
    v_mfma_f32_16x16x32_bf16 v[148:151], v[36:39], v[96:99], v[148:151]
    ds_read_b64 v[64:65], v18 offset:0
    v_mfma_f32_16x16x32_bf16 v[148:151], v[32:35], v[80:83], v[148:151]
    ds_read_b64 v[66:67], v19 offset:0
    s_waitcnt lgkmcnt(6)
    v_mfma_f32_16x16x32_bf16 v[160:163], v[24:27], v[80:83], v[160:163]
    ds_read_b64_tr_b16 v[32:33], v6 offset:256
    s_waitcnt lgkmcnt(3)
    v_mfma_f32_16x16x32_bf16 v[160:163], v[28:31], v[96:99], v[160:163]
    ds_read_b64_tr_b16 v[34:35], v6 offset:6400
    v_mfma_f32_16x16x32_bf16 v[168:171], v[28:31], v[100:103], v[168:171]
    ds_read_b64 v[68:69], v18 offset:2048
    v_mfma_f32_16x16x32_bf16 v[168:171], v[24:27], v[84:87], v[168:171]
    ds_read_b64 v[70:71], v19 offset:2048
    v_mfma_f32_16x16x32_bf16 v[208:211], v[24:27], v[88:91], v[208:211]
    ds_read_b64_tr_b16 v[36:37], v6 offset:12544
    v_mfma_f32_16x16x32_bf16 v[208:211], v[28:31], v[104:107], v[208:211]
    ds_read_b64_tr_b16 v[38:39], v6 offset:18688
    v_mfma_f32_16x16x32_bf16 v[216:219], v[28:31], v[108:111], v[216:219]
    ds_read_b64 v[72:73], v114 offset:0
    v_mfma_f32_16x16x32_bf16 v[216:219], v[24:27], v[92:95], v[216:219]
    ds_read_b64 v[74:75], v115 offset:0
    s_waitcnt lgkmcnt(6)
    v_mfma_f32_16x16x32_bf16 v[220:223], v[32:35], v[92:95], v[220:223]
    v_add_u32 v5, 0, v116
    v_xor_b32 v6, 32, v5
    ds_read_b64_tr_b16 v[24:25], v5 offset:0
    s_waitcnt lgkmcnt(3)
    v_mfma_f32_16x16x32_bf16 v[220:223], v[36:39], v[108:111], v[220:223]
    ds_read_b64_tr_b16 v[26:27], v5 offset:6144
    v_mfma_f32_16x16x32_bf16 v[212:215], v[36:39], v[104:107], v[212:215]
    ds_read_b64 v[76:77], v114 offset:2048
    v_mfma_f32_16x16x32_bf16 v[212:215], v[32:35], v[88:91], v[212:215]
    ds_read_b64 v[78:79], v115 offset:2048
    v_mfma_f32_16x16x32_bf16 v[172:175], v[32:35], v[84:87], v[172:175]
    ds_read_b64_tr_b16 v[28:29], v5 offset:12288
    v_mfma_f32_16x16x32_bf16 v[172:175], v[36:39], v[100:103], v[172:175]
    ds_read_b64_tr_b16 v[30:31], v5 offset:18432
    v_mfma_f32_16x16x32_bf16 v[164:167], v[36:39], v[96:99], v[164:167]
    v_mfma_f32_16x16x32_bf16 v[164:167], v[32:35], v[80:83], v[164:167]
    s_waitcnt lgkmcnt(4)
    v_mfma_f32_16x16x32_bf16 v[128:131], v[24:27], v[48:51], v[128:131]
    ds_read_b64_tr_b16 v[32:33], v6 offset:0
    s_waitcnt lgkmcnt(1)
    v_mfma_f32_16x16x32_bf16 v[128:131], v[28:31], v[64:67], v[128:131]
    ds_read_b64_tr_b16 v[34:35], v6 offset:6144
    v_mfma_f32_16x16x32_bf16 v[136:139], v[28:31], v[68:71], v[136:139]
    v_mfma_f32_16x16x32_bf16 v[136:139], v[24:27], v[52:55], v[136:139]
    v_mfma_f32_16x16x32_bf16 v[176:179], v[24:27], v[56:59], v[176:179]
    ds_read_b64_tr_b16 v[36:37], v6 offset:12288
    v_mfma_f32_16x16x32_bf16 v[176:179], v[28:31], v[72:75], v[176:179]
    ds_read_b64_tr_b16 v[38:39], v6 offset:18432
    v_mfma_f32_16x16x32_bf16 v[184:187], v[28:31], v[76:79], v[184:187]
    v_add_u32 v16, 131072, v14
    v_xor_b32 v112, 4096, v16
    v_mfma_f32_16x16x32_bf16 v[184:187], v[24:27], v[60:63], v[184:187]
    v_xor_b32 v17, 32, v16
    v_xor_b32 v113, 32, v112
    s_waitcnt lgkmcnt(2)
    v_mfma_f32_16x16x32_bf16 v[188:191], v[32:35], v[60:63], v[188:191]
    ds_read_b64_tr_b16 v[24:25], v5 offset:128
    s_waitcnt lgkmcnt(1)
    v_mfma_f32_16x16x32_bf16 v[188:191], v[36:39], v[76:79], v[188:191]
    ds_read_b64_tr_b16 v[26:27], v5 offset:6272
    v_mfma_f32_16x16x32_bf16 v[180:183], v[36:39], v[72:75], v[180:183]
    v_xor_b32 v18, 64, v16
    v_xor_b32 v114, 64, v112
    v_mfma_f32_16x16x32_bf16 v[180:183], v[32:35], v[56:59], v[180:183]
    s_barrier
    v_xor_b32 v19, 96, v16
    v_xor_b32 v115, 96, v112
    v_mfma_f32_16x16x32_bf16 v[140:143], v[32:35], v[52:55], v[140:143]
    ds_read_b64_tr_b16 v[28:29], v5 offset:12416
    v_mfma_f32_16x16x32_bf16 v[140:143], v[36:39], v[68:71], v[140:143]
    ds_read_b64_tr_b16 v[30:31], v5 offset:18560
    v_mfma_f32_16x16x32_bf16 v[132:135], v[36:39], v[64:67], v[132:135]
    ds_read_b64 v[80:81], v16 offset:0
    v_mfma_f32_16x16x32_bf16 v[132:135], v[32:35], v[48:51], v[132:135]
    ds_read_b64 v[82:83], v17 offset:0
    s_waitcnt lgkmcnt(4)
    v_mfma_f32_16x16x32_bf16 v[144:147], v[24:27], v[48:51], v[144:147]
    ds_read_b64_tr_b16 v[32:33], v6 offset:128
    s_waitcnt lgkmcnt(3)
    v_mfma_f32_16x16x32_bf16 v[144:147], v[28:31], v[64:67], v[144:147]
    ds_read_b64_tr_b16 v[34:35], v6 offset:6272
    v_mfma_f32_16x16x32_bf16 v[152:155], v[28:31], v[68:71], v[152:155]
    ds_read_b64 v[84:85], v16 offset:2048
    v_mfma_f32_16x16x32_bf16 v[152:155], v[24:27], v[52:55], v[152:155]
    ds_read_b64 v[86:87], v17 offset:2048
    v_mfma_f32_16x16x32_bf16 v[192:195], v[24:27], v[56:59], v[192:195]
    ds_read_b64_tr_b16 v[36:37], v6 offset:12416
    v_mfma_f32_16x16x32_bf16 v[192:195], v[28:31], v[72:75], v[192:195]
    ds_read_b64_tr_b16 v[38:39], v6 offset:18560
    v_mfma_f32_16x16x32_bf16 v[200:203], v[28:31], v[76:79], v[200:203]
    ds_read_b64 v[88:89], v112 offset:0
    v_mfma_f32_16x16x32_bf16 v[200:203], v[24:27], v[60:63], v[200:203]
    ds_read_b64 v[90:91], v113 offset:0
    s_waitcnt lgkmcnt(6)
    v_mfma_f32_16x16x32_bf16 v[204:207], v[32:35], v[60:63], v[204:207]
    ds_read_b64_tr_b16 v[24:25], v5 offset:256
    s_waitcnt lgkmcnt(3)
    v_mfma_f32_16x16x32_bf16 v[204:207], v[36:39], v[76:79], v[204:207]
    ds_read_b64_tr_b16 v[26:27], v5 offset:6400
    v_mfma_f32_16x16x32_bf16 v[196:199], v[36:39], v[72:75], v[196:199]
    ds_read_b64 v[92:93], v112 offset:2048
    v_mfma_f32_16x16x32_bf16 v[196:199], v[32:35], v[56:59], v[196:199]
    ds_read_b64 v[94:95], v113 offset:2048
    v_mfma_f32_16x16x32_bf16 v[156:159], v[32:35], v[52:55], v[156:159]
    ds_read_b64_tr_b16 v[28:29], v5 offset:12544
    v_mfma_f32_16x16x32_bf16 v[156:159], v[36:39], v[68:71], v[156:159]
    ds_read_b64_tr_b16 v[30:31], v5 offset:18688
    v_mfma_f32_16x16x32_bf16 v[148:151], v[36:39], v[64:67], v[148:151]
    ds_read_b64 v[96:97], v18 offset:0
    v_mfma_f32_16x16x32_bf16 v[148:151], v[32:35], v[48:51], v[148:151]
    ds_read_b64 v[98:99], v19 offset:0
    s_waitcnt lgkmcnt(6)
    v_mfma_f32_16x16x32_bf16 v[160:163], v[24:27], v[48:51], v[160:163]
    ds_read_b64_tr_b16 v[32:33], v6 offset:256
    s_waitcnt lgkmcnt(3)
    v_mfma_f32_16x16x32_bf16 v[160:163], v[28:31], v[64:67], v[160:163]
    ds_read_b64_tr_b16 v[34:35], v6 offset:6400
    v_mfma_f32_16x16x32_bf16 v[168:171], v[28:31], v[68:71], v[168:171]
    ds_read_b64 v[100:101], v18 offset:2048
    v_mfma_f32_16x16x32_bf16 v[168:171], v[24:27], v[52:55], v[168:171]
    ds_read_b64 v[102:103], v19 offset:2048
    v_mfma_f32_16x16x32_bf16 v[208:211], v[24:27], v[56:59], v[208:211]
    ds_read_b64_tr_b16 v[36:37], v6 offset:12544
    v_mfma_f32_16x16x32_bf16 v[208:211], v[28:31], v[72:75], v[208:211]
    ds_read_b64_tr_b16 v[38:39], v6 offset:18688
    v_mfma_f32_16x16x32_bf16 v[216:219], v[28:31], v[76:79], v[216:219]
    ds_read_b64 v[104:105], v114 offset:0
    v_mfma_f32_16x16x32_bf16 v[216:219], v[24:27], v[60:63], v[216:219]
    ds_read_b64 v[106:107], v115 offset:0
    s_waitcnt lgkmcnt(6)
    v_mfma_f32_16x16x32_bf16 v[220:223], v[32:35], v[60:63], v[220:223]
    v_add_u32 v5, 24576, v116
    v_xor_b32 v6, 32, v5
    ds_read_b64_tr_b16 v[24:25], v5 offset:0
    s_waitcnt lgkmcnt(3)
    v_mfma_f32_16x16x32_bf16 v[220:223], v[36:39], v[76:79], v[220:223]
    ds_read_b64_tr_b16 v[26:27], v5 offset:6144
    v_mfma_f32_16x16x32_bf16 v[212:215], v[36:39], v[72:75], v[212:215]
    ds_read_b64 v[108:109], v114 offset:2048
    v_mfma_f32_16x16x32_bf16 v[212:215], v[32:35], v[56:59], v[212:215]
    ds_read_b64 v[110:111], v115 offset:2048
    v_mfma_f32_16x16x32_bf16 v[172:175], v[32:35], v[52:55], v[172:175]
    ds_read_b64_tr_b16 v[28:29], v5 offset:12288
    v_mfma_f32_16x16x32_bf16 v[172:175], v[36:39], v[68:71], v[172:175]
    ds_read_b64_tr_b16 v[30:31], v5 offset:18432
    v_mfma_f32_16x16x32_bf16 v[164:167], v[36:39], v[64:67], v[164:167]
    v_mfma_f32_16x16x32_bf16 v[164:167], v[32:35], v[48:51], v[164:167]
    s_waitcnt lgkmcnt(4)
    v_mfma_f32_16x16x32_bf16 v[128:131], v[24:27], v[80:83], v[128:131]
    ds_read_b64_tr_b16 v[32:33], v6 offset:0
    s_waitcnt lgkmcnt(1)
    v_mfma_f32_16x16x32_bf16 v[128:131], v[28:31], v[96:99], v[128:131]
    ds_read_b64_tr_b16 v[34:35], v6 offset:6144
    v_mfma_f32_16x16x32_bf16 v[136:139], v[28:31], v[100:103], v[136:139]
    v_mfma_f32_16x16x32_bf16 v[136:139], v[24:27], v[84:87], v[136:139]
    v_mfma_f32_16x16x32_bf16 v[176:179], v[24:27], v[88:91], v[176:179]
    ds_read_b64_tr_b16 v[36:37], v6 offset:12288
    v_mfma_f32_16x16x32_bf16 v[176:179], v[28:31], v[104:107], v[176:179]
    ds_read_b64_tr_b16 v[38:39], v6 offset:18432
    v_mfma_f32_16x16x32_bf16 v[184:187], v[28:31], v[108:111], v[184:187]
    v_add_u32 v16, 114688, v14
    v_xor_b32 v112, 4096, v16
    v_mfma_f32_16x16x32_bf16 v[184:187], v[24:27], v[92:95], v[184:187]
    v_xor_b32 v17, 32, v16
    v_xor_b32 v113, 32, v112
    s_waitcnt lgkmcnt(2)
    v_mfma_f32_16x16x32_bf16 v[188:191], v[32:35], v[92:95], v[188:191]
    ds_read_b64_tr_b16 v[24:25], v5 offset:128
    s_waitcnt lgkmcnt(1)
    v_mfma_f32_16x16x32_bf16 v[188:191], v[36:39], v[108:111], v[188:191]
    ds_read_b64_tr_b16 v[26:27], v5 offset:6272
    v_mfma_f32_16x16x32_bf16 v[180:183], v[36:39], v[104:107], v[180:183]
    v_xor_b32 v18, 64, v16
    v_xor_b32 v114, 64, v112
    v_mfma_f32_16x16x32_bf16 v[180:183], v[32:35], v[88:91], v[180:183]
    s_barrier
    v_xor_b32 v19, 96, v16
    v_xor_b32 v115, 96, v112
    v_mfma_f32_16x16x32_bf16 v[140:143], v[32:35], v[84:87], v[140:143]
    ds_read_b64_tr_b16 v[28:29], v5 offset:12416
    v_mfma_f32_16x16x32_bf16 v[140:143], v[36:39], v[100:103], v[140:143]
    ds_read_b64_tr_b16 v[30:31], v5 offset:18560
    v_mfma_f32_16x16x32_bf16 v[132:135], v[36:39], v[96:99], v[132:135]
    ds_read_b64 v[48:49], v16 offset:0
    v_mfma_f32_16x16x32_bf16 v[132:135], v[32:35], v[80:83], v[132:135]
    ds_read_b64 v[50:51], v17 offset:0
    s_waitcnt lgkmcnt(4)
    v_mfma_f32_16x16x32_bf16 v[144:147], v[24:27], v[80:83], v[144:147]
    ds_read_b64_tr_b16 v[32:33], v6 offset:128
    s_waitcnt lgkmcnt(3)
    v_mfma_f32_16x16x32_bf16 v[144:147], v[28:31], v[96:99], v[144:147]
    ds_read_b64_tr_b16 v[34:35], v6 offset:6272
    v_mfma_f32_16x16x32_bf16 v[152:155], v[28:31], v[100:103], v[152:155]
    ds_read_b64 v[52:53], v16 offset:2048
    v_mfma_f32_16x16x32_bf16 v[152:155], v[24:27], v[84:87], v[152:155]
    ds_read_b64 v[54:55], v17 offset:2048
    v_mfma_f32_16x16x32_bf16 v[192:195], v[24:27], v[88:91], v[192:195]
    ds_read_b64_tr_b16 v[36:37], v6 offset:12416
    v_mfma_f32_16x16x32_bf16 v[192:195], v[28:31], v[104:107], v[192:195]
    ds_read_b64_tr_b16 v[38:39], v6 offset:18560
    v_mfma_f32_16x16x32_bf16 v[200:203], v[28:31], v[108:111], v[200:203]
    ds_read_b64 v[56:57], v112 offset:0
    v_mfma_f32_16x16x32_bf16 v[200:203], v[24:27], v[92:95], v[200:203]
    ds_read_b64 v[58:59], v113 offset:0
    s_waitcnt lgkmcnt(6)
    v_mfma_f32_16x16x32_bf16 v[204:207], v[32:35], v[92:95], v[204:207]
    ds_read_b64_tr_b16 v[24:25], v5 offset:256
    s_waitcnt lgkmcnt(3)
    v_mfma_f32_16x16x32_bf16 v[204:207], v[36:39], v[108:111], v[204:207]
    ds_read_b64_tr_b16 v[26:27], v5 offset:6400
    v_mfma_f32_16x16x32_bf16 v[196:199], v[36:39], v[104:107], v[196:199]
    ds_read_b64 v[60:61], v112 offset:2048
    v_mfma_f32_16x16x32_bf16 v[196:199], v[32:35], v[88:91], v[196:199]
    ds_read_b64 v[62:63], v113 offset:2048
    v_mfma_f32_16x16x32_bf16 v[156:159], v[32:35], v[84:87], v[156:159]
    ds_read_b64_tr_b16 v[28:29], v5 offset:12544
    v_mfma_f32_16x16x32_bf16 v[156:159], v[36:39], v[100:103], v[156:159]
    ds_read_b64_tr_b16 v[30:31], v5 offset:18688
    v_mfma_f32_16x16x32_bf16 v[148:151], v[36:39], v[96:99], v[148:151]
    ds_read_b64 v[64:65], v18 offset:0
    v_mfma_f32_16x16x32_bf16 v[148:151], v[32:35], v[80:83], v[148:151]
    ds_read_b64 v[66:67], v19 offset:0
    s_waitcnt lgkmcnt(6)
    v_mfma_f32_16x16x32_bf16 v[160:163], v[24:27], v[80:83], v[160:163]
    ds_read_b64_tr_b16 v[32:33], v6 offset:256
    s_waitcnt lgkmcnt(3)
    v_mfma_f32_16x16x32_bf16 v[160:163], v[28:31], v[96:99], v[160:163]
    ds_read_b64_tr_b16 v[34:35], v6 offset:6400
    v_mfma_f32_16x16x32_bf16 v[168:171], v[28:31], v[100:103], v[168:171]
    ds_read_b64 v[68:69], v18 offset:2048
    v_mfma_f32_16x16x32_bf16 v[168:171], v[24:27], v[84:87], v[168:171]
    ds_read_b64 v[70:71], v19 offset:2048
    v_mfma_f32_16x16x32_bf16 v[208:211], v[24:27], v[88:91], v[208:211]
    ds_read_b64_tr_b16 v[36:37], v6 offset:12544
    v_mfma_f32_16x16x32_bf16 v[208:211], v[28:31], v[104:107], v[208:211]
    ds_read_b64_tr_b16 v[38:39], v6 offset:18688
    v_mfma_f32_16x16x32_bf16 v[216:219], v[28:31], v[108:111], v[216:219]
    ds_read_b64 v[72:73], v114 offset:0
    v_mfma_f32_16x16x32_bf16 v[216:219], v[24:27], v[92:95], v[216:219]
    ds_read_b64 v[74:75], v115 offset:0
    s_waitcnt lgkmcnt(6)
    v_mfma_f32_16x16x32_bf16 v[220:223], v[32:35], v[92:95], v[220:223]
    v_add_u32 v5, 49152, v116
    v_xor_b32 v6, 32, v5
    ds_read_b64_tr_b16 v[24:25], v5 offset:0
    s_waitcnt lgkmcnt(3)
    v_mfma_f32_16x16x32_bf16 v[220:223], v[36:39], v[108:111], v[220:223]
    ds_read_b64_tr_b16 v[26:27], v5 offset:6144
    v_mfma_f32_16x16x32_bf16 v[212:215], v[36:39], v[104:107], v[212:215]
    ds_read_b64 v[76:77], v114 offset:2048
    v_mfma_f32_16x16x32_bf16 v[212:215], v[32:35], v[88:91], v[212:215]
    ds_read_b64 v[78:79], v115 offset:2048
    v_mfma_f32_16x16x32_bf16 v[172:175], v[32:35], v[84:87], v[172:175]
    ds_read_b64_tr_b16 v[28:29], v5 offset:12288
    v_mfma_f32_16x16x32_bf16 v[172:175], v[36:39], v[100:103], v[172:175]
    ds_read_b64_tr_b16 v[30:31], v5 offset:18432
    v_mfma_f32_16x16x32_bf16 v[164:167], v[36:39], v[96:99], v[164:167]
    v_mfma_f32_16x16x32_bf16 v[164:167], v[32:35], v[80:83], v[164:167]
    s_waitcnt lgkmcnt(4)
    v_mfma_f32_16x16x32_bf16 v[128:131], v[24:27], v[48:51], v[128:131]
    ds_read_b64_tr_b16 v[32:33], v6 offset:0
    s_waitcnt lgkmcnt(1)
    v_mfma_f32_16x16x32_bf16 v[128:131], v[28:31], v[64:67], v[128:131]
    ds_read_b64_tr_b16 v[34:35], v6 offset:6144
    v_mfma_f32_16x16x32_bf16 v[136:139], v[28:31], v[68:71], v[136:139]
    v_mfma_f32_16x16x32_bf16 v[136:139], v[24:27], v[52:55], v[136:139]
    v_mfma_f32_16x16x32_bf16 v[176:179], v[24:27], v[56:59], v[176:179]
    ds_read_b64_tr_b16 v[36:37], v6 offset:12288
    v_mfma_f32_16x16x32_bf16 v[176:179], v[28:31], v[72:75], v[176:179]
    ds_read_b64_tr_b16 v[38:39], v6 offset:18432
    v_mfma_f32_16x16x32_bf16 v[184:187], v[28:31], v[76:79], v[184:187]
    v_add_u32 v16, 147456, v14
    v_xor_b32 v112, 4096, v16
    v_mfma_f32_16x16x32_bf16 v[184:187], v[24:27], v[60:63], v[184:187]
    v_xor_b32 v17, 32, v16
    v_xor_b32 v113, 32, v112
    s_waitcnt lgkmcnt(2)
    v_mfma_f32_16x16x32_bf16 v[188:191], v[32:35], v[60:63], v[188:191]
    ds_read_b64_tr_b16 v[24:25], v5 offset:128
    s_waitcnt lgkmcnt(1)
    v_mfma_f32_16x16x32_bf16 v[188:191], v[36:39], v[76:79], v[188:191]
    ds_read_b64_tr_b16 v[26:27], v5 offset:6272
    v_mfma_f32_16x16x32_bf16 v[180:183], v[36:39], v[72:75], v[180:183]
    v_xor_b32 v18, 64, v16
    v_xor_b32 v114, 64, v112
    v_mfma_f32_16x16x32_bf16 v[180:183], v[32:35], v[56:59], v[180:183]
    s_barrier
    v_xor_b32 v19, 96, v16
    v_xor_b32 v115, 96, v112
    v_mfma_f32_16x16x32_bf16 v[140:143], v[32:35], v[52:55], v[140:143]
    ds_read_b64_tr_b16 v[28:29], v5 offset:12416
    v_mfma_f32_16x16x32_bf16 v[140:143], v[36:39], v[68:71], v[140:143]
    ds_read_b64_tr_b16 v[30:31], v5 offset:18560
    v_mfma_f32_16x16x32_bf16 v[132:135], v[36:39], v[64:67], v[132:135]
    ds_read_b64 v[80:81], v16 offset:0
    v_mfma_f32_16x16x32_bf16 v[132:135], v[32:35], v[48:51], v[132:135]
    ds_read_b64 v[82:83], v17 offset:0
    s_waitcnt lgkmcnt(4)
    v_mfma_f32_16x16x32_bf16 v[144:147], v[24:27], v[48:51], v[144:147]
    ds_read_b64_tr_b16 v[32:33], v6 offset:128
    s_waitcnt lgkmcnt(3)
    v_mfma_f32_16x16x32_bf16 v[144:147], v[28:31], v[64:67], v[144:147]
    ds_read_b64_tr_b16 v[34:35], v6 offset:6272
    v_mfma_f32_16x16x32_bf16 v[152:155], v[28:31], v[68:71], v[152:155]
    ds_read_b64 v[84:85], v16 offset:2048
    v_mfma_f32_16x16x32_bf16 v[152:155], v[24:27], v[52:55], v[152:155]
    ds_read_b64 v[86:87], v17 offset:2048
    v_mfma_f32_16x16x32_bf16 v[192:195], v[24:27], v[56:59], v[192:195]
    ds_read_b64_tr_b16 v[36:37], v6 offset:12416
    v_mfma_f32_16x16x32_bf16 v[192:195], v[28:31], v[72:75], v[192:195]
    ds_read_b64_tr_b16 v[38:39], v6 offset:18560
    v_mfma_f32_16x16x32_bf16 v[200:203], v[28:31], v[76:79], v[200:203]
    ds_read_b64 v[88:89], v112 offset:0
    v_mfma_f32_16x16x32_bf16 v[200:203], v[24:27], v[60:63], v[200:203]
    ds_read_b64 v[90:91], v113 offset:0
    s_waitcnt lgkmcnt(6)
    v_mfma_f32_16x16x32_bf16 v[204:207], v[32:35], v[60:63], v[204:207]
    ds_read_b64_tr_b16 v[24:25], v5 offset:256
    s_waitcnt lgkmcnt(3)
    v_mfma_f32_16x16x32_bf16 v[204:207], v[36:39], v[76:79], v[204:207]
    ds_read_b64_tr_b16 v[26:27], v5 offset:6400
    v_mfma_f32_16x16x32_bf16 v[196:199], v[36:39], v[72:75], v[196:199]
    ds_read_b64 v[92:93], v112 offset:2048
    v_mfma_f32_16x16x32_bf16 v[196:199], v[32:35], v[56:59], v[196:199]
    ds_read_b64 v[94:95], v113 offset:2048
    v_mfma_f32_16x16x32_bf16 v[156:159], v[32:35], v[52:55], v[156:159]
    ds_read_b64_tr_b16 v[28:29], v5 offset:12544
    v_mfma_f32_16x16x32_bf16 v[156:159], v[36:39], v[68:71], v[156:159]
    ds_read_b64_tr_b16 v[30:31], v5 offset:18688
    v_mfma_f32_16x16x32_bf16 v[148:151], v[36:39], v[64:67], v[148:151]
    ds_read_b64 v[96:97], v18 offset:0
    v_mfma_f32_16x16x32_bf16 v[148:151], v[32:35], v[48:51], v[148:151]
    ds_read_b64 v[98:99], v19 offset:0
    s_waitcnt lgkmcnt(6)
    v_mfma_f32_16x16x32_bf16 v[160:163], v[24:27], v[48:51], v[160:163]
    ds_read_b64_tr_b16 v[32:33], v6 offset:256
    s_waitcnt lgkmcnt(3)
    v_mfma_f32_16x16x32_bf16 v[160:163], v[28:31], v[64:67], v[160:163]
    ds_read_b64_tr_b16 v[34:35], v6 offset:6400
    v_mfma_f32_16x16x32_bf16 v[168:171], v[28:31], v[68:71], v[168:171]
    ds_read_b64 v[100:101], v18 offset:2048
    v_mfma_f32_16x16x32_bf16 v[168:171], v[24:27], v[52:55], v[168:171]
    ds_read_b64 v[102:103], v19 offset:2048
    v_mfma_f32_16x16x32_bf16 v[208:211], v[24:27], v[56:59], v[208:211]
    ds_read_b64_tr_b16 v[36:37], v6 offset:12544
    v_mfma_f32_16x16x32_bf16 v[208:211], v[28:31], v[72:75], v[208:211]
    ds_read_b64_tr_b16 v[38:39], v6 offset:18688
    v_mfma_f32_16x16x32_bf16 v[216:219], v[28:31], v[76:79], v[216:219]
    ds_read_b64 v[104:105], v114 offset:0
    v_mfma_f32_16x16x32_bf16 v[216:219], v[24:27], v[60:63], v[216:219]
    ds_read_b64 v[106:107], v115 offset:0
    s_waitcnt lgkmcnt(6)
    v_mfma_f32_16x16x32_bf16 v[220:223], v[32:35], v[60:63], v[220:223]
    v_add_u32 v5, 73728, v116
    v_xor_b32 v6, 32, v5
    ds_read_b64_tr_b16 v[24:25], v5 offset:0
    s_waitcnt lgkmcnt(3)
    v_mfma_f32_16x16x32_bf16 v[220:223], v[36:39], v[76:79], v[220:223]
    ds_read_b64_tr_b16 v[26:27], v5 offset:6144
    v_mfma_f32_16x16x32_bf16 v[212:215], v[36:39], v[72:75], v[212:215]
    ds_read_b64 v[108:109], v114 offset:2048
    v_mfma_f32_16x16x32_bf16 v[212:215], v[32:35], v[56:59], v[212:215]
    ds_read_b64 v[110:111], v115 offset:2048
    v_mfma_f32_16x16x32_bf16 v[172:175], v[32:35], v[52:55], v[172:175]
    ds_read_b64_tr_b16 v[28:29], v5 offset:12288
    v_mfma_f32_16x16x32_bf16 v[172:175], v[36:39], v[68:71], v[172:175]
    ds_read_b64_tr_b16 v[30:31], v5 offset:18432
    v_mfma_f32_16x16x32_bf16 v[164:167], v[36:39], v[64:67], v[164:167]
    v_mfma_f32_16x16x32_bf16 v[164:167], v[32:35], v[48:51], v[164:167]
    s_waitcnt lgkmcnt(4)
    v_mfma_f32_16x16x32_bf16 v[128:131], v[24:27], v[80:83], v[128:131]
    ds_read_b64_tr_b16 v[32:33], v6 offset:0
    s_waitcnt lgkmcnt(1)
    v_mfma_f32_16x16x32_bf16 v[128:131], v[28:31], v[96:99], v[128:131]
    ds_read_b64_tr_b16 v[34:35], v6 offset:6144
    v_mfma_f32_16x16x32_bf16 v[136:139], v[28:31], v[100:103], v[136:139]
    v_mfma_f32_16x16x32_bf16 v[136:139], v[24:27], v[84:87], v[136:139]
    v_mfma_f32_16x16x32_bf16 v[176:179], v[24:27], v[88:91], v[176:179]
    ds_read_b64_tr_b16 v[36:37], v6 offset:12288
    v_mfma_f32_16x16x32_bf16 v[176:179], v[28:31], v[104:107], v[176:179]
    ds_read_b64_tr_b16 v[38:39], v6 offset:18432
    v_mfma_f32_16x16x32_bf16 v[184:187], v[28:31], v[108:111], v[184:187]
    v_add_u32 v16, 131072, v14
    v_xor_b32 v112, 4096, v16
    v_mfma_f32_16x16x32_bf16 v[184:187], v[24:27], v[92:95], v[184:187]
    s_barrier
    v_xor_b32 v17, 32, v16
    v_xor_b32 v113, 32, v112
    s_waitcnt lgkmcnt(2)
    v_mfma_f32_16x16x32_bf16 v[188:191], v[32:35], v[92:95], v[188:191]
    ds_read_b64_tr_b16 v[24:25], v5 offset:128
    s_waitcnt lgkmcnt(1)
    v_mfma_f32_16x16x32_bf16 v[188:191], v[36:39], v[108:111], v[188:191]
    ds_read_b64_tr_b16 v[26:27], v5 offset:6272
    v_mfma_f32_16x16x32_bf16 v[180:183], v[36:39], v[104:107], v[180:183]
    v_xor_b32 v18, 64, v16
    v_xor_b32 v114, 64, v112
    v_mfma_f32_16x16x32_bf16 v[180:183], v[32:35], v[88:91], v[180:183]
    v_xor_b32 v19, 96, v16
    v_xor_b32 v115, 96, v112
    v_mfma_f32_16x16x32_bf16 v[140:143], v[32:35], v[84:87], v[140:143]
    ds_read_b64_tr_b16 v[28:29], v5 offset:12416
    v_mfma_f32_16x16x32_bf16 v[140:143], v[36:39], v[100:103], v[140:143]
    ds_read_b64_tr_b16 v[30:31], v5 offset:18560
    v_mfma_f32_16x16x32_bf16 v[132:135], v[36:39], v[96:99], v[132:135]
    ds_read_b64 v[48:49], v16 offset:0
    v_mfma_f32_16x16x32_bf16 v[132:135], v[32:35], v[80:83], v[132:135]
    ds_read_b64 v[50:51], v17 offset:0
    s_waitcnt lgkmcnt(4)
    v_mfma_f32_16x16x32_bf16 v[144:147], v[24:27], v[80:83], v[144:147]
    ds_read_b64_tr_b16 v[32:33], v6 offset:128
    s_waitcnt lgkmcnt(3)
    v_mfma_f32_16x16x32_bf16 v[144:147], v[28:31], v[96:99], v[144:147]
    ds_read_b64_tr_b16 v[34:35], v6 offset:6272
    v_mfma_f32_16x16x32_bf16 v[152:155], v[28:31], v[100:103], v[152:155]
    ds_read_b64 v[52:53], v16 offset:2048
    v_mfma_f32_16x16x32_bf16 v[152:155], v[24:27], v[84:87], v[152:155]
    ds_read_b64 v[54:55], v17 offset:2048
    v_mfma_f32_16x16x32_bf16 v[192:195], v[24:27], v[88:91], v[192:195]
    ds_read_b64_tr_b16 v[36:37], v6 offset:12416
    v_mfma_f32_16x16x32_bf16 v[192:195], v[28:31], v[104:107], v[192:195]
    ds_read_b64_tr_b16 v[38:39], v6 offset:18560
    v_mfma_f32_16x16x32_bf16 v[200:203], v[28:31], v[108:111], v[200:203]
    ds_read_b64 v[56:57], v112 offset:0
    v_mfma_f32_16x16x32_bf16 v[200:203], v[24:27], v[92:95], v[200:203]
    ds_read_b64 v[58:59], v113 offset:0
    s_waitcnt lgkmcnt(6)
    v_mfma_f32_16x16x32_bf16 v[204:207], v[32:35], v[92:95], v[204:207]
    ds_read_b64_tr_b16 v[24:25], v5 offset:256
    s_waitcnt lgkmcnt(3)
    v_mfma_f32_16x16x32_bf16 v[204:207], v[36:39], v[108:111], v[204:207]
    ds_read_b64_tr_b16 v[26:27], v5 offset:6400
    v_mfma_f32_16x16x32_bf16 v[196:199], v[36:39], v[104:107], v[196:199]
    ds_read_b64 v[60:61], v112 offset:2048
    v_mfma_f32_16x16x32_bf16 v[196:199], v[32:35], v[88:91], v[196:199]
    ds_read_b64 v[62:63], v113 offset:2048
    v_mfma_f32_16x16x32_bf16 v[156:159], v[32:35], v[84:87], v[156:159]
    ds_read_b64_tr_b16 v[28:29], v5 offset:12544
    v_mfma_f32_16x16x32_bf16 v[156:159], v[36:39], v[100:103], v[156:159]
    ds_read_b64_tr_b16 v[30:31], v5 offset:18688
    v_mfma_f32_16x16x32_bf16 v[148:151], v[36:39], v[96:99], v[148:151]
    ds_read_b64 v[64:65], v18 offset:0
    v_mfma_f32_16x16x32_bf16 v[148:151], v[32:35], v[80:83], v[148:151]
    ds_read_b64 v[66:67], v19 offset:0
    s_waitcnt lgkmcnt(6)
    v_mfma_f32_16x16x32_bf16 v[160:163], v[24:27], v[80:83], v[160:163]
    ds_read_b64_tr_b16 v[32:33], v6 offset:256
    s_waitcnt lgkmcnt(3)
    v_mfma_f32_16x16x32_bf16 v[160:163], v[28:31], v[96:99], v[160:163]
    ds_read_b64_tr_b16 v[34:35], v6 offset:6400
    v_mfma_f32_16x16x32_bf16 v[168:171], v[28:31], v[100:103], v[168:171]
    ds_read_b64 v[68:69], v18 offset:2048
    v_mfma_f32_16x16x32_bf16 v[168:171], v[24:27], v[84:87], v[168:171]
    ds_read_b64 v[70:71], v19 offset:2048
    v_mfma_f32_16x16x32_bf16 v[208:211], v[24:27], v[88:91], v[208:211]
    ds_read_b64_tr_b16 v[36:37], v6 offset:12544
    v_mfma_f32_16x16x32_bf16 v[208:211], v[28:31], v[104:107], v[208:211]
    ds_read_b64_tr_b16 v[38:39], v6 offset:18688
    v_mfma_f32_16x16x32_bf16 v[216:219], v[28:31], v[108:111], v[216:219]
    ds_read_b64 v[72:73], v114 offset:0
    v_mfma_f32_16x16x32_bf16 v[216:219], v[24:27], v[92:95], v[216:219]
    ds_read_b64 v[74:75], v115 offset:0
    s_waitcnt lgkmcnt(6)
    v_mfma_f32_16x16x32_bf16 v[220:223], v[32:35], v[92:95], v[220:223]
    v_add_u32 v5, 0, v116
    v_xor_b32 v6, 32, v5
    ds_read_b64_tr_b16 v[24:25], v5 offset:0
    s_waitcnt lgkmcnt(3)
    v_mfma_f32_16x16x32_bf16 v[220:223], v[36:39], v[108:111], v[220:223]
    ds_read_b64_tr_b16 v[26:27], v5 offset:6144
    v_mfma_f32_16x16x32_bf16 v[212:215], v[36:39], v[104:107], v[212:215]
    ds_read_b64 v[76:77], v114 offset:2048
    v_mfma_f32_16x16x32_bf16 v[212:215], v[32:35], v[88:91], v[212:215]
    ds_read_b64 v[78:79], v115 offset:2048
    v_mfma_f32_16x16x32_bf16 v[172:175], v[32:35], v[84:87], v[172:175]
    ds_read_b64_tr_b16 v[28:29], v5 offset:12288
    v_mfma_f32_16x16x32_bf16 v[172:175], v[36:39], v[100:103], v[172:175]
    ds_read_b64_tr_b16 v[30:31], v5 offset:18432
    v_mfma_f32_16x16x32_bf16 v[164:167], v[36:39], v[96:99], v[164:167]
    v_mfma_f32_16x16x32_bf16 v[164:167], v[32:35], v[80:83], v[164:167]
    s_waitcnt lgkmcnt(4)
    v_mfma_f32_16x16x32_bf16 v[128:131], v[24:27], v[48:51], v[128:131]
    ds_read_b64_tr_b16 v[32:33], v6 offset:0
    s_waitcnt lgkmcnt(1)
    v_mfma_f32_16x16x32_bf16 v[128:131], v[28:31], v[64:67], v[128:131]
    ds_read_b64_tr_b16 v[34:35], v6 offset:6144
    v_mfma_f32_16x16x32_bf16 v[136:139], v[28:31], v[68:71], v[136:139]
    v_mfma_f32_16x16x32_bf16 v[136:139], v[24:27], v[52:55], v[136:139]
    s_barrier
    v_mfma_f32_16x16x32_bf16 v[176:179], v[24:27], v[56:59], v[176:179]
    ds_read_b64_tr_b16 v[36:37], v6 offset:12288
    v_mfma_f32_16x16x32_bf16 v[176:179], v[28:31], v[72:75], v[176:179]
    ds_read_b64_tr_b16 v[38:39], v6 offset:18432
    v_mfma_f32_16x16x32_bf16 v[184:187], v[28:31], v[76:79], v[184:187]
    v_add_u32 v16, 114688, v14
    v_xor_b32 v112, 4096, v16
    v_mfma_f32_16x16x32_bf16 v[184:187], v[24:27], v[60:63], v[184:187]
    v_xor_b32 v17, 32, v16
    v_xor_b32 v113, 32, v112
    s_waitcnt lgkmcnt(2)
    v_mfma_f32_16x16x32_bf16 v[188:191], v[32:35], v[60:63], v[188:191]
    ds_read_b64_tr_b16 v[24:25], v5 offset:128
    s_waitcnt lgkmcnt(1)
    v_mfma_f32_16x16x32_bf16 v[188:191], v[36:39], v[76:79], v[188:191]
    ds_read_b64_tr_b16 v[26:27], v5 offset:6272
    v_mfma_f32_16x16x32_bf16 v[180:183], v[36:39], v[72:75], v[180:183]
    v_xor_b32 v18, 64, v16
    v_xor_b32 v114, 64, v112
    v_mfma_f32_16x16x32_bf16 v[180:183], v[32:35], v[56:59], v[180:183]
    v_xor_b32 v19, 96, v16
    v_xor_b32 v115, 96, v112
    v_mfma_f32_16x16x32_bf16 v[140:143], v[32:35], v[52:55], v[140:143]
    ds_read_b64_tr_b16 v[28:29], v5 offset:12416
    v_mfma_f32_16x16x32_bf16 v[140:143], v[36:39], v[68:71], v[140:143]
    ds_read_b64_tr_b16 v[30:31], v5 offset:18560
    v_mfma_f32_16x16x32_bf16 v[132:135], v[36:39], v[64:67], v[132:135]
    ds_read_b64 v[80:81], v16 offset:0
    v_mfma_f32_16x16x32_bf16 v[132:135], v[32:35], v[48:51], v[132:135]
    ds_read_b64 v[82:83], v17 offset:0
    s_waitcnt lgkmcnt(4)
    v_mfma_f32_16x16x32_bf16 v[144:147], v[24:27], v[48:51], v[144:147]
    ds_read_b64_tr_b16 v[32:33], v6 offset:128
    s_waitcnt lgkmcnt(3)
    v_mfma_f32_16x16x32_bf16 v[144:147], v[28:31], v[64:67], v[144:147]
    ds_read_b64_tr_b16 v[34:35], v6 offset:6272
    v_mfma_f32_16x16x32_bf16 v[152:155], v[28:31], v[68:71], v[152:155]
    ds_read_b64 v[84:85], v16 offset:2048
    v_mfma_f32_16x16x32_bf16 v[152:155], v[24:27], v[52:55], v[152:155]
    ds_read_b64 v[86:87], v17 offset:2048
    v_mfma_f32_16x16x32_bf16 v[192:195], v[24:27], v[56:59], v[192:195]
    ds_read_b64_tr_b16 v[36:37], v6 offset:12416
    v_mfma_f32_16x16x32_bf16 v[192:195], v[28:31], v[72:75], v[192:195]
    ds_read_b64_tr_b16 v[38:39], v6 offset:18560
    v_mfma_f32_16x16x32_bf16 v[200:203], v[28:31], v[76:79], v[200:203]
    ds_read_b64 v[88:89], v112 offset:0
    v_mfma_f32_16x16x32_bf16 v[200:203], v[24:27], v[60:63], v[200:203]
    ds_read_b64 v[90:91], v113 offset:0
    s_waitcnt lgkmcnt(6)
    v_mfma_f32_16x16x32_bf16 v[204:207], v[32:35], v[60:63], v[204:207]
    ds_read_b64_tr_b16 v[24:25], v5 offset:256
    s_waitcnt lgkmcnt(3)
    v_mfma_f32_16x16x32_bf16 v[204:207], v[36:39], v[76:79], v[204:207]
    ds_read_b64_tr_b16 v[26:27], v5 offset:6400
    v_mfma_f32_16x16x32_bf16 v[196:199], v[36:39], v[72:75], v[196:199]
    ds_read_b64 v[92:93], v112 offset:2048
    v_mfma_f32_16x16x32_bf16 v[196:199], v[32:35], v[56:59], v[196:199]
    ds_read_b64 v[94:95], v113 offset:2048
    v_mfma_f32_16x16x32_bf16 v[156:159], v[32:35], v[52:55], v[156:159]
    ds_read_b64_tr_b16 v[28:29], v5 offset:12544
    v_mfma_f32_16x16x32_bf16 v[156:159], v[36:39], v[68:71], v[156:159]
    ds_read_b64_tr_b16 v[30:31], v5 offset:18688
    v_mfma_f32_16x16x32_bf16 v[148:151], v[36:39], v[64:67], v[148:151]
    ds_read_b64 v[96:97], v18 offset:0
    v_mfma_f32_16x16x32_bf16 v[148:151], v[32:35], v[48:51], v[148:151]
    ds_read_b64 v[98:99], v19 offset:0
    s_waitcnt lgkmcnt(6)
    v_mfma_f32_16x16x32_bf16 v[160:163], v[24:27], v[48:51], v[160:163]
    ds_read_b64_tr_b16 v[32:33], v6 offset:256
    s_waitcnt lgkmcnt(3)
    v_mfma_f32_16x16x32_bf16 v[160:163], v[28:31], v[64:67], v[160:163]
    ds_read_b64_tr_b16 v[34:35], v6 offset:6400
    v_mfma_f32_16x16x32_bf16 v[168:171], v[28:31], v[68:71], v[168:171]
    ds_read_b64 v[100:101], v18 offset:2048
    v_mfma_f32_16x16x32_bf16 v[168:171], v[24:27], v[52:55], v[168:171]
    ds_read_b64 v[102:103], v19 offset:2048
    v_mfma_f32_16x16x32_bf16 v[208:211], v[24:27], v[56:59], v[208:211]
    ds_read_b64_tr_b16 v[36:37], v6 offset:12544
    v_mfma_f32_16x16x32_bf16 v[208:211], v[28:31], v[72:75], v[208:211]
    ds_read_b64_tr_b16 v[38:39], v6 offset:18688
    v_mfma_f32_16x16x32_bf16 v[216:219], v[28:31], v[76:79], v[216:219]
    ds_read_b64 v[104:105], v114 offset:0
    v_mfma_f32_16x16x32_bf16 v[216:219], v[24:27], v[60:63], v[216:219]
    ds_read_b64 v[106:107], v115 offset:0
    s_waitcnt lgkmcnt(6)
    v_mfma_f32_16x16x32_bf16 v[220:223], v[32:35], v[60:63], v[220:223]
    v_add_u32 v5, 24576, v116
    v_xor_b32 v6, 32, v5
    ds_read_b64_tr_b16 v[24:25], v5 offset:0
    s_waitcnt lgkmcnt(3)
    v_mfma_f32_16x16x32_bf16 v[220:223], v[36:39], v[76:79], v[220:223]
    ds_read_b64_tr_b16 v[26:27], v5 offset:6144
    v_mfma_f32_16x16x32_bf16 v[212:215], v[36:39], v[72:75], v[212:215]
    ds_read_b64 v[108:109], v114 offset:2048
    v_mfma_f32_16x16x32_bf16 v[212:215], v[32:35], v[56:59], v[212:215]
    ds_read_b64 v[110:111], v115 offset:2048
    v_mfma_f32_16x16x32_bf16 v[172:175], v[32:35], v[52:55], v[172:175]
    ds_read_b64_tr_b16 v[28:29], v5 offset:12288
    v_mfma_f32_16x16x32_bf16 v[172:175], v[36:39], v[68:71], v[172:175]
    ds_read_b64_tr_b16 v[30:31], v5 offset:18432
    v_mfma_f32_16x16x32_bf16 v[164:167], v[36:39], v[64:67], v[164:167]
    v_mfma_f32_16x16x32_bf16 v[164:167], v[32:35], v[48:51], v[164:167]
    s_waitcnt lgkmcnt(4)
    v_mfma_f32_16x16x32_bf16 v[128:131], v[24:27], v[80:83], v[128:131]
    ds_read_b64_tr_b16 v[32:33], v6 offset:0
    s_waitcnt lgkmcnt(1)
    v_mfma_f32_16x16x32_bf16 v[128:131], v[28:31], v[96:99], v[128:131]
    ds_read_b64_tr_b16 v[34:35], v6 offset:6144
    v_mfma_f32_16x16x32_bf16 v[136:139], v[28:31], v[100:103], v[136:139]
    v_mfma_f32_16x16x32_bf16 v[136:139], v[24:27], v[84:87], v[136:139]
    s_barrier
    v_mfma_f32_16x16x32_bf16 v[176:179], v[24:27], v[88:91], v[176:179]
    ds_read_b64_tr_b16 v[36:37], v6 offset:12288
    v_mfma_f32_16x16x32_bf16 v[176:179], v[28:31], v[104:107], v[176:179]
    ds_read_b64_tr_b16 v[38:39], v6 offset:18432
    v_mfma_f32_16x16x32_bf16 v[184:187], v[28:31], v[108:111], v[184:187]
    v_add_u32 v16, 147456, v14
    v_xor_b32 v112, 4096, v16
    v_mfma_f32_16x16x32_bf16 v[184:187], v[24:27], v[92:95], v[184:187]
    v_xor_b32 v17, 32, v16
    v_xor_b32 v113, 32, v112
    s_waitcnt lgkmcnt(2)
    v_mfma_f32_16x16x32_bf16 v[188:191], v[32:35], v[92:95], v[188:191]
    ds_read_b64_tr_b16 v[24:25], v5 offset:128
    s_waitcnt lgkmcnt(1)
    v_mfma_f32_16x16x32_bf16 v[188:191], v[36:39], v[108:111], v[188:191]
    ds_read_b64_tr_b16 v[26:27], v5 offset:6272
    v_mfma_f32_16x16x32_bf16 v[180:183], v[36:39], v[104:107], v[180:183]
    v_xor_b32 v18, 64, v16
    v_xor_b32 v114, 64, v112
    v_mfma_f32_16x16x32_bf16 v[180:183], v[32:35], v[88:91], v[180:183]
    v_xor_b32 v19, 96, v16
    v_xor_b32 v115, 96, v112
    v_mfma_f32_16x16x32_bf16 v[140:143], v[32:35], v[84:87], v[140:143]
    ds_read_b64_tr_b16 v[28:29], v5 offset:12416
    v_mfma_f32_16x16x32_bf16 v[140:143], v[36:39], v[100:103], v[140:143]
    ds_read_b64_tr_b16 v[30:31], v5 offset:18560
    v_mfma_f32_16x16x32_bf16 v[132:135], v[36:39], v[96:99], v[132:135]
    ds_read_b64 v[48:49], v16 offset:0
    v_mfma_f32_16x16x32_bf16 v[132:135], v[32:35], v[80:83], v[132:135]
    ds_read_b64 v[50:51], v17 offset:0
    s_waitcnt lgkmcnt(4)
    v_mfma_f32_16x16x32_bf16 v[144:147], v[24:27], v[80:83], v[144:147]
    ds_read_b64_tr_b16 v[32:33], v6 offset:128
    s_waitcnt lgkmcnt(3)
    v_mfma_f32_16x16x32_bf16 v[144:147], v[28:31], v[96:99], v[144:147]
    ds_read_b64_tr_b16 v[34:35], v6 offset:6272
    v_mfma_f32_16x16x32_bf16 v[152:155], v[28:31], v[100:103], v[152:155]
    ds_read_b64 v[52:53], v16 offset:2048
    v_mfma_f32_16x16x32_bf16 v[152:155], v[24:27], v[84:87], v[152:155]
    ds_read_b64 v[54:55], v17 offset:2048
    v_mfma_f32_16x16x32_bf16 v[192:195], v[24:27], v[88:91], v[192:195]
    ds_read_b64_tr_b16 v[36:37], v6 offset:12416
    v_mfma_f32_16x16x32_bf16 v[192:195], v[28:31], v[104:107], v[192:195]
    ds_read_b64_tr_b16 v[38:39], v6 offset:18560
    v_mfma_f32_16x16x32_bf16 v[200:203], v[28:31], v[108:111], v[200:203]
    ds_read_b64 v[56:57], v112 offset:0
    v_mfma_f32_16x16x32_bf16 v[200:203], v[24:27], v[92:95], v[200:203]
    ds_read_b64 v[58:59], v113 offset:0
    s_waitcnt lgkmcnt(6)
    v_mfma_f32_16x16x32_bf16 v[204:207], v[32:35], v[92:95], v[204:207]
    ds_read_b64_tr_b16 v[24:25], v5 offset:256
    s_waitcnt lgkmcnt(3)
    v_mfma_f32_16x16x32_bf16 v[204:207], v[36:39], v[108:111], v[204:207]
    ds_read_b64_tr_b16 v[26:27], v5 offset:6400
    v_mfma_f32_16x16x32_bf16 v[196:199], v[36:39], v[104:107], v[196:199]
    ds_read_b64 v[60:61], v112 offset:2048
    v_mfma_f32_16x16x32_bf16 v[196:199], v[32:35], v[88:91], v[196:199]
    ds_read_b64 v[62:63], v113 offset:2048
    v_mfma_f32_16x16x32_bf16 v[156:159], v[32:35], v[84:87], v[156:159]
    ds_read_b64_tr_b16 v[28:29], v5 offset:12544
    v_mfma_f32_16x16x32_bf16 v[156:159], v[36:39], v[100:103], v[156:159]
    ds_read_b64_tr_b16 v[30:31], v5 offset:18688
    v_mfma_f32_16x16x32_bf16 v[148:151], v[36:39], v[96:99], v[148:151]
    ds_read_b64 v[64:65], v18 offset:0
    v_mfma_f32_16x16x32_bf16 v[148:151], v[32:35], v[80:83], v[148:151]
    ds_read_b64 v[66:67], v19 offset:0
    s_waitcnt lgkmcnt(6)
    v_mfma_f32_16x16x32_bf16 v[160:163], v[24:27], v[80:83], v[160:163]
    ds_read_b64_tr_b16 v[32:33], v6 offset:256
    s_waitcnt lgkmcnt(3)
    v_mfma_f32_16x16x32_bf16 v[160:163], v[28:31], v[96:99], v[160:163]
    ds_read_b64_tr_b16 v[34:35], v6 offset:6400
    v_mfma_f32_16x16x32_bf16 v[168:171], v[28:31], v[100:103], v[168:171]
    ds_read_b64 v[68:69], v18 offset:2048
    v_mfma_f32_16x16x32_bf16 v[168:171], v[24:27], v[84:87], v[168:171]
    ds_read_b64 v[70:71], v19 offset:2048
    v_mfma_f32_16x16x32_bf16 v[208:211], v[24:27], v[88:91], v[208:211]
    ds_read_b64_tr_b16 v[36:37], v6 offset:12544
    v_mfma_f32_16x16x32_bf16 v[208:211], v[28:31], v[104:107], v[208:211]
    ds_read_b64_tr_b16 v[38:39], v6 offset:18688
    v_mfma_f32_16x16x32_bf16 v[216:219], v[28:31], v[108:111], v[216:219]
    ds_read_b64 v[72:73], v114 offset:0
    v_mfma_f32_16x16x32_bf16 v[216:219], v[24:27], v[92:95], v[216:219]
    ds_read_b64 v[74:75], v115 offset:0
    s_waitcnt lgkmcnt(6)
    v_mfma_f32_16x16x32_bf16 v[220:223], v[32:35], v[92:95], v[220:223]
    v_add_u32 v5, 49152, v116
    v_xor_b32 v6, 32, v5
    ds_read_b64_tr_b16 v[24:25], v5 offset:0
    s_waitcnt lgkmcnt(3)
    v_mfma_f32_16x16x32_bf16 v[220:223], v[36:39], v[108:111], v[220:223]
    ds_read_b64_tr_b16 v[26:27], v5 offset:6144
    v_mfma_f32_16x16x32_bf16 v[212:215], v[36:39], v[104:107], v[212:215]
    ds_read_b64 v[76:77], v114 offset:2048
    v_mfma_f32_16x16x32_bf16 v[212:215], v[32:35], v[88:91], v[212:215]
    ds_read_b64 v[78:79], v115 offset:2048
    v_mfma_f32_16x16x32_bf16 v[172:175], v[32:35], v[84:87], v[172:175]
    ds_read_b64_tr_b16 v[28:29], v5 offset:12288
    v_mfma_f32_16x16x32_bf16 v[172:175], v[36:39], v[100:103], v[172:175]
    ds_read_b64_tr_b16 v[30:31], v5 offset:18432
    v_mfma_f32_16x16x32_bf16 v[164:167], v[36:39], v[96:99], v[164:167]
    v_mfma_f32_16x16x32_bf16 v[164:167], v[32:35], v[80:83], v[164:167]
    s_waitcnt lgkmcnt(4)
    v_mfma_f32_16x16x32_bf16 v[128:131], v[24:27], v[48:51], v[128:131]
    ds_read_b64_tr_b16 v[32:33], v6 offset:0
    s_waitcnt lgkmcnt(1)
    v_mfma_f32_16x16x32_bf16 v[128:131], v[28:31], v[64:67], v[128:131]
    ds_read_b64_tr_b16 v[34:35], v6 offset:6144
    v_mfma_f32_16x16x32_bf16 v[136:139], v[28:31], v[68:71], v[136:139]
    v_mfma_f32_16x16x32_bf16 v[136:139], v[24:27], v[52:55], v[136:139]
    s_barrier
    v_mfma_f32_16x16x32_bf16 v[176:179], v[24:27], v[56:59], v[176:179]
    ds_read_b64_tr_b16 v[36:37], v6 offset:12288
    v_mfma_f32_16x16x32_bf16 v[176:179], v[28:31], v[72:75], v[176:179]
    ds_read_b64_tr_b16 v[38:39], v6 offset:18432
    v_mfma_f32_16x16x32_bf16 v[184:187], v[28:31], v[76:79], v[184:187]
    v_add_u32 v16, 131072, v14
    v_xor_b32 v112, 4096, v16
    v_mfma_f32_16x16x32_bf16 v[184:187], v[24:27], v[60:63], v[184:187]
    v_xor_b32 v17, 32, v16
    v_xor_b32 v113, 32, v112
    s_waitcnt lgkmcnt(2)
    v_mfma_f32_16x16x32_bf16 v[188:191], v[32:35], v[60:63], v[188:191]
    ds_read_b64_tr_b16 v[24:25], v5 offset:128
    s_waitcnt lgkmcnt(1)
    v_mfma_f32_16x16x32_bf16 v[188:191], v[36:39], v[76:79], v[188:191]
    ds_read_b64_tr_b16 v[26:27], v5 offset:6272
    v_mfma_f32_16x16x32_bf16 v[180:183], v[36:39], v[72:75], v[180:183]
    v_xor_b32 v18, 64, v16
    v_xor_b32 v114, 64, v112
    v_mfma_f32_16x16x32_bf16 v[180:183], v[32:35], v[56:59], v[180:183]
    v_xor_b32 v19, 96, v16
    v_xor_b32 v115, 96, v112
    v_mfma_f32_16x16x32_bf16 v[140:143], v[32:35], v[52:55], v[140:143]
    ds_read_b64_tr_b16 v[28:29], v5 offset:12416
    v_mfma_f32_16x16x32_bf16 v[140:143], v[36:39], v[68:71], v[140:143]
    ds_read_b64_tr_b16 v[30:31], v5 offset:18560
    v_mfma_f32_16x16x32_bf16 v[132:135], v[36:39], v[64:67], v[132:135]
    ds_read_b64 v[80:81], v16 offset:0
    v_mfma_f32_16x16x32_bf16 v[132:135], v[32:35], v[48:51], v[132:135]
    ds_read_b64 v[82:83], v17 offset:0
    s_waitcnt lgkmcnt(4)
    v_mfma_f32_16x16x32_bf16 v[144:147], v[24:27], v[48:51], v[144:147]
    ds_read_b64_tr_b16 v[32:33], v6 offset:128
    s_waitcnt lgkmcnt(3)
    v_mfma_f32_16x16x32_bf16 v[144:147], v[28:31], v[64:67], v[144:147]
    ds_read_b64_tr_b16 v[34:35], v6 offset:6272
    v_mfma_f32_16x16x32_bf16 v[152:155], v[28:31], v[68:71], v[152:155]
    ds_read_b64 v[84:85], v16 offset:2048
    v_mfma_f32_16x16x32_bf16 v[152:155], v[24:27], v[52:55], v[152:155]
    ds_read_b64 v[86:87], v17 offset:2048
    v_mfma_f32_16x16x32_bf16 v[192:195], v[24:27], v[56:59], v[192:195]
    ds_read_b64_tr_b16 v[36:37], v6 offset:12416
    v_mfma_f32_16x16x32_bf16 v[192:195], v[28:31], v[72:75], v[192:195]
    ds_read_b64_tr_b16 v[38:39], v6 offset:18560
    v_mfma_f32_16x16x32_bf16 v[200:203], v[28:31], v[76:79], v[200:203]
    ds_read_b64 v[88:89], v112 offset:0
    v_mfma_f32_16x16x32_bf16 v[200:203], v[24:27], v[60:63], v[200:203]
    ds_read_b64 v[90:91], v113 offset:0
    s_waitcnt lgkmcnt(6)
    v_mfma_f32_16x16x32_bf16 v[204:207], v[32:35], v[60:63], v[204:207]
    ds_read_b64_tr_b16 v[24:25], v5 offset:256
    s_waitcnt lgkmcnt(3)
    v_mfma_f32_16x16x32_bf16 v[204:207], v[36:39], v[76:79], v[204:207]
    ds_read_b64_tr_b16 v[26:27], v5 offset:6400
    v_mfma_f32_16x16x32_bf16 v[196:199], v[36:39], v[72:75], v[196:199]
    ds_read_b64 v[92:93], v112 offset:2048
    v_mfma_f32_16x16x32_bf16 v[196:199], v[32:35], v[56:59], v[196:199]
    ds_read_b64 v[94:95], v113 offset:2048
    v_mfma_f32_16x16x32_bf16 v[156:159], v[32:35], v[52:55], v[156:159]
    ds_read_b64_tr_b16 v[28:29], v5 offset:12544
    v_mfma_f32_16x16x32_bf16 v[156:159], v[36:39], v[68:71], v[156:159]
    ds_read_b64_tr_b16 v[30:31], v5 offset:18688
    v_mfma_f32_16x16x32_bf16 v[148:151], v[36:39], v[64:67], v[148:151]
    ds_read_b64 v[96:97], v18 offset:0
    v_mfma_f32_16x16x32_bf16 v[148:151], v[32:35], v[48:51], v[148:151]
    ds_read_b64 v[98:99], v19 offset:0
    s_waitcnt lgkmcnt(6)
    v_mfma_f32_16x16x32_bf16 v[160:163], v[24:27], v[48:51], v[160:163]
    ds_read_b64_tr_b16 v[32:33], v6 offset:256
    s_waitcnt lgkmcnt(3)
    v_mfma_f32_16x16x32_bf16 v[160:163], v[28:31], v[64:67], v[160:163]
    ds_read_b64_tr_b16 v[34:35], v6 offset:6400
    v_mfma_f32_16x16x32_bf16 v[168:171], v[28:31], v[68:71], v[168:171]
    ds_read_b64 v[100:101], v18 offset:2048
    v_mfma_f32_16x16x32_bf16 v[168:171], v[24:27], v[52:55], v[168:171]
    ds_read_b64 v[102:103], v19 offset:2048
    v_mfma_f32_16x16x32_bf16 v[208:211], v[24:27], v[56:59], v[208:211]
    ds_read_b64_tr_b16 v[36:37], v6 offset:12544
    v_mfma_f32_16x16x32_bf16 v[208:211], v[28:31], v[72:75], v[208:211]
    ds_read_b64_tr_b16 v[38:39], v6 offset:18688
    v_mfma_f32_16x16x32_bf16 v[216:219], v[28:31], v[76:79], v[216:219]
    ds_read_b64 v[104:105], v114 offset:0
    v_mfma_f32_16x16x32_bf16 v[216:219], v[24:27], v[60:63], v[216:219]
    ds_read_b64 v[106:107], v115 offset:0
    s_waitcnt lgkmcnt(6)
    v_mfma_f32_16x16x32_bf16 v[220:223], v[32:35], v[60:63], v[220:223]
    v_add_u32 v5, 73728, v116
    v_xor_b32 v6, 32, v5
    ds_read_b64_tr_b16 v[24:25], v5 offset:0
    s_waitcnt lgkmcnt(3)
    v_mfma_f32_16x16x32_bf16 v[220:223], v[36:39], v[76:79], v[220:223]
    ds_read_b64_tr_b16 v[26:27], v5 offset:6144
    v_mfma_f32_16x16x32_bf16 v[212:215], v[36:39], v[72:75], v[212:215]
    ds_read_b64 v[108:109], v114 offset:2048
    v_mfma_f32_16x16x32_bf16 v[212:215], v[32:35], v[56:59], v[212:215]
    ds_read_b64 v[110:111], v115 offset:2048
    v_mfma_f32_16x16x32_bf16 v[172:175], v[32:35], v[52:55], v[172:175]
    ds_read_b64_tr_b16 v[28:29], v5 offset:12288
    v_mfma_f32_16x16x32_bf16 v[172:175], v[36:39], v[68:71], v[172:175]
    ds_read_b64_tr_b16 v[30:31], v5 offset:18432
    v_mfma_f32_16x16x32_bf16 v[164:167], v[36:39], v[64:67], v[164:167]
    v_mfma_f32_16x16x32_bf16 v[164:167], v[32:35], v[48:51], v[164:167]
    s_waitcnt lgkmcnt(4)
    v_mfma_f32_16x16x32_bf16 v[128:131], v[24:27], v[80:83], v[128:131]
    ds_read_b64_tr_b16 v[32:33], v6 offset:0
    s_waitcnt lgkmcnt(1)
    v_mfma_f32_16x16x32_bf16 v[128:131], v[28:31], v[96:99], v[128:131]
    ds_read_b64_tr_b16 v[34:35], v6 offset:6144
    v_mfma_f32_16x16x32_bf16 v[136:139], v[28:31], v[100:103], v[136:139]
    v_mfma_f32_16x16x32_bf16 v[136:139], v[24:27], v[84:87], v[136:139]
    v_mfma_f32_16x16x32_bf16 v[176:179], v[24:27], v[88:91], v[176:179]
    ds_read_b64_tr_b16 v[36:37], v6 offset:12288
    v_mfma_f32_16x16x32_bf16 v[176:179], v[28:31], v[104:107], v[176:179]
    ds_read_b64_tr_b16 v[38:39], v6 offset:18432
    v_mfma_f32_16x16x32_bf16 v[184:187], v[28:31], v[108:111], v[184:187]
    v_mfma_f32_16x16x32_bf16 v[184:187], v[24:27], v[92:95], v[184:187]
    s_waitcnt lgkmcnt(2)
    v_mfma_f32_16x16x32_bf16 v[188:191], v[32:35], v[92:95], v[188:191]
    ds_read_b64_tr_b16 v[24:25], v5 offset:128
    s_waitcnt lgkmcnt(1)
    v_mfma_f32_16x16x32_bf16 v[188:191], v[36:39], v[108:111], v[188:191]
    ds_read_b64_tr_b16 v[26:27], v5 offset:6272
    v_mfma_f32_16x16x32_bf16 v[180:183], v[36:39], v[104:107], v[180:183]
    v_mfma_f32_16x16x32_bf16 v[180:183], v[32:35], v[88:91], v[180:183]
    v_mfma_f32_16x16x32_bf16 v[140:143], v[32:35], v[84:87], v[140:143]
    ds_read_b64_tr_b16 v[28:29], v5 offset:12416
    v_mfma_f32_16x16x32_bf16 v[140:143], v[36:39], v[100:103], v[140:143]
    ds_read_b64_tr_b16 v[30:31], v5 offset:18560
    v_mfma_f32_16x16x32_bf16 v[132:135], v[36:39], v[96:99], v[132:135]
    v_mfma_f32_16x16x32_bf16 v[132:135], v[32:35], v[80:83], v[132:135]
    s_waitcnt lgkmcnt(2)
    v_mfma_f32_16x16x32_bf16 v[144:147], v[24:27], v[80:83], v[144:147]
    ds_read_b64_tr_b16 v[32:33], v6 offset:128
    s_waitcnt lgkmcnt(1)
    v_mfma_f32_16x16x32_bf16 v[144:147], v[28:31], v[96:99], v[144:147]
    ds_read_b64_tr_b16 v[34:35], v6 offset:6272
    v_mfma_f32_16x16x32_bf16 v[152:155], v[28:31], v[100:103], v[152:155]
    v_mfma_f32_16x16x32_bf16 v[152:155], v[24:27], v[84:87], v[152:155]
    v_mfma_f32_16x16x32_bf16 v[192:195], v[24:27], v[88:91], v[192:195]
    ds_read_b64_tr_b16 v[36:37], v6 offset:12416
    v_mfma_f32_16x16x32_bf16 v[192:195], v[28:31], v[104:107], v[192:195]
    ds_read_b64_tr_b16 v[38:39], v6 offset:18560
    v_mfma_f32_16x16x32_bf16 v[200:203], v[28:31], v[108:111], v[200:203]
    v_mfma_f32_16x16x32_bf16 v[200:203], v[24:27], v[92:95], v[200:203]
    s_waitcnt lgkmcnt(2)
    v_mfma_f32_16x16x32_bf16 v[204:207], v[32:35], v[92:95], v[204:207]
    ds_read_b64_tr_b16 v[24:25], v5 offset:256
    s_waitcnt lgkmcnt(1)
    v_mfma_f32_16x16x32_bf16 v[204:207], v[36:39], v[108:111], v[204:207]
    ds_read_b64_tr_b16 v[26:27], v5 offset:6400
    v_mfma_f32_16x16x32_bf16 v[196:199], v[36:39], v[104:107], v[196:199]
    v_mfma_f32_16x16x32_bf16 v[196:199], v[32:35], v[88:91], v[196:199]
    v_mfma_f32_16x16x32_bf16 v[156:159], v[32:35], v[84:87], v[156:159]
    ds_read_b64_tr_b16 v[28:29], v5 offset:12544
    v_mfma_f32_16x16x32_bf16 v[156:159], v[36:39], v[100:103], v[156:159]
    ds_read_b64_tr_b16 v[30:31], v5 offset:18688
    v_mfma_f32_16x16x32_bf16 v[148:151], v[36:39], v[96:99], v[148:151]
    v_mfma_f32_16x16x32_bf16 v[148:151], v[32:35], v[80:83], v[148:151]
    s_waitcnt lgkmcnt(2)
    v_mfma_f32_16x16x32_bf16 v[160:163], v[24:27], v[80:83], v[160:163]
    ds_read_b64_tr_b16 v[32:33], v6 offset:256
    s_waitcnt lgkmcnt(1)
    v_mfma_f32_16x16x32_bf16 v[160:163], v[28:31], v[96:99], v[160:163]
    ds_read_b64_tr_b16 v[34:35], v6 offset:6400
    v_mfma_f32_16x16x32_bf16 v[168:171], v[28:31], v[100:103], v[168:171]
    v_mfma_f32_16x16x32_bf16 v[168:171], v[24:27], v[84:87], v[168:171]
    v_mfma_f32_16x16x32_bf16 v[208:211], v[24:27], v[88:91], v[208:211]
    ds_read_b64_tr_b16 v[36:37], v6 offset:12544
    v_mfma_f32_16x16x32_bf16 v[208:211], v[28:31], v[104:107], v[208:211]
    ds_read_b64_tr_b16 v[38:39], v6 offset:18688
    v_mfma_f32_16x16x32_bf16 v[216:219], v[28:31], v[108:111], v[216:219]
    v_mfma_f32_16x16x32_bf16 v[216:219], v[24:27], v[92:95], v[216:219]
    s_waitcnt lgkmcnt(2)
    v_mfma_f32_16x16x32_bf16 v[220:223], v[32:35], v[92:95], v[220:223]
    s_waitcnt lgkmcnt(0)
    v_mfma_f32_16x16x32_bf16 v[220:223], v[36:39], v[108:111], v[220:223]
    v_mfma_f32_16x16x32_bf16 v[212:215], v[36:39], v[104:107], v[212:215]
    v_mfma_f32_16x16x32_bf16 v[212:215], v[32:35], v[88:91], v[212:215]
    v_mfma_f32_16x16x32_bf16 v[172:175], v[32:35], v[84:87], v[172:175]
    v_mfma_f32_16x16x32_bf16 v[172:175], v[36:39], v[100:103], v[172:175]
    v_mfma_f32_16x16x32_bf16 v[164:167], v[36:39], v[96:99], v[164:167]
    v_mfma_f32_16x16x32_bf16 v[164:167], v[32:35], v[80:83], v[164:167]
    s_barrier
    s_mov_b32 s38, 0x3dd53b95
    s_mov_b32 s39, 0x3dd53b95
    s_mul_i32 s48, s41, 6144
    s_add_u32 s48, s48, 73728
    v_add_u32 v117, s48, v15
    s_xor_b32 s54, s41, 1
    s_mul_i32 s48, s54, 6144
    s_add_u32 s48, s48, 73728
    v_add_u32 v118, s48, v15
    v_pk_mul_f32 v[176:177], v[176:177], s[38:39]
    v_cvt_pk_bf16_f32 v56, v176, v177
    v_pk_mul_f32 v[178:179], v[178:179], s[38:39]
    v_cvt_pk_bf16_f32 v57, v178, v179
    v_pk_mul_f32 v[180:181], v[180:181], s[38:39]
    v_cvt_pk_bf16_f32 v58, v180, v181
    v_pk_mul_f32 v[182:183], v[182:183], s[38:39]
    v_cvt_pk_bf16_f32 v59, v182, v183
    v_pk_mul_f32 v[184:185], v[184:185], s[38:39]
    v_cvt_pk_bf16_f32 v60, v184, v185
    v_pk_mul_f32 v[186:187], v[186:187], s[38:39]
    v_cvt_pk_bf16_f32 v61, v186, v187
    v_pk_mul_f32 v[188:189], v[188:189], s[38:39]
    v_cvt_pk_bf16_f32 v62, v188, v189
    v_pk_mul_f32 v[190:191], v[190:191], s[38:39]
    v_cvt_pk_bf16_f32 v63, v190, v191
    v_pk_mul_f32 v[192:193], v[192:193], s[38:39]
    v_cvt_pk_bf16_f32 v72, v192, v193
    v_pk_mul_f32 v[194:195], v[194:195], s[38:39]
    v_cvt_pk_bf16_f32 v73, v194, v195
    v_pk_mul_f32 v[196:197], v[196:197], s[38:39]
    v_cvt_pk_bf16_f32 v74, v196, v197
    v_pk_mul_f32 v[198:199], v[198:199], s[38:39]
    v_cvt_pk_bf16_f32 v75, v198, v199
    v_pk_mul_f32 v[200:201], v[200:201], s[38:39]
    v_cvt_pk_bf16_f32 v76, v200, v201
    v_pk_mul_f32 v[202:203], v[202:203], s[38:39]
    v_cvt_pk_bf16_f32 v77, v202, v203
    v_pk_mul_f32 v[204:205], v[204:205], s[38:39]
    v_cvt_pk_bf16_f32 v78, v204, v205
    v_pk_mul_f32 v[206:207], v[206:207], s[38:39]
    v_cvt_pk_bf16_f32 v79, v206, v207
    v_pk_mul_f32 v[208:209], v[208:209], s[38:39]
    v_cvt_pk_bf16_f32 v88, v208, v209
    v_pk_mul_f32 v[210:211], v[210:211], s[38:39]
    v_cvt_pk_bf16_f32 v89, v210, v211
    v_pk_mul_f32 v[212:213], v[212:213], s[38:39]
    v_cvt_pk_bf16_f32 v90, v212, v213
    v_pk_mul_f32 v[214:215], v[214:215], s[38:39]
    v_cvt_pk_bf16_f32 v91, v214, v215
    v_pk_mul_f32 v[216:217], v[216:217], s[38:39]
    v_cvt_pk_bf16_f32 v92, v216, v217
    v_pk_mul_f32 v[218:219], v[218:219], s[38:39]
    v_cvt_pk_bf16_f32 v93, v218, v219
    v_pk_mul_f32 v[220:221], v[220:221], s[38:39]
    v_cvt_pk_bf16_f32 v94, v220, v221
    v_pk_mul_f32 v[222:223], v[222:223], s[38:39]
    v_cvt_pk_bf16_f32 v95, v222, v223
    v_permlane32_swap_b32 v56, v58
    v_permlane32_swap_b32 v57, v59
    v_permlane32_swap_b32 v60, v62
    v_permlane32_swap_b32 v61, v63
    v_permlane32_swap_b32 v72, v74
    v_permlane32_swap_b32 v73, v75
    v_permlane32_swap_b32 v76, v78
    v_permlane32_swap_b32 v77, v79
    v_permlane32_swap_b32 v88, v90
    v_permlane32_swap_b32 v89, v91
    v_permlane32_swap_b32 v92, v94
    v_permlane32_swap_b32 v93, v95
    v_permlane16_swap_b32 v56, v58
    v_permlane16_swap_b32 v57, v59
    v_permlane16_swap_b32 v60, v62
    v_permlane16_swap_b32 v61, v63
    v_permlane16_swap_b32 v72, v74
    v_permlane16_swap_b32 v73, v75
    v_permlane16_swap_b32 v76, v78
    v_permlane16_swap_b32 v77, v79
    v_permlane16_swap_b32 v88, v90
    v_permlane16_swap_b32 v89, v91
    v_permlane16_swap_b32 v92, v94
    v_permlane16_swap_b32 v93, v95
    ds_write_b128 v117, v[56:59] offset:0
    ds_write_b128 v117, v[60:63] offset:1024
    ds_write_b128 v117, v[72:75] offset:2048
    ds_write_b128 v117, v[76:79] offset:3072
    ds_write_b128 v117, v[88:91] offset:4096
    ds_write_b128 v117, v[92:95] offset:5120
    v_pk_mul_f32 v[128:129], v[128:129], s[38:39]
    v_cvt_pk_bf16_f32 v48, v128, v129
    v_pk_mul_f32 v[130:131], v[130:131], s[38:39]
    v_cvt_pk_bf16_f32 v49, v130, v131
    v_pk_mul_f32 v[132:133], v[132:133], s[38:39]
    v_cvt_pk_bf16_f32 v50, v132, v133
    v_pk_mul_f32 v[134:135], v[134:135], s[38:39]
    v_cvt_pk_bf16_f32 v51, v134, v135
    v_pk_mul_f32 v[136:137], v[136:137], s[38:39]
    v_cvt_pk_bf16_f32 v52, v136, v137
    v_pk_mul_f32 v[138:139], v[138:139], s[38:39]
    v_cvt_pk_bf16_f32 v53, v138, v139
    v_pk_mul_f32 v[140:141], v[140:141], s[38:39]
    v_cvt_pk_bf16_f32 v54, v140, v141
    v_pk_mul_f32 v[142:143], v[142:143], s[38:39]
    v_cvt_pk_bf16_f32 v55, v142, v143
    v_pk_mul_f32 v[144:145], v[144:145], s[38:39]
    v_cvt_pk_bf16_f32 v64, v144, v145
    v_pk_mul_f32 v[146:147], v[146:147], s[38:39]
    v_cvt_pk_bf16_f32 v65, v146, v147
    v_pk_mul_f32 v[148:149], v[148:149], s[38:39]
    v_cvt_pk_bf16_f32 v66, v148, v149
    v_pk_mul_f32 v[150:151], v[150:151], s[38:39]
    v_cvt_pk_bf16_f32 v67, v150, v151
    v_pk_mul_f32 v[152:153], v[152:153], s[38:39]
    v_cvt_pk_bf16_f32 v68, v152, v153
    v_pk_mul_f32 v[154:155], v[154:155], s[38:39]
    v_cvt_pk_bf16_f32 v69, v154, v155
    v_pk_mul_f32 v[156:157], v[156:157], s[38:39]
    v_cvt_pk_bf16_f32 v70, v156, v157
    v_pk_mul_f32 v[158:159], v[158:159], s[38:39]
    v_cvt_pk_bf16_f32 v71, v158, v159
    v_pk_mul_f32 v[160:161], v[160:161], s[38:39]
    v_cvt_pk_bf16_f32 v80, v160, v161
    v_pk_mul_f32 v[162:163], v[162:163], s[38:39]
    v_cvt_pk_bf16_f32 v81, v162, v163
    v_pk_mul_f32 v[164:165], v[164:165], s[38:39]
    v_cvt_pk_bf16_f32 v82, v164, v165
    v_pk_mul_f32 v[166:167], v[166:167], s[38:39]
    v_cvt_pk_bf16_f32 v83, v166, v167
    v_pk_mul_f32 v[168:169], v[168:169], s[38:39]
    v_cvt_pk_bf16_f32 v84, v168, v169
    v_pk_mul_f32 v[170:171], v[170:171], s[38:39]
    v_cvt_pk_bf16_f32 v85, v170, v171
    v_pk_mul_f32 v[172:173], v[172:173], s[38:39]
    v_cvt_pk_bf16_f32 v86, v172, v173
    v_pk_mul_f32 v[174:175], v[174:175], s[38:39]
    v_cvt_pk_bf16_f32 v87, v174, v175
    v_permlane32_swap_b32 v48, v50
    v_permlane32_swap_b32 v49, v51
    v_permlane32_swap_b32 v52, v54
    v_permlane32_swap_b32 v53, v55
    v_permlane32_swap_b32 v64, v66
    v_permlane32_swap_b32 v65, v67
    v_permlane32_swap_b32 v68, v70
    v_permlane32_swap_b32 v69, v71
    v_permlane32_swap_b32 v80, v82
    v_permlane32_swap_b32 v81, v83
    v_permlane32_swap_b32 v84, v86
    v_permlane32_swap_b32 v85, v87
    v_permlane16_swap_b32 v48, v50
    v_permlane16_swap_b32 v49, v51
    v_permlane16_swap_b32 v52, v54
    v_permlane16_swap_b32 v53, v55
    v_permlane16_swap_b32 v64, v66
    v_permlane16_swap_b32 v65, v67
    v_permlane16_swap_b32 v68, v70
    v_permlane16_swap_b32 v69, v71
    v_permlane16_swap_b32 v80, v82
    v_permlane16_swap_b32 v81, v83
    v_permlane16_swap_b32 v84, v86
    v_permlane16_swap_b32 v85, v87
    s_waitcnt lgkmcnt(0)
    s_barrier
    ds_read_b128 v[56:59], v118 offset:0
    ds_read_b128 v[60:63], v118 offset:1024
    ds_read_b128 v[72:75], v118 offset:2048
    ds_read_b128 v[76:79], v118 offset:3072
    ds_read_b128 v[88:91], v118 offset:4096
    ds_read_b128 v[92:95], v118 offset:5120
    s_waitcnt vmcnt(0)
    v_mov_b64 v[240:241], 0
    v_mov_b64 v[242:243], 0
    v_mov_b64 v[244:245], 0
    v_mov_b64 v[246:247], 0
    v_mov_b64 v[248:249], 0
    v_mov_b64 v[250:251], 0
    v_mov_b64 v[252:253], 0
    v_mov_b64 v[254:255], 0
    v_mov_b64 v[128:129], 0
    v_mov_b64 v[130:131], 0
    v_mov_b64 v[132:133], 0
    v_mov_b64 v[134:135], 0
    v_mov_b64 v[136:137], 0
    v_mov_b64 v[138:139], 0
    v_mov_b64 v[140:141], 0
    v_mov_b64 v[142:143], 0
    v_mov_b64 v[144:145], 0
    v_mov_b64 v[146:147], 0
    v_mov_b64 v[148:149], 0
    v_mov_b64 v[150:151], 0
    v_mov_b64 v[152:153], 0
    v_mov_b64 v[154:155], 0
    v_mov_b64 v[156:157], 0
    v_mov_b64 v[158:159], 0
    v_mov_b64 v[160:161], 0
    v_mov_b64 v[162:163], 0
    v_mov_b64 v[164:165], 0
    v_mov_b64 v[166:167], 0
    v_mov_b64 v[168:169], 0
    v_mov_b64 v[170:171], 0
    v_mov_b64 v[172:173], 0
    v_mov_b64 v[174:175], 0
    v_mov_b64 v[176:177], 0
    v_mov_b64 v[178:179], 0
    v_mov_b64 v[180:181], 0
    v_mov_b64 v[182:183], 0
    v_mov_b64 v[184:185], 0
    v_mov_b64 v[186:187], 0
    v_mov_b64 v[188:189], 0
    v_mov_b64 v[190:191], 0
    v_mov_b64 v[192:193], 0
    v_mov_b64 v[194:195], 0
    v_mov_b64 v[196:197], 0
    v_mov_b64 v[198:199], 0
    v_mov_b64 v[200:201], 0
    v_mov_b64 v[202:203], 0
    v_mov_b64 v[204:205], 0
    v_mov_b64 v[206:207], 0
    v_mov_b64 v[208:209], 0
    v_mov_b64 v[210:211], 0
    v_mov_b64 v[212:213], 0
    v_mov_b64 v[214:215], 0
    v_mov_b64 v[216:217], 0
    v_mov_b64 v[218:219], 0
    v_mov_b64 v[220:221], 0
    v_mov_b64 v[222:223], 0
    v_mov_b32 v16, 0x3f803f80
    v_mov_b32 v17, 0x3f803f80
    v_mov_b32 v18, 0x3f803f80
    v_mov_b32 v19, 0x3f803f80
    s_mov_b32 s58, 0xff800000
    v_lshrrev_b32 v24, 2, v0
    v_mul_u32_u24 v14, 128, v24
    v_bfe_u32 v24, v0, 3, 2
    v_lshl_add_u32 v14, v24, 5, v14
    v_and_b32 v24, 3, v0
    v_lshl_add_u32 v14, v24, 3, v14
    s_waitcnt lgkmcnt(0)
    s_barrier
    s_mov_b32 s50, 98304
    s_branch L_ATT
L_SIDE_A:
    s_cmp_eq_u32 s41, 3
    s_cbranch_scc1 L_84
    s_cmp_ge_u32 s35, 28
    s_cbranch_scc1 L_86
    s_bitcmp1_b32 s35, 0
    s_cbranch_scc1 L_88
    s_add_u32 m0, s28, 0
    s_add_u32 s48, s30, 0
    buffer_load_dwordx4 v10, s[4:7], s48 offen nt lds
    buffer_load_dwordx4 v11, s[4:7], s48 offen offset:1024 nt lds
    s_add_u32 m0, s28, 6144
    s_add_u32 s48, s30, 6144
    buffer_load_dwordx4 v10, s[4:7], s48 offen nt lds
    buffer_load_dwordx4 v11, s[4:7], s48 offen offset:1024 nt lds
    s_add_u32 m0, s28, 12288
    s_add_u32 s48, s30, 12288
    buffer_load_dwordx4 v10, s[4:7], s48 offen nt lds
    buffer_load_dwordx4 v11, s[4:7], s48 offen offset:1024 nt lds
    s_add_u32 m0, s28, 18432
    s_add_u32 s48, s30, 18432
    buffer_load_dwordx4 v10, s[4:7], s48 offen nt lds
    buffer_load_dwordx4 v11, s[4:7], s48 offen offset:1024 nt lds
    s_branch L_89
L_88:
    s_add_u32 m0, s28, 0
    s_add_u32 s48, s30, 0
    buffer_load_dwordx4 v12, s[8:11], s48 offen nt lds
    buffer_load_dwordx4 v13, s[8:11], s48 offen offset:1024 nt lds
    s_add_u32 m0, s28, 6144
    s_add_u32 s48, s30, 6144
    buffer_load_dwordx4 v12, s[8:11], s48 offen nt lds
    buffer_load_dwordx4 v13, s[8:11], s48 offen offset:1024 nt lds
    s_add_u32 m0, s28, 12288
    s_add_u32 s48, s30, 12288
    buffer_load_dwordx4 v12, s[8:11], s48 offen nt lds
    buffer_load_dwordx4 v13, s[8:11], s48 offen offset:1024 nt lds
    s_add_u32 m0, s28, 18432
    s_add_u32 s48, s30, 18432
    buffer_load_dwordx4 v12, s[8:11], s48 offen nt lds
    buffer_load_dwordx4 v13, s[8:11], s48 offen offset:1024 nt lds
    s_add_u32 s30, s30, 24576
L_89:
    s_branch L_87
L_86:
    s_sub_u32 s54, s35, 29
    s_cmp_eq_u32 s35, 28
    s_cselect_b32 s54, 9, s54
    s_add_u32 s57, s56, s54
    s_sub_u32 s48, s57, 10
    s_cmp_ge_u32 s57, 10
    s_cselect_b32 s57, s48, s57
    s_mul_i32 s57, s57, 128
    s_add_u32 s57, s57, s45
    s_add_u32 m0, s28, 0
    s_add_u32 s48, s57, 245760
    buffer_load_dwordx4 v2, s[16:19], s48 offen lds
    buffer_load_dwordx4 v3, s[16:19], s48 offen offset:1024 lds
    s_add_u32 m0, s28, 6144
    s_add_u32 s48, s57, 307200
    buffer_load_dwordx4 v2, s[16:19], s48 offen lds
    buffer_load_dwordx4 v3, s[16:19], s48 offen offset:1024 lds
    s_add_u32 m0, s28, 12288
    s_add_u32 s48, s57, 368640
    buffer_load_dwordx4 v2, s[16:19], s48 offen lds
    buffer_load_dwordx4 v3, s[16:19], s48 offen offset:1024 lds
    s_add_u32 m0, s28, 18432
    s_add_u32 s48, s57, 430080
    buffer_load_dwordx4 v2, s[16:19], s48 offen lds
    buffer_load_dwordx4 v3, s[16:19], s48 offen offset:1024 lds
L_87:
    s_add_u32 s28, s28, 24576
    s_cmp_eq_u32 s28, s29
    s_cselect_b32 s28, s42, s28
    s_branch L_85
L_84:
    s_bitcmp1_b32 s31, 0
    s_cbranch_scc0 L_90
    s_add_u32 s57, s56, s33
    s_sub_u32 s48, s57, 10
    s_cmp_ge_u32 s57, 10
    s_cselect_b32 s57, s48, s57
    s_mul_i32 s57, s57, 128
    s_add_u32 s57, s57, s45
    s_mov_b32 m0, 122880
    s_add_u32 s48, s57, 0
    buffer_load_dwordx4 v12, s[16:19], s48 offen offset:0 lds
    buffer_load_dwordx4 v13, s[16:19], s48 offen offset:1024 lds
    buffer_load_dwordx4 v4, s[16:19], s48 offen offset:2048 lds
    s_mov_b32 m0, 125952
    s_add_u32 s48, s57, 30720
    buffer_load_dwordx4 v12, s[16:19], s48 offen offset:0 lds
    buffer_load_dwordx4 v13, s[16:19], s48 offen offset:1024 lds
    buffer_load_dwordx4 v4, s[16:19], s48 offen offset:2048 lds
    s_mov_b32 m0, 129024
    s_add_u32 s48, s57, 61440
    buffer_load_dwordx4 v12, s[16:19], s48 offen offset:0 lds
    buffer_load_dwordx4 v13, s[16:19], s48 offen offset:1024 lds
    buffer_load_dwordx4 v4, s[16:19], s48 offen offset:2048 lds
    s_mov_b32 m0, 132096
    s_add_u32 s48, s57, 92160
    buffer_load_dwordx4 v12, s[16:19], s48 offen offset:0 lds
    buffer_load_dwordx4 v13, s[16:19], s48 offen offset:1024 lds
    buffer_load_dwordx4 v4, s[16:19], s48 offen offset:2048 lds
    s_mov_b32 m0, 135168
    s_add_u32 s48, s57, 122880
    buffer_load_dwordx4 v12, s[16:19], s48 offen offset:0 lds
    buffer_load_dwordx4 v13, s[16:19], s48 offen offset:1024 lds
    buffer_load_dwordx4 v4, s[16:19], s48 offen offset:2048 lds
    s_mov_b32 m0, 138240
    s_add_u32 s48, s57, 153600
    buffer_load_dwordx4 v12, s[16:19], s48 offen offset:0 lds
    buffer_load_dwordx4 v13, s[16:19], s48 offen offset:1024 lds
    buffer_load_dwordx4 v4, s[16:19], s48 offen offset:2048 lds
    s_mov_b32 m0, 141312
    s_add_u32 s48, s57, 184320
    buffer_load_dwordx4 v12, s[16:19], s48 offen offset:0 lds
    buffer_load_dwordx4 v13, s[16:19], s48 offen offset:1024 lds
    buffer_load_dwordx4 v4, s[16:19], s48 offen offset:2048 lds
    s_mov_b32 m0, 144384
    s_add_u32 s48, s57, 215040
    buffer_load_dwordx4 v12, s[16:19], s48 offen offset:0 lds
    buffer_load_dwordx4 v13, s[16:19], s48 offen offset:1024 lds
    buffer_load_dwordx4 v4, s[16:19], s48 offen offset:2048 lds
    s_add_u32 s33, s33, 1
L_90:
L_85:
    s_cmp_eq_u32 s35, 0
    s_cbranch_scc0 L_92
    v_add_f32 v248, v248, v249
    v_add_f32 v252, v252, v253
    v_mov_b32 v250, v248
    v_mov_b32 v254, v252
    s_nop 0
    v_permlane32_swap_b32 v248, v250
    v_permlane32_swap_b32 v252, v254
    v_add_f32 v248, v248, v250
    v_add_f32 v252, v252, v254
    v_mov_b32 v250, v248
    v_mov_b32 v254, v252
    s_nop 0
    v_permlane16_swap_b32 v248, v250
    v_permlane16_swap_b32 v252, v254
    v_add_f32 v248, v248, v250
    v_add_f32 v252, v252, v254
    v_mov_b32 v249, v248
    v_mov_b32 v253, v252
    v_rcp_f32 v248, v248
    v_rcp_f32 v249, v249
    v_rcp_f32 v252, v252
    v_rcp_f32 v253, v253
    v_pk_mul_f32 v[128:129], v[128:129], v[248:249]
    v_cvt_pk_bf16_f32 v48, v128, v129
    v_pk_mul_f32 v[130:131], v[130:131], v[248:249]
    v_cvt_pk_bf16_f32 v49, v130, v131
    v_pk_mul_f32 v[132:133], v[132:133], v[248:249]
    v_cvt_pk_bf16_f32 v50, v132, v133
    v_pk_mul_f32 v[134:135], v[134:135], v[248:249]
    v_cvt_pk_bf16_f32 v51, v134, v135
    v_pk_mul_f32 v[136:137], v[136:137], v[252:253]
    v_cvt_pk_bf16_f32 v52, v136, v137
    v_pk_mul_f32 v[138:139], v[138:139], v[252:253]
    v_cvt_pk_bf16_f32 v53, v138, v139
    v_pk_mul_f32 v[140:141], v[140:141], v[252:253]
    v_cvt_pk_bf16_f32 v54, v140, v141
    v_pk_mul_f32 v[142:143], v[142:143], v[252:253]
    v_cvt_pk_bf16_f32 v55, v142, v143
    v_pk_mul_f32 v[144:145], v[144:145], v[248:249]
    v_cvt_pk_bf16_f32 v56, v144, v145
    v_pk_mul_f32 v[146:147], v[146:147], v[248:249]
    v_cvt_pk_bf16_f32 v57, v146, v147
    v_pk_mul_f32 v[148:149], v[148:149], v[248:249]
    v_cvt_pk_bf16_f32 v58, v148, v149
    v_pk_mul_f32 v[150:151], v[150:151], v[248:249]
    v_cvt_pk_bf16_f32 v59, v150, v151
    v_pk_mul_f32 v[152:153], v[152:153], v[252:253]
    v_cvt_pk_bf16_f32 v60, v152, v153
    v_pk_mul_f32 v[154:155], v[154:155], v[252:253]
    v_cvt_pk_bf16_f32 v61, v154, v155
    v_pk_mul_f32 v[156:157], v[156:157], v[252:253]
    v_cvt_pk_bf16_f32 v62, v156, v157
    v_pk_mul_f32 v[158:159], v[158:159], v[252:253]
    v_cvt_pk_bf16_f32 v63, v158, v159
    v_pk_mul_f32 v[160:161], v[160:161], v[248:249]
    v_cvt_pk_bf16_f32 v64, v160, v161
    v_pk_mul_f32 v[162:163], v[162:163], v[248:249]
    v_cvt_pk_bf16_f32 v65, v162, v163
    v_pk_mul_f32 v[164:165], v[164:165], v[248:249]
    v_cvt_pk_bf16_f32 v66, v164, v165
    v_pk_mul_f32 v[166:167], v[166:167], v[248:249]
    v_cvt_pk_bf16_f32 v67, v166, v167
    v_pk_mul_f32 v[168:169], v[168:169], v[252:253]
    v_cvt_pk_bf16_f32 v68, v168, v169
    v_pk_mul_f32 v[170:171], v[170:171], v[252:253]
    v_cvt_pk_bf16_f32 v69, v170, v171
    v_pk_mul_f32 v[172:173], v[172:173], v[252:253]
    v_cvt_pk_bf16_f32 v70, v172, v173
    v_pk_mul_f32 v[174:175], v[174:175], v[252:253]
    v_cvt_pk_bf16_f32 v71, v174, v175
    v_pk_mul_f32 v[176:177], v[176:177], v[248:249]
    v_cvt_pk_bf16_f32 v72, v176, v177
    v_pk_mul_f32 v[178:179], v[178:179], v[248:249]
    v_cvt_pk_bf16_f32 v73, v178, v179
    v_pk_mul_f32 v[180:181], v[180:181], v[248:249]
    v_cvt_pk_bf16_f32 v74, v180, v181
    v_pk_mul_f32 v[182:183], v[182:183], v[248:249]
    v_cvt_pk_bf16_f32 v75, v182, v183
    v_pk_mul_f32 v[184:185], v[184:185], v[252:253]
    v_cvt_pk_bf16_f32 v76, v184, v185
    v_pk_mul_f32 v[186:187], v[186:187], v[252:253]
    v_cvt_pk_bf16_f32 v77, v186, v187
    v_pk_mul_f32 v[188:189], v[188:189], v[252:253]
    v_cvt_pk_bf16_f32 v78, v188, v189
    v_pk_mul_f32 v[190:191], v[190:191], v[252:253]
    v_cvt_pk_bf16_f32 v79, v190, v191
    v_pk_mul_f32 v[192:193], v[192:193], v[248:249]
    v_cvt_pk_bf16_f32 v80, v192, v193
    v_pk_mul_f32 v[194:195], v[194:195], v[248:249]
    v_cvt_pk_bf16_f32 v81, v194, v195
    v_pk_mul_f32 v[196:197], v[196:197], v[248:249]
    v_cvt_pk_bf16_f32 v82, v196, v197
    v_pk_mul_f32 v[198:199], v[198:199], v[248:249]
    v_cvt_pk_bf16_f32 v83, v198, v199
    v_pk_mul_f32 v[200:201], v[200:201], v[252:253]
    v_cvt_pk_bf16_f32 v84, v200, v201
    v_pk_mul_f32 v[202:203], v[202:203], v[252:253]
    v_cvt_pk_bf16_f32 v85, v202, v203
    v_pk_mul_f32 v[204:205], v[204:205], v[252:253]
    v_cvt_pk_bf16_f32 v86, v204, v205
    v_pk_mul_f32 v[206:207], v[206:207], v[252:253]
    v_cvt_pk_bf16_f32 v87, v206, v207
    v_pk_mul_f32 v[208:209], v[208:209], v[248:249]
    v_cvt_pk_bf16_f32 v88, v208, v209
    v_pk_mul_f32 v[210:211], v[210:211], v[248:249]
    v_cvt_pk_bf16_f32 v89, v210, v211
    v_pk_mul_f32 v[212:213], v[212:213], v[248:249]
    v_cvt_pk_bf16_f32 v90, v212, v213
    v_pk_mul_f32 v[214:215], v[214:215], v[248:249]
    v_cvt_pk_bf16_f32 v91, v214, v215
    v_pk_mul_f32 v[216:217], v[216:217], v[252:253]
    v_cvt_pk_bf16_f32 v92, v216, v217
    v_pk_mul_f32 v[218:219], v[218:219], v[252:253]
    v_cvt_pk_bf16_f32 v93, v218, v219
    v_pk_mul_f32 v[220:221], v[220:221], v[252:253]
    v_cvt_pk_bf16_f32 v94, v220, v221
    v_pk_mul_f32 v[222:223], v[222:223], v[252:253]
    v_cvt_pk_bf16_f32 v95, v222, v223
    s_cmp_eq_u32 s41, 3
    s_cbranch_scc1 L_94
    s_lshr_b32 s48, s42, 7
    s_add_u32 s48, s48, 0
    v_lshrrev_b32 v24, 3, v0
    v_add_u32 v24, s48, v24
    v_mul_u32_u24 v25, 43, v24
    v_lshrrev_b32 v25, 7, v25
    v_mul_u32_u24 v26, 1280, v24
    v_lshrrev_b32 v25, 3, v0
    v_and_b32 v25, 6, v25
    v_xor_b32 v25, v25, v0
    v_and_b32 v25, 7, v25
    v_lshlrev_b32 v25, 4, v25
    v_add_u32 v26, v26, v25
    v_subrev_u32 v2, 0, v26
    s_lshr_b32 s48, s42, 7
    s_add_u32 s48, s48, 8
    v_lshrrev_b32 v24, 3, v0
    v_add_u32 v24, s48, v24
    v_mul_u32_u24 v25, 43, v24
    v_lshrrev_b32 v25, 7, v25
    v_mul_u32_u24 v26, 1280, v24
    v_lshrrev_b32 v25, 3, v0
    v_and_b32 v25, 6, v25
    v_xor_b32 v25, v25, v0
    v_and_b32 v25, 7, v25
    v_lshlrev_b32 v25, 4, v25
    v_add_u32 v26, v26, v25
    v_subrev_u32 v3, 1024, v26
    s_branch L_95
L_94:
    s_lshr_b32 s48, s55, 4
    s_lshl_b32 s48, s48, 2
    v_mov_b32 v11, 0
    buffer_load_dword v10, v11, s[20:23], s48 offen offset:0 sc1
L_95:
L_92:
    s_bitcmp1_b32 s32, 0
    s_cbranch_scc0 L_96
    v_add_u32 v5, 122880, v14
    v_xor_b32 v6, 32, v5
    v_xor_b32 v7, 64, v5
    v_xor_b32 v8, 96, v5
    ds_read_b64_tr_b16 v[24:25], v5 offset:0
    ds_read_b64_tr_b16 v[26:27], v5 offset:2048
    ds_read_b64_tr_b16 v[28:29], v5 offset:4096
    ds_read_b64_tr_b16 v[30:31], v5 offset:6144
    ds_read_b64_tr_b16 v[32:33], v5 offset:8192
    ds_read_b64_tr_b16 v[34:35], v5 offset:10240
    s_waitcnt lgkmcnt(4)
    v_mfma_f32_16x16x32_bf16 v[96:99], v[24:27], v[48:51], 0
    ds_read_b64_tr_b16 v[36:37], v5 offset:12288
    s_waitcnt lgkmcnt(3)
    v_mfma_f32_16x16x32_bf16 v[96:99], v[28:31], v[56:59], v[96:99]
    ds_read_b64_tr_b16 v[38:39], v5 offset:14336
    v_mfma_f32_16x16x32_bf16 v[104:107], v[28:31], v[60:63], 0
    ds_read_b64_tr_b16 v[40:41], v5 offset:16384
    v_mfma_f32_16x16x32_bf16 v[104:107], v[24:27], v[52:55], v[104:107]
    ds_read_b64_tr_b16 v[42:43], v5 offset:18432
    s_waitcnt lgkmcnt(4)
    v_mfma_f32_16x16x32_bf16 v[104:107], v[32:35], v[68:71], v[104:107]
    ds_read_b64_tr_b16 v[24:25], v5 offset:20480
    s_waitcnt lgkmcnt(3)
    v_mfma_f32_16x16x32_bf16 v[104:107], v[36:39], v[76:79], v[104:107]
    ds_read_b64_tr_b16 v[26:27], v5 offset:22528
    v_mfma_f32_16x16x32_bf16 v[96:99], v[36:39], v[72:75], v[96:99]
    ds_read_b64_tr_b16 v[28:29], v6 offset:0
    v_mfma_f32_16x16x32_bf16 v[96:99], v[32:35], v[64:67], v[96:99]
    ds_read_b64_tr_b16 v[30:31], v6 offset:2048
    s_waitcnt lgkmcnt(4)
    v_mfma_f32_16x16x32_bf16 v[96:99], v[40:43], v[80:83], v[96:99]
    ds_read_b64_tr_b16 v[32:33], v6 offset:4096
    s_waitcnt lgkmcnt(3)
    v_mfma_f32_16x16x32_bf16 v[96:99], v[24:27], v[88:91], v[96:99]
    ds_read_b64_tr_b16 v[34:35], v6 offset:6144
    v_mfma_f32_16x16x32_bf16 v[104:107], v[24:27], v[92:95], v[104:107]
    ds_read_b64_tr_b16 v[36:37], v6 offset:8192
    v_mfma_f32_16x16x32_bf16 v[104:107], v[40:43], v[84:87], v[104:107]
    ds_read_b64_tr_b16 v[38:39], v6 offset:10240
    s_waitcnt lgkmcnt(4)
    v_mfma_f32_16x16x32_bf16 v[108:111], v[28:31], v[52:55], 0
    ds_read_b64_tr_b16 v[40:41], v6 offset:12288
    s_waitcnt lgkmcnt(3)
    v_mfma_f32_16x16x32_bf16 v[108:111], v[32:35], v[60:63], v[108:111]
    ds_read_b64_tr_b16 v[42:43], v6 offset:14336
    v_mfma_f32_16x16x32_bf16 v[100:103], v[32:35], v[56:59], 0
    ds_read_b64_tr_b16 v[24:25], v6 offset:16384
    v_mfma_f32_16x16x32_bf16 v[100:103], v[28:31], v[48:51], v[100:103]
    ds_read_b64_tr_b16 v[26:27], v6 offset:18432
    s_waitcnt lgkmcnt(4)
    v_mfma_f32_16x16x32_bf16 v[100:103], v[36:39], v[64:67], v[100:103]
    ds_read_b64_tr_b16 v[28:29], v6 offset:20480
    s_waitcnt lgkmcnt(3)
    v_mfma_f32_16x16x32_bf16 v[100:103], v[40:43], v[72:75], v[100:103]
    ds_read_b64_tr_b16 v[30:31], v6 offset:22528
    v_mfma_f32_16x16x32_bf16 v[108:111], v[40:43], v[76:79], v[108:111]
    ds_read_b64_tr_b16 v[32:33], v7 offset:0
    v_mfma_f32_16x16x32_bf16 v[108:111], v[36:39], v[68:71], v[108:111]
    ds_read_b64_tr_b16 v[34:35], v7 offset:2048
    s_waitcnt lgkmcnt(4)
    v_mfma_f32_16x16x32_bf16 v[108:111], v[24:27], v[84:87], v[108:111]
    ds_read_b64_tr_b16 v[36:37], v7 offset:4096
    s_waitcnt lgkmcnt(3)
    v_mfma_f32_16x16x32_bf16 v[108:111], v[28:31], v[92:95], v[108:111]
    ds_read_b64_tr_b16 v[38:39], v7 offset:6144
    v_mfma_f32_16x16x32_bf16 v[100:103], v[28:31], v[88:91], v[100:103]
    ds_read_b64_tr_b16 v[40:41], v7 offset:8192
    v_mfma_f32_16x16x32_bf16 v[100:103], v[24:27], v[80:83], v[100:103]
    ds_read_b64_tr_b16 v[42:43], v7 offset:10240
    s_waitcnt lgkmcnt(4)
    v_mfma_f32_16x16x32_bf16 v[112:115], v[32:35], v[48:51], 0
    ds_read_b64_tr_b16 v[24:25], v7 offset:12288
    s_waitcnt lgkmcnt(3)
    v_mfma_f32_16x16x32_bf16 v[112:115], v[36:39], v[56:59], v[112:115]
    ds_read_b64_tr_b16 v[26:27], v7 offset:14336
    v_mfma_f32_16x16x32_bf16 v[120:123], v[36:39], v[60:63], 0
    ds_read_b64_tr_b16 v[28:29], v7 offset:16384
    v_mfma_f32_16x16x32_bf16 v[120:123], v[32:35], v[52:55], v[120:123]
    ds_read_b64_tr_b16 v[30:31], v7 offset:18432
    s_waitcnt lgkmcnt(4)
    v_mfma_f32_16x16x32_bf16 v[120:123], v[40:43], v[68:71], v[120:123]
    ds_read_b64_tr_b16 v[32:33], v7 offset:20480
    s_waitcnt lgkmcnt(3)
    v_mfma_f32_16x16x32_bf16 v[120:123], v[24:27], v[76:79], v[120:123]
    ds_read_b64_tr_b16 v[34:35], v7 offset:22528
    v_mfma_f32_16x16x32_bf16 v[112:115], v[24:27], v[72:75], v[112:115]
    ds_read_b64_tr_b16 v[36:37], v8 offset:0
    v_mfma_f32_16x16x32_bf16 v[112:115], v[40:43], v[64:67], v[112:115]
    ds_read_b64_tr_b16 v[38:39], v8 offset:2048
    s_waitcnt lgkmcnt(4)
    v_mfma_f32_16x16x32_bf16 v[112:115], v[28:31], v[80:83], v[112:115]
    ds_read_b64_tr_b16 v[40:41], v8 offset:4096
    s_waitcnt lgkmcnt(3)
    v_mfma_f32_16x16x32_bf16 v[112:115], v[32:35], v[88:91], v[112:115]
    ds_read_b64_tr_b16 v[42:43], v8 offset:6144
    v_mfma_f32_16x16x32_bf16 v[120:123], v[32:35], v[92:95], v[120:123]
    ds_read_b64_tr_b16 v[24:25], v8 offset:8192
    v_mfma_f32_16x16x32_bf16 v[120:123], v[28:31], v[84:87], v[120:123]
    ds_read_b64_tr_b16 v[26:27], v8 offset:10240
    s_waitcnt lgkmcnt(4)
    v_mfma_f32_16x16x32_bf16 v[124:127], v[36:39], v[52:55], 0
    ds_read_b64_tr_b16 v[28:29], v8 offset:12288
    s_waitcnt lgkmcnt(3)
    v_mfma_f32_16x16x32_bf16 v[124:127], v[40:43], v[60:63], v[124:127]
    ds_read_b64_tr_b16 v[30:31], v8 offset:14336
    v_mfma_f32_16x16x32_bf16 v[116:119], v[40:43], v[56:59], 0
    ds_read_b64_tr_b16 v[32:33], v8 offset:16384
    v_mfma_f32_16x16x32_bf16 v[116:119], v[36:39], v[48:51], v[116:119]
    ds_read_b64_tr_b16 v[34:35], v8 offset:18432
    s_waitcnt lgkmcnt(4)
    v_mfma_f32_16x16x32_bf16 v[116:119], v[24:27], v[64:67], v[116:119]
    ds_read_b64_tr_b16 v[36:37], v8 offset:20480
    s_waitcnt lgkmcnt(3)
    v_mfma_f32_16x16x32_bf16 v[116:119], v[28:31], v[72:75], v[116:119]
    ds_read_b64_tr_b16 v[38:39], v8 offset:22528
    v_mfma_f32_16x16x32_bf16 v[124:127], v[28:31], v[76:79], v[124:127]
    v_mfma_f32_16x16x32_bf16 v[124:127], v[24:27], v[68:71], v[124:127]
    s_waitcnt lgkmcnt(2)
    v_mfma_f32_16x16x32_bf16 v[124:127], v[32:35], v[84:87], v[124:127]
    s_waitcnt lgkmcnt(0)
    v_mfma_f32_16x16x32_bf16 v[124:127], v[36:39], v[92:95], v[124:127]
    v_mfma_f32_16x16x32_bf16 v[116:119], v[36:39], v[88:91], v[116:119]
    v_mfma_f32_16x16x32_bf16 v[116:119], v[32:35], v[80:83], v[116:119]
    s_cmp_eq_u32 s34, 0
    s_cbranch_scc0 L_99
    v_cvt_pk_bf16_f32 v16, v96, v97
    v_cvt_pk_bf16_f32 v17, v98, v99
    v_cvt_pk_bf16_f32 v18, v100, v101
    v_cvt_pk_bf16_f32 v19, v102, v103
    v_cvt_pk_bf16_f32 v20, v104, v105
    v_cvt_pk_bf16_f32 v21, v106, v107
    v_cvt_pk_bf16_f32 v22, v108, v109
    v_cvt_pk_bf16_f32 v23, v110, v111
    v_cvt_pk_bf16_f32 v112, v112, v113
    v_cvt_pk_bf16_f32 v113, v114, v115
    v_cvt_pk_bf16_f32 v114, v116, v117
    v_cvt_pk_bf16_f32 v115, v118, v119
    v_cvt_pk_bf16_f32 v116, v120, v121
    v_cvt_pk_bf16_f32 v117, v122, v123
    v_cvt_pk_bf16_f32 v118, v124, v125
    v_cvt_pk_bf16_f32 v119, v126, v127
    s_lshl_b32 s48, s41, 11
    s_add_u32 s48, s48, 147456
    v_add_u32 v44, s48, v15
    ds_write_b128 v44, v[112:115] offset:8192
    ds_write_b128 v44, v[116:119] offset:9216
    s_waitcnt lgkmcnt(0)
    s_branch L_98
L_99:
    s_cmp_eq_u32 s34, 1
    s_cbranch_scc0 L_100
    v_cvt_pk_bf16_f32 v128, v96, v97
    v_cvt_pk_bf16_f32 v129, v98, v99
    v_cvt_pk_bf16_f32 v130, v100, v101
    v_cvt_pk_bf16_f32 v131, v102, v103
    v_cvt_pk_bf16_f32 v132, v104, v105
    v_cvt_pk_bf16_f32 v133, v106, v107
    v_cvt_pk_bf16_f32 v134, v108, v109
    v_cvt_pk_bf16_f32 v135, v110, v111
    v_cvt_pk_bf16_f32 v136, v112, v113
    v_cvt_pk_bf16_f32 v137, v114, v115
    v_cvt_pk_bf16_f32 v138, v116, v117
    v_cvt_pk_bf16_f32 v139, v118, v119
    v_cvt_pk_bf16_f32 v140, v120, v121
    v_cvt_pk_bf16_f32 v141, v122, v123
    v_cvt_pk_bf16_f32 v142, v124, v125
    v_cvt_pk_bf16_f32 v143, v126, v127
    s_branch L_98
L_100:
    s_cmp_eq_u32 s34, 2
    s_cbranch_scc0 L_101
    v_cvt_pk_bf16_f32 v144, v96, v97
    v_cvt_pk_bf16_f32 v145, v98, v99
    v_cvt_pk_bf16_f32 v146, v100, v101
    v_cvt_pk_bf16_f32 v147, v102, v103
    v_cvt_pk_bf16_f32 v148, v104, v105
    v_cvt_pk_bf16_f32 v149, v106, v107
    v_cvt_pk_bf16_f32 v150, v108, v109
    v_cvt_pk_bf16_f32 v151, v110, v111
    v_cvt_pk_bf16_f32 v152, v112, v113
    v_cvt_pk_bf16_f32 v153, v114, v115
    v_cvt_pk_bf16_f32 v154, v116, v117
    v_cvt_pk_bf16_f32 v155, v118, v119
    v_cvt_pk_bf16_f32 v156, v120, v121
    v_cvt_pk_bf16_f32 v157, v122, v123
    v_cvt_pk_bf16_f32 v158, v124, v125
    v_cvt_pk_bf16_f32 v159, v126, v127
    s_branch L_98
L_101:
    s_cmp_eq_u32 s34, 3
    s_cbranch_scc0 L_102
    v_cvt_pk_bf16_f32 v160, v96, v97
    v_cvt_pk_bf16_f32 v161, v98, v99
    v_cvt_pk_bf16_f32 v162, v100, v101
    v_cvt_pk_bf16_f32 v163, v102, v103
    v_cvt_pk_bf16_f32 v164, v104, v105
    v_cvt_pk_bf16_f32 v165, v106, v107
    v_cvt_pk_bf16_f32 v166, v108, v109
    v_cvt_pk_bf16_f32 v167, v110, v111
    v_cvt_pk_bf16_f32 v168, v112, v113
    v_cvt_pk_bf16_f32 v169, v114, v115
    v_cvt_pk_bf16_f32 v170, v116, v117
    v_cvt_pk_bf16_f32 v171, v118, v119
    v_cvt_pk_bf16_f32 v172, v120, v121
    v_cvt_pk_bf16_f32 v173, v122, v123
    v_cvt_pk_bf16_f32 v174, v124, v125
    v_cvt_pk_bf16_f32 v175, v126, v127
    s_branch L_98
L_102:
    s_cmp_eq_u32 s34, 4
    s_cbranch_scc0 L_103
    v_cvt_pk_bf16_f32 v176, v96, v97
    v_cvt_pk_bf16_f32 v177, v98, v99
    v_cvt_pk_bf16_f32 v178, v100, v101
    v_cvt_pk_bf16_f32 v179, v102, v103
    v_cvt_pk_bf16_f32 v180, v104, v105
    v_cvt_pk_bf16_f32 v181, v106, v107
    v_cvt_pk_bf16_f32 v182, v108, v109
    v_cvt_pk_bf16_f32 v183, v110, v111
    v_cvt_pk_bf16_f32 v184, v112, v113
    v_cvt_pk_bf16_f32 v185, v114, v115
    v_cvt_pk_bf16_f32 v186, v116, v117
    v_cvt_pk_bf16_f32 v187, v118, v119
    v_cvt_pk_bf16_f32 v188, v120, v121
    v_cvt_pk_bf16_f32 v189, v122, v123
    v_cvt_pk_bf16_f32 v190, v124, v125
    v_cvt_pk_bf16_f32 v191, v126, v127
    s_branch L_98
L_103:
    s_cmp_eq_u32 s34, 5
    s_cbranch_scc0 L_104
    v_cvt_pk_bf16_f32 v192, v96, v97
    v_cvt_pk_bf16_f32 v193, v98, v99
    v_cvt_pk_bf16_f32 v194, v100, v101
    v_cvt_pk_bf16_f32 v195, v102, v103
    v_cvt_pk_bf16_f32 v196, v104, v105
    v_cvt_pk_bf16_f32 v197, v106, v107
    v_cvt_pk_bf16_f32 v198, v108, v109
    v_cvt_pk_bf16_f32 v199, v110, v111
    v_cvt_pk_bf16_f32 v200, v112, v113
    v_cvt_pk_bf16_f32 v201, v114, v115
    v_cvt_pk_bf16_f32 v202, v116, v117
    v_cvt_pk_bf16_f32 v203, v118, v119
    v_cvt_pk_bf16_f32 v204, v120, v121
    v_cvt_pk_bf16_f32 v205, v122, v123
    v_cvt_pk_bf16_f32 v206, v124, v125
    v_cvt_pk_bf16_f32 v207, v126, v127
    s_branch L_98
L_104:
    s_cmp_eq_u32 s34, 6
    s_cbranch_scc0 L_105
    v_cvt_pk_bf16_f32 v208, v96, v97
    v_cvt_pk_bf16_f32 v209, v98, v99
    v_cvt_pk_bf16_f32 v210, v100, v101
    v_cvt_pk_bf16_f32 v211, v102, v103
    v_cvt_pk_bf16_f32 v212, v104, v105
    v_cvt_pk_bf16_f32 v213, v106, v107
    v_cvt_pk_bf16_f32 v214, v108, v109
    v_cvt_pk_bf16_f32 v215, v110, v111
    v_cvt_pk_bf16_f32 v216, v112, v113
    v_cvt_pk_bf16_f32 v217, v114, v115
    v_cvt_pk_bf16_f32 v218, v116, v117
    v_cvt_pk_bf16_f32 v219, v118, v119
    v_cvt_pk_bf16_f32 v220, v120, v121
    v_cvt_pk_bf16_f32 v221, v122, v123
    v_cvt_pk_bf16_f32 v222, v124, v125
    v_cvt_pk_bf16_f32 v223, v126, v127
    s_branch L_98
L_105:
    s_cmp_eq_u32 s34, 7
    s_cbranch_scc0 L_106
    v_cvt_pk_bf16_f32 v224, v96, v97
    v_cvt_pk_bf16_f32 v225, v98, v99
    v_cvt_pk_bf16_f32 v226, v100, v101
    v_cvt_pk_bf16_f32 v227, v102, v103
    v_cvt_pk_bf16_f32 v228, v104, v105
    v_cvt_pk_bf16_f32 v229, v106, v107
    v_cvt_pk_bf16_f32 v230, v108, v109
    v_cvt_pk_bf16_f32 v231, v110, v111
    v_cvt_pk_bf16_f32 v232, v112, v113
    v_cvt_pk_bf16_f32 v233, v114, v115
    v_cvt_pk_bf16_f32 v234, v116, v117
    v_cvt_pk_bf16_f32 v235, v118, v119
    v_cvt_pk_bf16_f32 v236, v120, v121
    v_cvt_pk_bf16_f32 v237, v122, v123
    v_cvt_pk_bf16_f32 v238, v124, v125
    v_cvt_pk_bf16_f32 v239, v126, v127
    s_branch L_98
L_106:
    s_cmp_eq_u32 s34, 8
    s_cbranch_scc0 L_107
    v_cvt_pk_bf16_f32 v240, v96, v97
    v_cvt_pk_bf16_f32 v241, v98, v99
    v_cvt_pk_bf16_f32 v242, v100, v101
    v_cvt_pk_bf16_f32 v243, v102, v103
    v_cvt_pk_bf16_f32 v244, v104, v105
    v_cvt_pk_bf16_f32 v245, v106, v107
    v_cvt_pk_bf16_f32 v246, v108, v109
    v_cvt_pk_bf16_f32 v247, v110, v111
    v_cvt_pk_bf16_f32 v248, v112, v113
    v_cvt_pk_bf16_f32 v249, v114, v115
    v_cvt_pk_bf16_f32 v250, v116, v117
    v_cvt_pk_bf16_f32 v251, v118, v119
    v_cvt_pk_bf16_f32 v252, v120, v121
    v_cvt_pk_bf16_f32 v253, v122, v123
    v_cvt_pk_bf16_f32 v254, v124, v125
    v_cvt_pk_bf16_f32 v255, v126, v127
    s_branch L_98
L_107:
    v_cvt_pk_bf16_f32 v112, v112, v113
    v_cvt_pk_bf16_f32 v113, v114, v115
    v_cvt_pk_bf16_f32 v114, v116, v117
    v_cvt_pk_bf16_f32 v115, v118, v119
    v_cvt_pk_bf16_f32 v116, v120, v121
    v_cvt_pk_bf16_f32 v117, v122, v123
    v_cvt_pk_bf16_f32 v118, v124, v125
    v_cvt_pk_bf16_f32 v119, v126, v127
    s_lshl_b32 s48, s41, 11
    s_add_u32 s48, s48, 147456
    v_add_u32 v44, s48, v15
    ds_write_b128 v44, v[112:115] offset:0
    ds_write_b128 v44, v[116:119] offset:1024
    s_waitcnt lgkmcnt(0)
L_98:
    s_add_u32 s34, s34, 1
L_96:
    s_cmp_eq_u32 s41, 3
    s_cbranch_scc1 L_109
    s_waitcnt vmcnt(24)
    s_branch L_110
L_109:
    s_bitcmp1_b32 s32, 1
    s_cbranch_scc0 L_111
    s_waitcnt vmcnt(0)
L_111:
L_110:
    s_lshr_b32 s31, s31, 1
    s_lshr_b32 s32, s32, 1
    s_add_u32 s35, s35, 1
    s_cmp_lt_u32 s35, 32
    s_barrier
    s_cbranch_scc1 L_SIDE_A
L_P3:
    s_mul_i32 s48, s41, 12288
    s_add_u32 s54, s48, 122880
    s_add_u32 s48, s48, 24576
    s_cmp_lt_u32 s41, 2
    s_cselect_b32 s48, s54, s48
    v_add_u32 v45, s48, v15
    s_lshl_b32 s48, s41, 11
    s_add_u32 s48, s48, 147456
    v_add_u32 v44, s48, v15
    v_add_u32 v5, 73728, v14
    v_xor_b32 v6, 32, v5
    s_mov_b32 s42, 0
    s_lshr_b32 s48, s42, 7
    s_add_u32 s48, s48, 0
    v_lshrrev_b32 v24, 3, v0
    v_add_u32 v24, s48, v24
    v_mul_u32_u24 v25, 43, v24
    v_lshrrev_b32 v25, 7, v25
    v_mul_u32_u24 v26, 1280, v24
    v_lshrrev_b32 v25, 3, v0
    v_and_b32 v25, 6, v25
    v_xor_b32 v25, v25, v0
    v_and_b32 v25, 7, v25
    v_lshlrev_b32 v25, 4, v25
    v_add_u32 v26, v26, v25
    v_subrev_u32 v12, 0, v26
    s_lshr_b32 s48, s42, 7
    s_add_u32 s48, s48, 8
    v_lshrrev_b32 v24, 3, v0
    v_add_u32 v24, s48, v24
    v_mul_u32_u24 v25, 43, v24
    v_lshrrev_b32 v25, 7, v25
    v_mul_u32_u24 v26, 1280, v24
    v_lshrrev_b32 v25, 3, v0
    v_and_b32 v25, 6, v25
    v_xor_b32 v25, v25, v0
    v_and_b32 v25, 7, v25
    v_lshlrev_b32 v25, 4, v25
    v_add_u32 v26, v26, v25
    v_subrev_u32 v13, 1024, v26
    s_lshr_b32 s48, s42, 7
    s_add_u32 s48, s48, 16
    v_lshrrev_b32 v24, 3, v0
    v_add_u32 v24, s48, v24
    v_mul_u32_u24 v25, 43, v24
    v_lshrrev_b32 v25, 7, v25
    v_mul_u32_u24 v26, 1280, v24
    v_lshrrev_b32 v25, 3, v0
    v_and_b32 v25, 6, v25
    v_xor_b32 v25, v25, v0
    v_and_b32 v25, 7, v25
    v_lshlrev_b32 v25, 4, v25
    v_add_u32 v26, v26, v25
    v_subrev_u32 v4, 2048, v26
    s_mul_i32 s28, s40, 30720
    s_add_u32 s28, s28, 245760
    s_mul_i32 s29, s40, 3072
    s_lshl_b32 s34, s41, 2
    s_lshl_b32 s48, s52, 1
    s_add_u32 s34, s34, s48
    s_and_b32 s48, s55, 15
    s_sub_u32 s34, s48, s34
    s_barrier
    ds_read_b128 v[48:51], v45 offset:0
    ds_read_b128 v[52:55], v45 offset:1024
    ds_read_b128 v[56:59], v45 offset:2048
    ds_read_b128 v[60:63], v45 offset:3072
    ds_read_b128 v[64:67], v45 offset:4096
    ds_read_b128 v[68:71], v45 offset:5120
    ds_read_b128 v[72:75], v45 offset:6144
    ds_read_b128 v[76:79], v45 offset:7168
    ds_read_b128 v[80:83], v45 offset:8192
    ds_read_b128 v[84:87], v45 offset:9216
    ds_read_b128 v[88:91], v45 offset:10240
    ds_read_b128 v[92:95], v45 offset:11264
    ds_read_b64_tr_b16 v[24:25], v5 offset:0
    ds_read_b64_tr_b16 v[26:27], v5 offset:2048
    ds_read_b64_tr_b16 v[28:29], v5 offset:4096
    s_waitcnt lgkmcnt(14)
    ds_read_b64_tr_b16 v[30:31], v5 offset:6144
    s_waitcnt lgkmcnt(14)
    ds_read_b64_tr_b16 v[32:33], v5 offset:8192
    s_waitcnt lgkmcnt(14)
    ds_read_b64_tr_b16 v[34:35], v5 offset:10240
    s_waitcnt lgkmcnt(4)
    v_mfma_f32_16x16x32_bf16 v[96:99], v[24:27], v[48:51], v[96:99]
    ds_read_b64_tr_b16 v[36:37], v5 offset:12288
    s_waitcnt lgkmcnt(3)
    v_mfma_f32_16x16x32_bf16 v[96:99], v[28:31], v[56:59], v[96:99]
    ds_read_b64_tr_b16 v[38:39], v5 offset:14336
    s_waitcnt vmcnt(16)
    s_barrier
    ds_write_b128 v44, v[136:139] offset:0
    ds_write_b128 v44, v[140:143] offset:1024
    s_add_u32 s57, s56, 3
    s_sub_u32 s48, s57, 10
    s_cmp_ge_u32 s57, 10
    s_cselect_b32 s57, s48, s57
    s_mul_i32 s57, s57, 128
    s_add_u32 s57, s57, s45
    s_add_u32 s30, s57, s28
    s_add_u32 m0, s29, 49152
    v_mfma_f32_16x16x32_bf16 v[104:107], v[28:31], v[60:63], v[104:107]
    ds_read_b64_tr_b16 v[40:41], v5 offset:16384
    buffer_load_dwordx4 v12, s[16:19], s30 offen offset:0 lds
    v_mfma_f32_16x16x32_bf16 v[104:107], v[24:27], v[52:55], v[104:107]
    ds_read_b64_tr_b16 v[42:43], v5 offset:18432
    v_and_b32 v127, s53, v23
    s_waitcnt lgkmcnt(6)
    v_mfma_f32_16x16x32_bf16 v[104:107], v[32:35], v[68:71], v[104:107]
    ds_read_b64_tr_b16 v[24:25], v5 offset:20480
    buffer_load_dwordx4 v13, s[16:19], s30 offen offset:1024 lds
    v_lshlrev_b32 v126, 16, v23
    s_waitcnt lgkmcnt(5)
    v_mfma_f32_16x16x32_bf16 v[104:107], v[36:39], v[76:79], v[104:107]
    ds_read_b64_tr_b16 v[26:27], v5 offset:22528
    v_and_b32 v125, s53, v22
    v_mfma_f32_16x16x32_bf16 v[96:99], v[36:39], v[72:75], v[96:99]
    ds_read_b64_tr_b16 v[28:29], v6 offset:0
    buffer_load_dwordx4 v4, s[16:19], s30 offen offset:2048 lds
    v_lshlrev_b32 v124, 16, v22
    v_mfma_f32_16x16x32_bf16 v[96:99], v[32:35], v[64:67], v[96:99]
    ds_read_b64_tr_b16 v[30:31], v6 offset:2048
    v_and_b32 v123, s53, v21
    s_waitcnt lgkmcnt(4)
    v_mfma_f32_16x16x32_bf16 v[96:99], v[40:43], v[80:83], v[96:99]
    ds_read_b64_tr_b16 v[32:33], v6 offset:4096
    v_lshlrev_b32 v122, 16, v21
    s_waitcnt lgkmcnt(3)
    v_mfma_f32_16x16x32_bf16 v[96:99], v[24:27], v[88:91], v[96:99]
    ds_read_b64_tr_b16 v[34:35], v6 offset:6144
    v_mfma_f32_16x16x32_bf16 v[104:107], v[24:27], v[92:95], v[104:107]
    ds_read_b64_tr_b16 v[36:37], v6 offset:8192
    v_and_b32 v121, s53, v20
    v_mfma_f32_16x16x32_bf16 v[104:107], v[40:43], v[84:87], v[104:107]
    ds_read_b64_tr_b16 v[38:39], v6 offset:10240
    v_lshlrev_b32 v120, 16, v20
    s_waitcnt lgkmcnt(4)
    v_mfma_f32_16x16x32_bf16 v[108:111], v[28:31], v[52:55], v[108:111]
    ds_read_b64_tr_b16 v[40:41], v6 offset:12288
    v_and_b32 v119, s53, v19
    s_waitcnt lgkmcnt(3)
    v_mfma_f32_16x16x32_bf16 v[108:111], v[32:35], v[60:63], v[108:111]
    ds_read_b64_tr_b16 v[42:43], v6 offset:14336
    v_lshlrev_b32 v118, 16, v19
    v_mfma_f32_16x16x32_bf16 v[100:103], v[32:35], v[56:59], v[100:103]
    ds_read_b64_tr_b16 v[24:25], v6 offset:16384
    v_and_b32 v117, s53, v18
    v_mfma_f32_16x16x32_bf16 v[100:103], v[28:31], v[48:51], v[100:103]
    ds_read_b64_tr_b16 v[26:27], v6 offset:18432
    s_waitcnt lgkmcnt(4)
    v_mfma_f32_16x16x32_bf16 v[100:103], v[36:39], v[64:67], v[100:103]
    ds_read_b64_tr_b16 v[28:29], v6 offset:20480
    v_lshlrev_b32 v116, 16, v18
    s_waitcnt lgkmcnt(3)
    v_mfma_f32_16x16x32_bf16 v[100:103], v[40:43], v[72:75], v[100:103]
    ds_read_b64_tr_b16 v[30:31], v6 offset:22528
    v_and_b32 v115, s53, v17
    v_mfma_f32_16x16x32_bf16 v[108:111], v[40:43], v[76:79], v[108:111]
    v_add_u32 v5, 98304, v14
    v_xor_b32 v6, 32, v5
    ds_read_b64_tr_b16 v[32:33], v5 offset:0
    v_lshlrev_b32 v114, 16, v17
    v_mfma_f32_16x16x32_bf16 v[108:111], v[36:39], v[68:71], v[108:111]
    ds_read_b64_tr_b16 v[34:35], v5 offset:2048
    v_and_b32 v113, s53, v16
    s_waitcnt lgkmcnt(4)
    v_mfma_f32_16x16x32_bf16 v[108:111], v[24:27], v[84:87], v[108:111]
    ds_read_b64_tr_b16 v[36:37], v5 offset:4096
    v_lshlrev_b32 v112, 16, v16
    s_waitcnt lgkmcnt(3)
    v_mfma_f32_16x16x32_bf16 v[108:111], v[28:31], v[92:95], v[108:111]
    ds_read_b64_tr_b16 v[38:39], v5 offset:6144
    v_mfma_f32_16x16x32_bf16 v[100:103], v[28:31], v[88:91], v[100:103]
    ds_read_b64_tr_b16 v[40:41], v5 offset:8192
    v_mfma_f32_16x16x32_bf16 v[100:103], v[24:27], v[80:83], v[100:103]
    ds_read_b64_tr_b16 v[42:43], v5 offset:10240
    s_waitcnt lgkmcnt(4)
    v_mfma_f32_16x16x32_bf16 v[112:115], v[32:35], v[48:51], v[112:115]
    ds_read_b64_tr_b16 v[24:25], v5 offset:12288
    s_waitcnt lgkmcnt(3)
    v_mfma_f32_16x16x32_bf16 v[112:115], v[36:39], v[56:59], v[112:115]
    ds_read_b64_tr_b16 v[26:27], v5 offset:14336
    s_waitcnt vmcnt(11)
    s_barrier
    ds_write_b128 v44, v[152:155] offset:8192
    ds_write_b128 v44, v[156:159] offset:9216
    s_add_u32 s57, s56, 4
    s_sub_u32 s48, s57, 10
    s_cmp_ge_u32 s57, 10
    s_cselect_b32 s57, s48, s57
    s_mul_i32 s57, s57, 128
    s_add_u32 s57, s57, s45
    s_add_u32 s30, s57, s28
    s_add_u32 m0, s29, 73728
    v_mfma_f32_16x16x32_bf16 v[120:123], v[36:39], v[60:63], v[120:123]
    ds_read_b64_tr_b16 v[28:29], v5 offset:16384
    buffer_load_dwordx4 v12, s[16:19], s30 offen offset:0 lds
    v_mfma_f32_16x16x32_bf16 v[120:123], v[32:35], v[52:55], v[120:123]
    ds_read_b64_tr_b16 v[30:31], v5 offset:18432
    v_cvt_pk_bf16_f32 v96, v96, v97
    v_cvt_pk_bf16_f32 v97, v98, v99
    s_waitcnt lgkmcnt(6)
    v_mfma_f32_16x16x32_bf16 v[120:123], v[40:43], v[68:71], v[120:123]
    ds_read_b64_tr_b16 v[32:33], v5 offset:20480
    buffer_load_dwordx4 v13, s[16:19], s30 offen offset:1024 lds
    v_cvt_pk_bf16_f32 v98, v100, v101
    s_waitcnt lgkmcnt(5)
    v_mfma_f32_16x16x32_bf16 v[120:123], v[24:27], v[76:79], v[120:123]
    ds_read_b64_tr_b16 v[34:35], v5 offset:22528
    s_add_u32 s57, s56, 9
    s_sub_u32 s48, s57, 10
    s_cmp_ge_u32 s57, 10
    s_cselect_b32 s57, s48, s57
    s_mul_i32 s57, s57, 16384
    s_add_u32 s57, s57, s47
    v_cvt_pk_bf16_f32 v99, v102, v103
    v_mfma_f32_16x16x32_bf16 v[112:115], v[24:27], v[72:75], v[112:115]
    ds_read_b64_tr_b16 v[36:37], v6 offset:0
    buffer_load_dwordx4 v4, s[16:19], s30 offen offset:2048 lds
    v_cvt_pk_bf16_f32 v100, v104, v105
    v_mfma_f32_16x16x32_bf16 v[112:115], v[40:43], v[64:67], v[112:115]
    ds_read_b64_tr_b16 v[38:39], v6 offset:2048
    v_cvt_pk_bf16_f32 v101, v106, v107
    v_cvt_pk_bf16_f32 v102, v108, v109
    s_waitcnt lgkmcnt(4)
    v_mfma_f32_16x16x32_bf16 v[112:115], v[28:31], v[80:83], v[112:115]
    ds_read_b64_tr_b16 v[40:41], v6 offset:4096
    v_cvt_pk_bf16_f32 v103, v110, v111
    s_waitcnt lgkmcnt(3)
    v_mfma_f32_16x16x32_bf16 v[112:115], v[32:35], v[88:91], v[112:115]
    ds_read_b64_tr_b16 v[42:43], v6 offset:6144
    s_mov_b32 s48, s57
    s_cmp_eq_u32 s34, 0
    s_cbranch_scc0 L_113
    s_sub_u32 s48, s57, s47
    s_lshr_b32 s48, s48, 4
    v_add_u32 v45, s48, v15
    v_add_u32 v45, 123904, v45
    ds_write_b128 v45, v[96:99]
    s_mov_b32 s48, 0x40000000
L_113:
    buffer_store_dwordx4 v[96:99], v15, s[24:27], s48 offen offset:0 sc1
    v_mfma_f32_16x16x32_bf16 v[120:123], v[32:35], v[92:95], v[120:123]
    ds_read_b64_tr_b16 v[24:25], v6 offset:8192
    s_mov_b32 s48, s57
    s_cmp_eq_u32 s34, 1
    s_cbranch_scc0 L_115
    s_sub_u32 s48, s57, s47
    s_lshr_b32 s48, s48, 4
    v_add_u32 v45, s48, v15
    v_add_u32 v45, 123904, v45
    ds_write_b128 v45, v[100:103]
    s_mov_b32 s48, 0x40000000
L_115:
    buffer_store_dwordx4 v[100:103], v15, s[24:27], s48 offen offset:1024 sc1
    v_and_b32 v111, s53, v135
    v_mfma_f32_16x16x32_bf16 v[120:123], v[28:31], v[84:87], v[120:123]
    ds_read_b64_tr_b16 v[26:27], v6 offset:10240
    v_lshlrev_b32 v110, 16, v135
    s_waitcnt lgkmcnt(4)
    v_mfma_f32_16x16x32_bf16 v[124:127], v[36:39], v[52:55], v[124:127]
    ds_read_b64_tr_b16 v[28:29], v6 offset:12288
    v_and_b32 v109, s53, v134
    v_lshlrev_b32 v108, 16, v134
    s_waitcnt lgkmcnt(3)
    v_mfma_f32_16x16x32_bf16 v[124:127], v[40:43], v[60:63], v[124:127]
    ds_read_b64_tr_b16 v[30:31], v6 offset:14336
    v_and_b32 v107, s53, v133
    v_mfma_f32_16x16x32_bf16 v[116:119], v[40:43], v[56:59], v[116:119]
    ds_read_b64_tr_b16 v[32:33], v6 offset:16384
    v_lshlrev_b32 v106, 16, v133
    v_and_b32 v105, s53, v132
    v_mfma_f32_16x16x32_bf16 v[116:119], v[36:39], v[48:51], v[116:119]
    ds_read_b64_tr_b16 v[34:35], v6 offset:18432
    v_lshlrev_b32 v104, 16, v132
    s_waitcnt lgkmcnt(4)
    v_mfma_f32_16x16x32_bf16 v[116:119], v[24:27], v[64:67], v[116:119]
    ds_read_b64_tr_b16 v[36:37], v6 offset:20480
    v_and_b32 v103, s53, v131
    s_waitcnt lgkmcnt(3)
    v_mfma_f32_16x16x32_bf16 v[116:119], v[28:31], v[72:75], v[116:119]
    ds_read_b64_tr_b16 v[38:39], v6 offset:22528
    v_lshlrev_b32 v102, 16, v131
    v_and_b32 v101, s53, v130
    v_mfma_f32_16x16x32_bf16 v[124:127], v[28:31], v[76:79], v[124:127]
    v_add_u32 v5, 0, v14
    v_xor_b32 v6, 32, v5
    ds_read_b64_tr_b16 v[40:41], v5 offset:0
    v_lshlrev_b32 v100, 16, v130
    v_mfma_f32_16x16x32_bf16 v[124:127], v[24:27], v[68:71], v[124:127]
    ds_read_b64_tr_b16 v[42:43], v5 offset:2048
    v_and_b32 v99, s53, v129
    v_lshlrev_b32 v98, 16, v129
    s_waitcnt lgkmcnt(4)
    v_mfma_f32_16x16x32_bf16 v[124:127], v[32:35], v[84:87], v[124:127]
    ds_read_b64_tr_b16 v[24:25], v5 offset:4096
    v_and_b32 v97, s53, v128
    s_waitcnt lgkmcnt(3)
    v_mfma_f32_16x16x32_bf16 v[124:127], v[36:39], v[92:95], v[124:127]
    ds_read_b64_tr_b16 v[26:27], v5 offset:6144
    v_lshlrev_b32 v96, 16, v128
    v_mfma_f32_16x16x32_bf16 v[116:119], v[36:39], v[88:91], v[116:119]
    ds_read_b64_tr_b16 v[28:29], v5 offset:8192
    v_mfma_f32_16x16x32_bf16 v[116:119], v[32:35], v[80:83], v[116:119]
    ds_read_b64_tr_b16 v[30:31], v5 offset:10240
    s_waitcnt lgkmcnt(4)
    v_mfma_f32_16x16x32_bf16 v[96:99], v[40:43], v[48:51], v[96:99]
    ds_read_b64_tr_b16 v[32:33], v5 offset:12288
    s_waitcnt lgkmcnt(3)
    v_mfma_f32_16x16x32_bf16 v[96:99], v[24:27], v[56:59], v[96:99]
    ds_read_b64_tr_b16 v[34:35], v5 offset:14336
    s_waitcnt vmcnt(8)
    s_barrier
    ds_write_b128 v44, v[168:171] offset:0
    ds_write_b128 v44, v[172:175] offset:1024
    s_add_u32 s57, s56, 5
    s_sub_u32 s48, s57, 10
    s_cmp_ge_u32 s57, 10
    s_cselect_b32 s57, s48, s57
    s_mul_i32 s57, s57, 128
    s_add_u32 s57, s57, s45
    s_add_u32 s30, s57, s28
    s_add_u32 m0, s29, 98304
    v_mfma_f32_16x16x32_bf16 v[104:107], v[24:27], v[60:63], v[104:107]
    ds_read_b64_tr_b16 v[36:37], v5 offset:16384
    buffer_load_dwordx4 v12, s[16:19], s30 offen offset:0 lds
    v_mfma_f32_16x16x32_bf16 v[104:107], v[40:43], v[52:55], v[104:107]
    ds_read_b64_tr_b16 v[38:39], v5 offset:18432
    v_cvt_pk_bf16_f32 v112, v112, v113
    v_cvt_pk_bf16_f32 v113, v114, v115
    s_waitcnt lgkmcnt(6)
    v_mfma_f32_16x16x32_bf16 v[104:107], v[28:31], v[68:71], v[104:107]
    ds_read_b64_tr_b16 v[40:41], v5 offset:20480
    buffer_load_dwordx4 v13, s[16:19], s30 offen offset:1024 lds
    v_cvt_pk_bf16_f32 v114, v116, v117
    s_waitcnt lgkmcnt(5)
    v_mfma_f32_16x16x32_bf16 v[104:107], v[32:35], v[76:79], v[104:107]
    ds_read_b64_tr_b16 v[42:43], v5 offset:22528
    s_add_u32 s57, s56, 0
    s_sub_u32 s48, s57, 10
    s_cmp_ge_u32 s57, 10
    s_cselect_b32 s57, s48, s57
    s_mul_i32 s57, s57, 16384
    s_add_u32 s57, s57, s47
    v_cvt_pk_bf16_f32 v115, v118, v119
    v_mfma_f32_16x16x32_bf16 v[96:99], v[32:35], v[72:75], v[96:99]
    ds_read_b64_tr_b16 v[24:25], v6 offset:0
    buffer_load_dwordx4 v4, s[16:19], s30 offen offset:2048 lds
    v_cvt_pk_bf16_f32 v116, v120, v121
    v_mfma_f32_16x16x32_bf16 v[96:99], v[28:31], v[64:67], v[96:99]
    ds_read_b64_tr_b16 v[26:27], v6 offset:2048
    v_cvt_pk_bf16_f32 v117, v122, v123
    v_cvt_pk_bf16_f32 v118, v124, v125
    s_waitcnt lgkmcnt(4)
    v_mfma_f32_16x16x32_bf16 v[96:99], v[36:39], v[80:83], v[96:99]
    ds_read_b64_tr_b16 v[28:29], v6 offset:4096
    v_cvt_pk_bf16_f32 v119, v126, v127
    s_waitcnt lgkmcnt(3)
    v_mfma_f32_16x16x32_bf16 v[96:99], v[40:43], v[88:91], v[96:99]
    ds_read_b64_tr_b16 v[30:31], v6 offset:6144
    s_mov_b32 s48, s57
    s_cmp_eq_u32 s34, 0
    s_cbranch_scc0 L_117
    s_sub_u32 s48, s57, s47
    s_lshr_b32 s48, s48, 4
    v_add_u32 v45, s48, v15
    v_add_u32 v45, 123904, v45
    ds_write_b128 v45, v[112:115]
    s_mov_b32 s48, 0x40000000
L_117:
    buffer_store_dwordx4 v[112:115], v15, s[24:27], s48 offen offset:0 sc1
    v_mfma_f32_16x16x32_bf16 v[104:107], v[40:43], v[92:95], v[104:107]
    ds_read_b64_tr_b16 v[32:33], v6 offset:8192
    s_mov_b32 s48, s57
    s_cmp_eq_u32 s34, 1
    s_cbranch_scc0 L_119
    s_sub_u32 s48, s57, s47
    s_lshr_b32 s48, s48, 4
    v_add_u32 v45, s48, v15
    v_add_u32 v45, 123904, v45
    ds_write_b128 v45, v[116:119]
    s_mov_b32 s48, 0x40000000
L_119:
    buffer_store_dwordx4 v[116:119], v15, s[24:27], s48 offen offset:1024 sc1
    v_and_b32 v127, s53, v151
    v_mfma_f32_16x16x32_bf16 v[104:107], v[36:39], v[84:87], v[104:107]
    ds_read_b64_tr_b16 v[34:35], v6 offset:10240
    v_lshlrev_b32 v126, 16, v151
    s_waitcnt lgkmcnt(4)
    v_mfma_f32_16x16x32_bf16 v[108:111], v[24:27], v[52:55], v[108:111]
    ds_read_b64_tr_b16 v[36:37], v6 offset:12288
    v_and_b32 v125, s53, v150
    v_lshlrev_b32 v124, 16, v150
    s_waitcnt lgkmcnt(3)
    v_mfma_f32_16x16x32_bf16 v[108:111], v[28:31], v[60:63], v[108:111]
    ds_read_b64_tr_b16 v[38:39], v6 offset:14336
    v_and_b32 v123, s53, v149
    v_mfma_f32_16x16x32_bf16 v[100:103], v[28:31], v[56:59], v[100:103]
    ds_read_b64_tr_b16 v[40:41], v6 offset:16384
    v_lshlrev_b32 v122, 16, v149
    v_and_b32 v121, s53, v148
    v_mfma_f32_16x16x32_bf16 v[100:103], v[24:27], v[48:51], v[100:103]
    ds_read_b64_tr_b16 v[42:43], v6 offset:18432
    v_lshlrev_b32 v120, 16, v148
    s_waitcnt lgkmcnt(4)
    v_mfma_f32_16x16x32_bf16 v[100:103], v[32:35], v[64:67], v[100:103]
    ds_read_b64_tr_b16 v[24:25], v6 offset:20480
    v_and_b32 v119, s53, v147
    s_waitcnt lgkmcnt(3)
    v_mfma_f32_16x16x32_bf16 v[100:103], v[36:39], v[72:75], v[100:103]
    ds_read_b64_tr_b16 v[26:27], v6 offset:22528
    v_lshlrev_b32 v118, 16, v147
    v_and_b32 v117, s53, v146
    v_mfma_f32_16x16x32_bf16 v[108:111], v[36:39], v[76:79], v[108:111]
    v_add_u32 v5, 24576, v14
    v_xor_b32 v6, 32, v5
    ds_read_b64_tr_b16 v[28:29], v5 offset:0
    v_lshlrev_b32 v116, 16, v146
    v_mfma_f32_16x16x32_bf16 v[108:111], v[32:35], v[68:71], v[108:111]
    ds_read_b64_tr_b16 v[30:31], v5 offset:2048
    v_and_b32 v115, s53, v145
    v_lshlrev_b32 v114, 16, v145
    s_waitcnt lgkmcnt(4)
    v_mfma_f32_16x16x32_bf16 v[108:111], v[40:43], v[84:87], v[108:111]
    ds_read_b64_tr_b16 v[32:33], v5 offset:4096
    v_and_b32 v113, s53, v144
    s_waitcnt lgkmcnt(3)
    v_mfma_f32_16x16x32_bf16 v[108:111], v[24:27], v[92:95], v[108:111]
    ds_read_b64_tr_b16 v[34:35], v5 offset:6144
    v_lshlrev_b32 v112, 16, v144
    v_mfma_f32_16x16x32_bf16 v[100:103], v[24:27], v[88:91], v[100:103]
    ds_read_b64_tr_b16 v[36:37], v5 offset:8192
    v_mfma_f32_16x16x32_bf16 v[100:103], v[40:43], v[80:83], v[100:103]
    ds_read_b64_tr_b16 v[38:39], v5 offset:10240
    s_waitcnt lgkmcnt(4)
    v_mfma_f32_16x16x32_bf16 v[112:115], v[28:31], v[48:51], v[112:115]
    ds_read_b64_tr_b16 v[40:41], v5 offset:12288
    s_waitcnt lgkmcnt(3)
    v_mfma_f32_16x16x32_bf16 v[112:115], v[32:35], v[56:59], v[112:115]
    ds_read_b64_tr_b16 v[42:43], v5 offset:14336
    s_waitcnt vmcnt(10)
    s_barrier
    ds_write_b128 v44, v[184:187] offset:8192
    ds_write_b128 v44, v[188:191] offset:9216
    s_add_u32 s57, s56, 6
    s_sub_u32 s48, s57, 10
    s_cmp_ge_u32 s57, 10
    s_cselect_b32 s57, s48, s57
    s_mul_i32 s57, s57, 128
    s_add_u32 s57, s57, s45
    s_add_u32 s30, s57, s28
    s_add_u32 m0, s29, 0
    v_mfma_f32_16x16x32_bf16 v[120:123], v[32:35], v[60:63], v[120:123]
    ds_read_b64_tr_b16 v[24:25], v5 offset:16384
    buffer_load_dwordx4 v12, s[16:19], s30 offen offset:0 lds
    v_mfma_f32_16x16x32_bf16 v[120:123], v[28:31], v[52:55], v[120:123]
    ds_read_b64_tr_b16 v[26:27], v5 offset:18432
    v_cvt_pk_bf16_f32 v96, v96, v97
    v_cvt_pk_bf16_f32 v97, v98, v99
    s_waitcnt lgkmcnt(6)
    v_mfma_f32_16x16x32_bf16 v[120:123], v[36:39], v[68:71], v[120:123]
    ds_read_b64_tr_b16 v[28:29], v5 offset:20480
    buffer_load_dwordx4 v13, s[16:19], s30 offen offset:1024 lds
    v_cvt_pk_bf16_f32 v98, v100, v101
    s_waitcnt lgkmcnt(5)
    v_mfma_f32_16x16x32_bf16 v[120:123], v[40:43], v[76:79], v[120:123]
    ds_read_b64_tr_b16 v[30:31], v5 offset:22528
    s_add_u32 s57, s56, 1
    s_sub_u32 s48, s57, 10
    s_cmp_ge_u32 s57, 10
    s_cselect_b32 s57, s48, s57
    s_mul_i32 s57, s57, 16384
    s_add_u32 s57, s57, s47
    v_cvt_pk_bf16_f32 v99, v102, v103
    v_mfma_f32_16x16x32_bf16 v[112:115], v[40:43], v[72:75], v[112:115]
    ds_read_b64_tr_b16 v[32:33], v6 offset:0
    buffer_load_dwordx4 v4, s[16:19], s30 offen offset:2048 lds
    v_cvt_pk_bf16_f32 v100, v104, v105
    v_mfma_f32_16x16x32_bf16 v[112:115], v[36:39], v[64:67], v[112:115]
    ds_read_b64_tr_b16 v[34:35], v6 offset:2048
    v_cvt_pk_bf16_f32 v101, v106, v107
    v_cvt_pk_bf16_f32 v102, v108, v109
    s_waitcnt lgkmcnt(4)
    v_mfma_f32_16x16x32_bf16 v[112:115], v[24:27], v[80:83], v[112:115]
    ds_read_b64_tr_b16 v[36:37], v6 offset:4096
    v_cvt_pk_bf16_f32 v103, v110, v111
    s_waitcnt lgkmcnt(3)
    v_mfma_f32_16x16x32_bf16 v[112:115], v[28:31], v[88:91], v[112:115]
    ds_read_b64_tr_b16 v[38:39], v6 offset:6144
    s_mov_b32 s48, s57
    s_cmp_eq_u32 s34, 0
    s_cbranch_scc0 L_121
    s_sub_u32 s48, s57, s47
    s_lshr_b32 s48, s48, 4
    v_add_u32 v45, s48, v15
    v_add_u32 v45, 123904, v45
    ds_write_b128 v45, v[96:99]
    s_mov_b32 s48, 0x40000000
L_121:
    buffer_store_dwordx4 v[96:99], v15, s[24:27], s48 offen offset:0 sc1
    v_mfma_f32_16x16x32_bf16 v[120:123], v[28:31], v[92:95], v[120:123]
    ds_read_b64_tr_b16 v[40:41], v6 offset:8192
    s_mov_b32 s48, s57
    s_cmp_eq_u32 s34, 1
    s_cbranch_scc0 L_123
    s_sub_u32 s48, s57, s47
    s_lshr_b32 s48, s48, 4
    v_add_u32 v45, s48, v15
    v_add_u32 v45, 123904, v45
    ds_write_b128 v45, v[100:103]
    s_mov_b32 s48, 0x40000000
L_123:
    buffer_store_dwordx4 v[100:103], v15, s[24:27], s48 offen offset:1024 sc1
    v_and_b32 v111, s53, v167
    v_mfma_f32_16x16x32_bf16 v[120:123], v[24:27], v[84:87], v[120:123]
    ds_read_b64_tr_b16 v[42:43], v6 offset:10240
    v_lshlrev_b32 v110, 16, v167
    s_waitcnt lgkmcnt(4)
    v_mfma_f32_16x16x32_bf16 v[124:127], v[32:35], v[52:55], v[124:127]
    ds_read_b64_tr_b16 v[24:25], v6 offset:12288
    v_and_b32 v109, s53, v166
    v_lshlrev_b32 v108, 16, v166
    s_waitcnt lgkmcnt(3)
    v_mfma_f32_16x16x32_bf16 v[124:127], v[36:39], v[60:63], v[124:127]
    ds_read_b64_tr_b16 v[26:27], v6 offset:14336
    v_and_b32 v107, s53, v165
    v_mfma_f32_16x16x32_bf16 v[116:119], v[36:39], v[56:59], v[116:119]
    ds_read_b64_tr_b16 v[28:29], v6 offset:16384
    v_lshlrev_b32 v106, 16, v165
    v_and_b32 v105, s53, v164
    v_mfma_f32_16x16x32_bf16 v[116:119], v[32:35], v[48:51], v[116:119]
    ds_read_b64_tr_b16 v[30:31], v6 offset:18432
    v_lshlrev_b32 v104, 16, v164
    s_waitcnt lgkmcnt(4)
    v_mfma_f32_16x16x32_bf16 v[116:119], v[40:43], v[64:67], v[116:119]
    ds_read_b64_tr_b16 v[32:33], v6 offset:20480
    v_and_b32 v103, s53, v163
    s_waitcnt lgkmcnt(3)
    v_mfma_f32_16x16x32_bf16 v[116:119], v[24:27], v[72:75], v[116:119]
    ds_read_b64_tr_b16 v[34:35], v6 offset:22528
    v_lshlrev_b32 v102, 16, v163
    v_and_b32 v101, s53, v162
    v_mfma_f32_16x16x32_bf16 v[124:127], v[24:27], v[76:79], v[124:127]
    v_add_u32 v5, 49152, v14
    v_xor_b32 v6, 32, v5
    ds_read_b64_tr_b16 v[36:37], v5 offset:0
    v_lshlrev_b32 v100, 16, v162
    v_mfma_f32_16x16x32_bf16 v[124:127], v[40:43], v[68:71], v[124:127]
    ds_read_b64_tr_b16 v[38:39], v5 offset:2048
    v_and_b32 v99, s53, v161
    v_lshlrev_b32 v98, 16, v161
    s_waitcnt lgkmcnt(4)
    v_mfma_f32_16x16x32_bf16 v[124:127], v[28:31], v[84:87], v[124:127]
    ds_read_b64_tr_b16 v[40:41], v5 offset:4096
    v_and_b32 v97, s53, v160
    s_waitcnt lgkmcnt(3)
    v_mfma_f32_16x16x32_bf16 v[124:127], v[32:35], v[92:95], v[124:127]
    ds_read_b64_tr_b16 v[42:43], v5 offset:6144
    v_lshlrev_b32 v96, 16, v160
    v_mfma_f32_16x16x32_bf16 v[116:119], v[32:35], v[88:91], v[116:119]
    ds_read_b64_tr_b16 v[24:25], v5 offset:8192
    v_mfma_f32_16x16x32_bf16 v[116:119], v[28:31], v[80:83], v[116:119]
    ds_read_b64_tr_b16 v[26:27], v5 offset:10240
    s_waitcnt lgkmcnt(4)
    v_mfma_f32_16x16x32_bf16 v[96:99], v[36:39], v[48:51], v[96:99]
    ds_read_b64_tr_b16 v[28:29], v5 offset:12288
    s_waitcnt lgkmcnt(3)
    v_mfma_f32_16x16x32_bf16 v[96:99], v[40:43], v[56:59], v[96:99]
    ds_read_b64_tr_b16 v[30:31], v5 offset:14336
    s_waitcnt vmcnt(12)
    s_barrier
    ds_write_b128 v44, v[200:203] offset:0
    ds_write_b128 v44, v[204:207] offset:1024
    s_add_u32 s57, s56, 7
    s_sub_u32 s48, s57, 10
    s_cmp_ge_u32 s57, 10
    s_cselect_b32 s57, s48, s57
    s_mul_i32 s57, s57, 128
    s_add_u32 s57, s57, s45
    s_add_u32 s30, s57, s28
    s_add_u32 m0, s29, 24576
    v_mfma_f32_16x16x32_bf16 v[104:107], v[40:43], v[60:63], v[104:107]
    ds_read_b64_tr_b16 v[32:33], v5 offset:16384
    buffer_load_dwordx4 v12, s[16:19], s30 offen offset:0 lds
    v_mfma_f32_16x16x32_bf16 v[104:107], v[36:39], v[52:55], v[104:107]
    ds_read_b64_tr_b16 v[34:35], v5 offset:18432
    v_cvt_pk_bf16_f32 v112, v112, v113
    v_cvt_pk_bf16_f32 v113, v114, v115
    s_waitcnt lgkmcnt(6)
    v_mfma_f32_16x16x32_bf16 v[104:107], v[24:27], v[68:71], v[104:107]
    ds_read_b64_tr_b16 v[36:37], v5 offset:20480
    buffer_load_dwordx4 v13, s[16:19], s30 offen offset:1024 lds
    v_cvt_pk_bf16_f32 v114, v116, v117
    s_waitcnt lgkmcnt(5)
    v_mfma_f32_16x16x32_bf16 v[104:107], v[28:31], v[76:79], v[104:107]
    ds_read_b64_tr_b16 v[38:39], v5 offset:22528
    s_add_u32 s57, s56, 2
    s_sub_u32 s48, s57, 10
    s_cmp_ge_u32 s57, 10
    s_cselect_b32 s57, s48, s57
    s_mul_i32 s57, s57, 16384
    s_add_u32 s57, s57, s47
    v_cvt_pk_bf16_f32 v115, v118, v119
    v_mfma_f32_16x16x32_bf16 v[96:99], v[28:31], v[72:75], v[96:99]
    ds_read_b64_tr_b16 v[40:41], v6 offset:0
    buffer_load_dwordx4 v4, s[16:19], s30 offen offset:2048 lds
    v_cvt_pk_bf16_f32 v116, v120, v121
    v_mfma_f32_16x16x32_bf16 v[96:99], v[24:27], v[64:67], v[96:99]
    ds_read_b64_tr_b16 v[42:43], v6 offset:2048
    v_cvt_pk_bf16_f32 v117, v122, v123
    v_cvt_pk_bf16_f32 v118, v124, v125
    s_waitcnt lgkmcnt(4)
    v_mfma_f32_16x16x32_bf16 v[96:99], v[32:35], v[80:83], v[96:99]
    ds_read_b64_tr_b16 v[24:25], v6 offset:4096
    v_cvt_pk_bf16_f32 v119, v126, v127
    s_waitcnt lgkmcnt(3)
    v_mfma_f32_16x16x32_bf16 v[96:99], v[36:39], v[88:91], v[96:99]
    ds_read_b64_tr_b16 v[26:27], v6 offset:6144
    s_mov_b32 s48, s57
    s_cmp_eq_u32 s34, 0
    s_cbranch_scc0 L_125
    s_sub_u32 s48, s57, s47
    s_lshr_b32 s48, s48, 4
    v_add_u32 v45, s48, v15
    v_add_u32 v45, 123904, v45
    ds_write_b128 v45, v[112:115]
    s_mov_b32 s48, 0x40000000
L_125:
    buffer_store_dwordx4 v[112:115], v15, s[24:27], s48 offen offset:0 sc1
    v_mfma_f32_16x16x32_bf16 v[104:107], v[36:39], v[92:95], v[104:107]
    ds_read_b64_tr_b16 v[28:29], v6 offset:8192
    s_mov_b32 s48, s57
    s_cmp_eq_u32 s34, 1
    s_cbranch_scc0 L_127
    s_sub_u32 s48, s57, s47
    s_lshr_b32 s48, s48, 4
    v_add_u32 v45, s48, v15
    v_add_u32 v45, 123904, v45
    ds_write_b128 v45, v[116:119]
    s_mov_b32 s48, 0x40000000
L_127:
    buffer_store_dwordx4 v[116:119], v15, s[24:27], s48 offen offset:1024 sc1
    v_and_b32 v127, s53, v183
    v_mfma_f32_16x16x32_bf16 v[104:107], v[32:35], v[84:87], v[104:107]
    ds_read_b64_tr_b16 v[30:31], v6 offset:10240
    v_lshlrev_b32 v126, 16, v183
    s_waitcnt lgkmcnt(4)
    v_mfma_f32_16x16x32_bf16 v[108:111], v[40:43], v[52:55], v[108:111]
    ds_read_b64_tr_b16 v[32:33], v6 offset:12288
    v_and_b32 v125, s53, v182
    v_lshlrev_b32 v124, 16, v182
    s_waitcnt lgkmcnt(3)
    v_mfma_f32_16x16x32_bf16 v[108:111], v[24:27], v[60:63], v[108:111]
    ds_read_b64_tr_b16 v[34:35], v6 offset:14336
    v_and_b32 v123, s53, v181
    v_mfma_f32_16x16x32_bf16 v[100:103], v[24:27], v[56:59], v[100:103]
    ds_read_b64_tr_b16 v[36:37], v6 offset:16384
    v_lshlrev_b32 v122, 16, v181
    v_and_b32 v121, s53, v180
    v_mfma_f32_16x16x32_bf16 v[100:103], v[40:43], v[48:51], v[100:103]
    ds_read_b64_tr_b16 v[38:39], v6 offset:18432
    v_lshlrev_b32 v120, 16, v180
    s_waitcnt lgkmcnt(4)
    v_mfma_f32_16x16x32_bf16 v[100:103], v[28:31], v[64:67], v[100:103]
    ds_read_b64_tr_b16 v[40:41], v6 offset:20480
    v_and_b32 v119, s53, v179
    s_waitcnt lgkmcnt(3)
    v_mfma_f32_16x16x32_bf16 v[100:103], v[32:35], v[72:75], v[100:103]
    ds_read_b64_tr_b16 v[42:43], v6 offset:22528
    v_lshlrev_b32 v118, 16, v179
    v_and_b32 v117, s53, v178
    v_mfma_f32_16x16x32_bf16 v[108:111], v[32:35], v[76:79], v[108:111]
    v_add_u32 v5, 73728, v14
    v_xor_b32 v6, 32, v5
    ds_read_b64_tr_b16 v[24:25], v5 offset:0
    v_lshlrev_b32 v116, 16, v178
    v_mfma_f32_16x16x32_bf16 v[108:111], v[28:31], v[68:71], v[108:111]
    ds_read_b64_tr_b16 v[26:27], v5 offset:2048
    v_and_b32 v115, s53, v177
    v_lshlrev_b32 v114, 16, v177
    s_waitcnt lgkmcnt(4)
    v_mfma_f32_16x16x32_bf16 v[108:111], v[36:39], v[84:87], v[108:111]
    ds_read_b64_tr_b16 v[28:29], v5 offset:4096
    v_and_b32 v113, s53, v176
    s_waitcnt lgkmcnt(3)
    v_mfma_f32_16x16x32_bf16 v[108:111], v[40:43], v[92:95], v[108:111]
    ds_read_b64_tr_b16 v[30:31], v5 offset:6144
    v_lshlrev_b32 v112, 16, v176
    v_mfma_f32_16x16x32_bf16 v[100:103], v[40:43], v[88:91], v[100:103]
    ds_read_b64_tr_b16 v[32:33], v5 offset:8192
    v_mfma_f32_16x16x32_bf16 v[100:103], v[36:39], v[80:83], v[100:103]
    ds_read_b64_tr_b16 v[34:35], v5 offset:10240
    s_waitcnt lgkmcnt(4)
    v_mfma_f32_16x16x32_bf16 v[112:115], v[24:27], v[48:51], v[112:115]
    ds_read_b64_tr_b16 v[36:37], v5 offset:12288
    s_waitcnt lgkmcnt(3)
    v_mfma_f32_16x16x32_bf16 v[112:115], v[28:31], v[56:59], v[112:115]
    ds_read_b64_tr_b16 v[38:39], v5 offset:14336
    s_waitcnt vmcnt(12)
    s_barrier
    ds_write_b128 v44, v[216:219] offset:8192
    ds_write_b128 v44, v[220:223] offset:9216
    s_add_u32 s57, s56, 8
    s_sub_u32 s48, s57, 10
    s_cmp_ge_u32 s57, 10
    s_cselect_b32 s57, s48, s57
    s_mul_i32 s57, s57, 128
    s_add_u32 s57, s57, s45
    s_add_u32 s30, s57, s28
    s_add_u32 m0, s29, 49152
    v_mfma_f32_16x16x32_bf16 v[120:123], v[28:31], v[60:63], v[120:123]
    ds_read_b64_tr_b16 v[40:41], v5 offset:16384
    buffer_load_dwordx4 v12, s[16:19], s30 offen offset:0 lds
    v_mfma_f32_16x16x32_bf16 v[120:123], v[24:27], v[52:55], v[120:123]
    ds_read_b64_tr_b16 v[42:43], v5 offset:18432
    v_cvt_pk_bf16_f32 v96, v96, v97
    v_cvt_pk_bf16_f32 v97, v98, v99
    s_waitcnt lgkmcnt(6)
    v_mfma_f32_16x16x32_bf16 v[120:123], v[32:35], v[68:71], v[120:123]
    ds_read_b64_tr_b16 v[24:25], v5 offset:20480
    buffer_load_dwordx4 v13, s[16:19], s30 offen offset:1024 lds
    v_cvt_pk_bf16_f32 v98, v100, v101
    s_waitcnt lgkmcnt(5)
    v_mfma_f32_16x16x32_bf16 v[120:123], v[36:39], v[76:79], v[120:123]
    ds_read_b64_tr_b16 v[26:27], v5 offset:22528
    s_add_u32 s57, s56, 3
    s_sub_u32 s48, s57, 10
    s_cmp_ge_u32 s57, 10
    s_cselect_b32 s57, s48, s57
    s_mul_i32 s57, s57, 16384
    s_add_u32 s57, s57, s47
    v_cvt_pk_bf16_f32 v99, v102, v103
    v_mfma_f32_16x16x32_bf16 v[112:115], v[36:39], v[72:75], v[112:115]
    ds_read_b64_tr_b16 v[28:29], v6 offset:0
    buffer_load_dwordx4 v4, s[16:19], s30 offen offset:2048 lds
    v_cvt_pk_bf16_f32 v100, v104, v105
    v_mfma_f32_16x16x32_bf16 v[112:115], v[32:35], v[64:67], v[112:115]
    ds_read_b64_tr_b16 v[30:31], v6 offset:2048
    v_cvt_pk_bf16_f32 v101, v106, v107
    v_cvt_pk_bf16_f32 v102, v108, v109
    s_waitcnt lgkmcnt(4)
    v_mfma_f32_16x16x32_bf16 v[112:115], v[40:43], v[80:83], v[112:115]
    ds_read_b64_tr_b16 v[32:33], v6 offset:4096
    v_cvt_pk_bf16_f32 v103, v110, v111
    s_waitcnt lgkmcnt(3)
    v_mfma_f32_16x16x32_bf16 v[112:115], v[24:27], v[88:91], v[112:115]
    ds_read_b64_tr_b16 v[34:35], v6 offset:6144
    s_mov_b32 s48, s57
    s_cmp_eq_u32 s34, 0
    s_cbranch_scc0 L_129
    s_sub_u32 s48, s57, s47
    s_lshr_b32 s48, s48, 4
    v_add_u32 v45, s48, v15
    v_add_u32 v45, 123904, v45
    ds_write_b128 v45, v[96:99]
    s_mov_b32 s48, 0x40000000
L_129:
    buffer_store_dwordx4 v[96:99], v15, s[24:27], s48 offen offset:0 sc1
    v_mfma_f32_16x16x32_bf16 v[120:123], v[24:27], v[92:95], v[120:123]
    ds_read_b64_tr_b16 v[36:37], v6 offset:8192
    s_mov_b32 s48, s57
    s_cmp_eq_u32 s34, 1
    s_cbranch_scc0 L_131
    s_sub_u32 s48, s57, s47
    s_lshr_b32 s48, s48, 4
    v_add_u32 v45, s48, v15
    v_add_u32 v45, 123904, v45
    ds_write_b128 v45, v[100:103]
    s_mov_b32 s48, 0x40000000
L_131:
    buffer_store_dwordx4 v[100:103], v15, s[24:27], s48 offen offset:1024 sc1
    v_and_b32 v111, s53, v199
    v_mfma_f32_16x16x32_bf16 v[120:123], v[40:43], v[84:87], v[120:123]
    ds_read_b64_tr_b16 v[38:39], v6 offset:10240
    v_lshlrev_b32 v110, 16, v199
    s_waitcnt lgkmcnt(4)
    v_mfma_f32_16x16x32_bf16 v[124:127], v[28:31], v[52:55], v[124:127]
    ds_read_b64_tr_b16 v[40:41], v6 offset:12288
    v_and_b32 v109, s53, v198
    v_lshlrev_b32 v108, 16, v198
    s_waitcnt lgkmcnt(3)
    v_mfma_f32_16x16x32_bf16 v[124:127], v[32:35], v[60:63], v[124:127]
    ds_read_b64_tr_b16 v[42:43], v6 offset:14336
    v_and_b32 v107, s53, v197
    v_mfma_f32_16x16x32_bf16 v[116:119], v[32:35], v[56:59], v[116:119]
    ds_read_b64_tr_b16 v[24:25], v6 offset:16384
    v_lshlrev_b32 v106, 16, v197
    v_and_b32 v105, s53, v196
    v_mfma_f32_16x16x32_bf16 v[116:119], v[28:31], v[48:51], v[116:119]
    ds_read_b64_tr_b16 v[26:27], v6 offset:18432
    v_lshlrev_b32 v104, 16, v196
    s_waitcnt lgkmcnt(4)
    v_mfma_f32_16x16x32_bf16 v[116:119], v[36:39], v[64:67], v[116:119]
    ds_read_b64_tr_b16 v[28:29], v6 offset:20480
    v_and_b32 v103, s53, v195
    s_waitcnt lgkmcnt(3)
    v_mfma_f32_16x16x32_bf16 v[116:119], v[40:43], v[72:75], v[116:119]
    ds_read_b64_tr_b16 v[30:31], v6 offset:22528
    v_lshlrev_b32 v102, 16, v195
    v_and_b32 v101, s53, v194
    v_mfma_f32_16x16x32_bf16 v[124:127], v[40:43], v[76:79], v[124:127]
    v_add_u32 v5, 98304, v14
    v_xor_b32 v6, 32, v5
    ds_read_b64_tr_b16 v[32:33], v5 offset:0
    v_lshlrev_b32 v100, 16, v194
    v_mfma_f32_16x16x32_bf16 v[124:127], v[36:39], v[68:71], v[124:127]
    ds_read_b64_tr_b16 v[34:35], v5 offset:2048
    v_and_b32 v99, s53, v193
    v_lshlrev_b32 v98, 16, v193
    s_waitcnt lgkmcnt(4)
    v_mfma_f32_16x16x32_bf16 v[124:127], v[24:27], v[84:87], v[124:127]
    ds_read_b64_tr_b16 v[36:37], v5 offset:4096
    v_and_b32 v97, s53, v192
    s_waitcnt lgkmcnt(3)
    v_mfma_f32_16x16x32_bf16 v[124:127], v[28:31], v[92:95], v[124:127]
    ds_read_b64_tr_b16 v[38:39], v5 offset:6144
    v_lshlrev_b32 v96, 16, v192
    v_mfma_f32_16x16x32_bf16 v[116:119], v[28:31], v[88:91], v[116:119]
    ds_read_b64_tr_b16 v[40:41], v5 offset:8192
    v_mfma_f32_16x16x32_bf16 v[116:119], v[24:27], v[80:83], v[116:119]
    ds_read_b64_tr_b16 v[42:43], v5 offset:10240
    s_waitcnt lgkmcnt(4)
    v_mfma_f32_16x16x32_bf16 v[96:99], v[32:35], v[48:51], v[96:99]
    ds_read_b64_tr_b16 v[24:25], v5 offset:12288
    s_waitcnt lgkmcnt(3)
    v_mfma_f32_16x16x32_bf16 v[96:99], v[36:39], v[56:59], v[96:99]
    ds_read_b64_tr_b16 v[26:27], v5 offset:14336
    s_waitcnt vmcnt(12)
    s_barrier
    s_cmp_eq_u32 s40, 3
    s_cbranch_scc0 L_133
    v_readfirstlane_b32 s100, v10
    v_and_b32 v11, 15, v0
    v_lshlrev_b32 v11, 3, v11
    s_not_b32 s101, s100
    s_lshr_b32 s48, s55, 4
    s_lshl_b32 s48, s48, 7
    s_add_u32 s48, s48, 50331648
    buffer_load_dwordx2 v[46:47], v11, s[24:27], s48 offen sc1
L_133:
    ds_write_b128 v44, v[232:235] offset:0
    ds_write_b128 v44, v[236:239] offset:1024
    v_mfma_f32_16x16x32_bf16 v[104:107], v[36:39], v[60:63], v[104:107]
    ds_read_b64_tr_b16 v[28:29], v5 offset:16384
    v_mfma_f32_16x16x32_bf16 v[104:107], v[32:35], v[52:55], v[104:107]
    ds_read_b64_tr_b16 v[30:31], v5 offset:18432
    v_cvt_pk_bf16_f32 v112, v112, v113
    v_cvt_pk_bf16_f32 v113, v114, v115
    s_waitcnt lgkmcnt(6)
    v_mfma_f32_16x16x32_bf16 v[104:107], v[40:43], v[68:71], v[104:107]
    ds_read_b64_tr_b16 v[32:33], v5 offset:20480
    v_cvt_pk_bf16_f32 v114, v116, v117
    s_waitcnt lgkmcnt(5)
    v_mfma_f32_16x16x32_bf16 v[104:107], v[24:27], v[76:79], v[104:107]
    ds_read_b64_tr_b16 v[34:35], v5 offset:22528
    s_add_u32 s57, s56, 4
    s_sub_u32 s48, s57, 10
    s_cmp_ge_u32 s57, 10
    s_cselect_b32 s57, s48, s57
    s_mul_i32 s57, s57, 16384
    s_add_u32 s57, s57, s47
    v_cvt_pk_bf16_f32 v115, v118, v119
    v_mfma_f32_16x16x32_bf16 v[96:99], v[24:27], v[72:75], v[96:99]
    ds_read_b64_tr_b16 v[36:37], v6 offset:0
    v_cvt_pk_bf16_f32 v116, v120, v121
    v_mfma_f32_16x16x32_bf16 v[96:99], v[40:43], v[64:67], v[96:99]
    ds_read_b64_tr_b16 v[38:39], v6 offset:2048
    v_cvt_pk_bf16_f32 v117, v122, v123
    v_cvt_pk_bf16_f32 v118, v124, v125
    s_waitcnt lgkmcnt(4)
    v_mfma_f32_16x16x32_bf16 v[96:99], v[28:31], v[80:83], v[96:99]
    ds_read_b64_tr_b16 v[40:41], v6 offset:4096
    v_cvt_pk_bf16_f32 v119, v126, v127
    s_waitcnt lgkmcnt(3)
    v_mfma_f32_16x16x32_bf16 v[96:99], v[32:35], v[88:91], v[96:99]
    ds_read_b64_tr_b16 v[42:43], v6 offset:6144
    s_mov_b32 s48, s57
    s_cmp_eq_u32 s34, 0
    s_cbranch_scc0 L_135
    s_sub_u32 s48, s57, s47
    s_lshr_b32 s48, s48, 4
    v_add_u32 v45, s48, v15
    v_add_u32 v45, 123904, v45
    ds_write_b128 v45, v[112:115]
    s_mov_b32 s48, 0x40000000
L_135:
    buffer_store_dwordx4 v[112:115], v15, s[24:27], s48 offen offset:0 sc1
    v_mfma_f32_16x16x32_bf16 v[104:107], v[32:35], v[92:95], v[104:107]
    ds_read_b64_tr_b16 v[24:25], v6 offset:8192
    s_mov_b32 s48, s57
    s_cmp_eq_u32 s34, 1
    s_cbranch_scc0 L_137
    s_sub_u32 s48, s57, s47
    s_lshr_b32 s48, s48, 4
    v_add_u32 v45, s48, v15
    v_add_u32 v45, 123904, v45
    ds_write_b128 v45, v[116:119]
    s_mov_b32 s48, 0x40000000
L_137:
    buffer_store_dwordx4 v[116:119], v15, s[24:27], s48 offen offset:1024 sc1
    v_and_b32 v127, s53, v215
    v_mfma_f32_16x16x32_bf16 v[104:107], v[28:31], v[84:87], v[104:107]
    ds_read_b64_tr_b16 v[26:27], v6 offset:10240
    v_lshlrev_b32 v126, 16, v215
    s_waitcnt lgkmcnt(4)
    v_mfma_f32_16x16x32_bf16 v[108:111], v[36:39], v[52:55], v[108:111]
    ds_read_b64_tr_b16 v[28:29], v6 offset:12288
    v_and_b32 v125, s53, v214
    v_lshlrev_b32 v124, 16, v214
    s_waitcnt lgkmcnt(3)
    v_mfma_f32_16x16x32_bf16 v[108:111], v[40:43], v[60:63], v[108:111]
    ds_read_b64_tr_b16 v[30:31], v6 offset:14336
    v_and_b32 v123, s53, v213
    v_mfma_f32_16x16x32_bf16 v[100:103], v[40:43], v[56:59], v[100:103]
    ds_read_b64_tr_b16 v[32:33], v6 offset:16384
    v_lshlrev_b32 v122, 16, v213
    v_and_b32 v121, s53, v212
    v_mfma_f32_16x16x32_bf16 v[100:103], v[36:39], v[48:51], v[100:103]
    ds_read_b64_tr_b16 v[34:35], v6 offset:18432
    v_lshlrev_b32 v120, 16, v212
    s_waitcnt lgkmcnt(4)
    v_mfma_f32_16x16x32_bf16 v[100:103], v[24:27], v[64:67], v[100:103]
    ds_read_b64_tr_b16 v[36:37], v6 offset:20480
    v_and_b32 v119, s53, v211
    s_waitcnt lgkmcnt(3)
    v_mfma_f32_16x16x32_bf16 v[100:103], v[28:31], v[72:75], v[100:103]
    ds_read_b64_tr_b16 v[38:39], v6 offset:22528
    v_lshlrev_b32 v118, 16, v211
    v_and_b32 v117, s53, v210
    v_mfma_f32_16x16x32_bf16 v[108:111], v[28:31], v[76:79], v[108:111]
    v_add_u32 v5, 0, v14
    v_xor_b32 v6, 32, v5
    ds_read_b64_tr_b16 v[40:41], v5 offset:0
    v_lshlrev_b32 v116, 16, v210
    v_mfma_f32_16x16x32_bf16 v[108:111], v[24:27], v[68:71], v[108:111]
    ds_read_b64_tr_b16 v[42:43], v5 offset:2048
    v_and_b32 v115, s53, v209
    v_lshlrev_b32 v114, 16, v209
    s_waitcnt lgkmcnt(4)
    v_mfma_f32_16x16x32_bf16 v[108:111], v[32:35], v[84:87], v[108:111]
    ds_read_b64_tr_b16 v[24:25], v5 offset:4096
    v_and_b32 v113, s53, v208
    s_waitcnt lgkmcnt(3)
    v_mfma_f32_16x16x32_bf16 v[108:111], v[36:39], v[92:95], v[108:111]
    ds_read_b64_tr_b16 v[26:27], v5 offset:6144
    v_lshlrev_b32 v112, 16, v208
    v_mfma_f32_16x16x32_bf16 v[100:103], v[36:39], v[88:91], v[100:103]
    ds_read_b64_tr_b16 v[28:29], v5 offset:8192
    v_mfma_f32_16x16x32_bf16 v[100:103], v[32:35], v[80:83], v[100:103]
    ds_read_b64_tr_b16 v[30:31], v5 offset:10240
    s_waitcnt lgkmcnt(4)
    v_mfma_f32_16x16x32_bf16 v[112:115], v[40:43], v[48:51], v[112:115]
    ds_read_b64_tr_b16 v[32:33], v5 offset:12288
    s_waitcnt lgkmcnt(3)
    v_mfma_f32_16x16x32_bf16 v[112:115], v[24:27], v[56:59], v[112:115]
    ds_read_b64_tr_b16 v[34:35], v5 offset:14336
    s_waitcnt vmcnt(9)
    s_barrier
    ds_write_b128 v44, v[248:251] offset:8192
    ds_write_b128 v44, v[252:255] offset:9216
    v_mfma_f32_16x16x32_bf16 v[120:123], v[24:27], v[60:63], v[120:123]
    ds_read_b64_tr_b16 v[36:37], v5 offset:16384
    v_mfma_f32_16x16x32_bf16 v[120:123], v[40:43], v[52:55], v[120:123]
    ds_read_b64_tr_b16 v[38:39], v5 offset:18432
    v_cvt_pk_bf16_f32 v96, v96, v97
    v_cvt_pk_bf16_f32 v97, v98, v99
    s_waitcnt lgkmcnt(6)
    v_mfma_f32_16x16x32_bf16 v[120:123], v[28:31], v[68:71], v[120:123]
    ds_read_b64_tr_b16 v[40:41], v5 offset:20480
    v_cvt_pk_bf16_f32 v98, v100, v101
    s_waitcnt lgkmcnt(5)
    v_mfma_f32_16x16x32_bf16 v[120:123], v[32:35], v[76:79], v[120:123]
    ds_read_b64_tr_b16 v[42:43], v5 offset:22528
    s_add_u32 s57, s56, 5
    s_sub_u32 s48, s57, 10
    s_cmp_ge_u32 s57, 10
    s_cselect_b32 s57, s48, s57
    s_mul_i32 s57, s57, 16384
    s_add_u32 s57, s57, s47
    v_cvt_pk_bf16_f32 v99, v102, v103
    v_mfma_f32_16x16x32_bf16 v[112:115], v[32:35], v[72:75], v[112:115]
    ds_read_b64_tr_b16 v[24:25], v6 offset:0
    v_cvt_pk_bf16_f32 v100, v104, v105
    v_mfma_f32_16x16x32_bf16 v[112:115], v[28:31], v[64:67], v[112:115]
    ds_read_b64_tr_b16 v[26:27], v6 offset:2048
    v_cvt_pk_bf16_f32 v101, v106, v107
    v_cvt_pk_bf16_f32 v102, v108, v109
    s_waitcnt lgkmcnt(4)
    v_mfma_f32_16x16x32_bf16 v[112:115], v[36:39], v[80:83], v[112:115]
    ds_read_b64_tr_b16 v[28:29], v6 offset:4096
    v_cvt_pk_bf16_f32 v103, v110, v111
    s_waitcnt lgkmcnt(3)
    v_mfma_f32_16x16x32_bf16 v[112:115], v[40:43], v[88:91], v[112:115]
    ds_read_b64_tr_b16 v[30:31], v6 offset:6144
    s_mov_b32 s48, s57
    s_cmp_eq_u32 s34, 0
    s_cbranch_scc0 L_139
    s_sub_u32 s48, s57, s47
    s_lshr_b32 s48, s48, 4
    v_add_u32 v45, s48, v15
    v_add_u32 v45, 123904, v45
    ds_write_b128 v45, v[96:99]
    s_mov_b32 s48, 0x40000000
L_139:
    buffer_store_dwordx4 v[96:99], v15, s[24:27], s48 offen offset:0 sc1
    v_mfma_f32_16x16x32_bf16 v[120:123], v[40:43], v[92:95], v[120:123]
    ds_read_b64_tr_b16 v[32:33], v6 offset:8192
    s_mov_b32 s48, s57
    s_cmp_eq_u32 s34, 1
    s_cbranch_scc0 L_141
    s_sub_u32 s48, s57, s47
    s_lshr_b32 s48, s48, 4
    v_add_u32 v45, s48, v15
    v_add_u32 v45, 123904, v45
    ds_write_b128 v45, v[100:103]
    s_mov_b32 s48, 0x40000000
L_141:
    buffer_store_dwordx4 v[100:103], v15, s[24:27], s48 offen offset:1024 sc1
    v_and_b32 v111, s53, v231
    v_mfma_f32_16x16x32_bf16 v[120:123], v[36:39], v[84:87], v[120:123]
    ds_read_b64_tr_b16 v[34:35], v6 offset:10240
    v_lshlrev_b32 v110, 16, v231
    s_waitcnt lgkmcnt(4)
    v_mfma_f32_16x16x32_bf16 v[124:127], v[24:27], v[52:55], v[124:127]
    ds_read_b64_tr_b16 v[36:37], v6 offset:12288
    v_and_b32 v109, s53, v230
    v_lshlrev_b32 v108, 16, v230
    s_waitcnt lgkmcnt(3)
    v_mfma_f32_16x16x32_bf16 v[124:127], v[28:31], v[60:63], v[124:127]
    ds_read_b64_tr_b16 v[38:39], v6 offset:14336
    v_and_b32 v107, s53, v229
    v_mfma_f32_16x16x32_bf16 v[116:119], v[28:31], v[56:59], v[116:119]
    ds_read_b64_tr_b16 v[40:41], v6 offset:16384
    v_lshlrev_b32 v106, 16, v229
    v_and_b32 v105, s53, v228
    v_mfma_f32_16x16x32_bf16 v[116:119], v[24:27], v[48:51], v[116:119]
    ds_read_b64_tr_b16 v[42:43], v6 offset:18432
    v_lshlrev_b32 v104, 16, v228
    s_waitcnt lgkmcnt(4)
    v_mfma_f32_16x16x32_bf16 v[116:119], v[32:35], v[64:67], v[116:119]
    ds_read_b64_tr_b16 v[24:25], v6 offset:20480
    v_and_b32 v103, s53, v227
    s_waitcnt lgkmcnt(3)
    v_mfma_f32_16x16x32_bf16 v[116:119], v[36:39], v[72:75], v[116:119]
    ds_read_b64_tr_b16 v[26:27], v6 offset:22528
    v_lshlrev_b32 v102, 16, v227
    v_and_b32 v101, s53, v226
    v_mfma_f32_16x16x32_bf16 v[124:127], v[36:39], v[76:79], v[124:127]
    v_add_u32 v5, 24576, v14
    v_xor_b32 v6, 32, v5
    ds_read_b64_tr_b16 v[28:29], v5 offset:0
    v_lshlrev_b32 v100, 16, v226
    v_mfma_f32_16x16x32_bf16 v[124:127], v[32:35], v[68:71], v[124:127]
    ds_read_b64_tr_b16 v[30:31], v5 offset:2048
    v_and_b32 v99, s53, v225
    v_lshlrev_b32 v98, 16, v225
    s_waitcnt lgkmcnt(4)
    v_mfma_f32_16x16x32_bf16 v[124:127], v[40:43], v[84:87], v[124:127]
    ds_read_b64_tr_b16 v[32:33], v5 offset:4096
    v_and_b32 v97, s53, v224
    s_waitcnt lgkmcnt(3)
    v_mfma_f32_16x16x32_bf16 v[124:127], v[24:27], v[92:95], v[124:127]
    ds_read_b64_tr_b16 v[34:35], v5 offset:6144
    v_lshlrev_b32 v96, 16, v224
    v_mfma_f32_16x16x32_bf16 v[116:119], v[24:27], v[88:91], v[116:119]
    ds_read_b64_tr_b16 v[36:37], v5 offset:8192
    v_mfma_f32_16x16x32_bf16 v[116:119], v[40:43], v[80:83], v[116:119]
    ds_read_b64_tr_b16 v[38:39], v5 offset:10240
    s_waitcnt lgkmcnt(4)
    v_mfma_f32_16x16x32_bf16 v[96:99], v[28:31], v[48:51], v[96:99]
    ds_read_b64_tr_b16 v[40:41], v5 offset:12288
    s_waitcnt lgkmcnt(3)
    v_mfma_f32_16x16x32_bf16 v[96:99], v[32:35], v[56:59], v[96:99]
    ds_read_b64_tr_b16 v[42:43], v5 offset:14336
    s_waitcnt vmcnt(6)
    s_cmp_eq_u32 s40, 3
    s_cbranch_scc0 L_143
    s_waitcnt vmcnt(4)
    v_cmp_eq_u64 vcc, s[100:101], v[46:47]
    s_nop 0
    s_and_b32 s48, vcc_lo, 0xffff
    s_cmp_eq_u32 s100, 0
    s_cselect_b32 s48, 0, s48
    v_mov_b32 v46, s48
    v_mov_b32 v47, 122880
    ds_write_b32 v47, v46
    s_waitcnt lgkmcnt(0)
L_143:
    s_barrier
    v_mfma_f32_16x16x32_bf16 v[104:107], v[32:35], v[60:63], v[104:107]
    ds_read_b64_tr_b16 v[24:25], v5 offset:16384
    v_mfma_f32_16x16x32_bf16 v[104:107], v[28:31], v[52:55], v[104:107]
    ds_read_b64_tr_b16 v[26:27], v5 offset:18432
    v_cvt_pk_bf16_f32 v112, v112, v113
    v_cvt_pk_bf16_f32 v113, v114, v115
    s_waitcnt lgkmcnt(4)
    v_mfma_f32_16x16x32_bf16 v[104:107], v[36:39], v[68:71], v[104:107]
    ds_read_b64_tr_b16 v[28:29], v5 offset:20480
    v_cvt_pk_bf16_f32 v114, v116, v117
    s_waitcnt lgkmcnt(3)
    v_mfma_f32_16x16x32_bf16 v[104:107], v[40:43], v[76:79], v[104:107]
    ds_read_b64_tr_b16 v[30:31], v5 offset:22528
    s_add_u32 s57, s56, 6
    s_sub_u32 s48, s57, 10
    s_cmp_ge_u32 s57, 10
    s_cselect_b32 s57, s48, s57
    s_mul_i32 s57, s57, 16384
    s_add_u32 s57, s57, s47
    v_cvt_pk_bf16_f32 v115, v118, v119
    v_mfma_f32_16x16x32_bf16 v[96:99], v[40:43], v[72:75], v[96:99]
    ds_read_b64_tr_b16 v[32:33], v6 offset:0
    v_cvt_pk_bf16_f32 v116, v120, v121
    v_mfma_f32_16x16x32_bf16 v[96:99], v[36:39], v[64:67], v[96:99]
    ds_read_b64_tr_b16 v[34:35], v6 offset:2048
    v_cvt_pk_bf16_f32 v117, v122, v123
    v_cvt_pk_bf16_f32 v118, v124, v125
    s_waitcnt lgkmcnt(4)
    v_mfma_f32_16x16x32_bf16 v[96:99], v[24:27], v[80:83], v[96:99]
    ds_read_b64_tr_b16 v[36:37], v6 offset:4096
    v_cvt_pk_bf16_f32 v119, v126, v127
    s_waitcnt lgkmcnt(3)
    v_mfma_f32_16x16x32_bf16 v[96:99], v[28:31], v[88:91], v[96:99]
    ds_read_b64_tr_b16 v[38:39], v6 offset:6144
    s_mov_b32 s48, s57
    s_cmp_eq_u32 s34, 0
    s_cbranch_scc0 L_145
    s_sub_u32 s48, s57, s47
    s_lshr_b32 s48, s48, 4
    v_add_u32 v45, s48, v15
    v_add_u32 v45, 123904, v45
    ds_write_b128 v45, v[112:115]
    s_mov_b32 s48, 0x40000000
L_145:
    buffer_store_dwordx4 v[112:115], v15, s[24:27], s48 offen offset:0 sc1
    v_mfma_f32_16x16x32_bf16 v[104:107], v[28:31], v[92:95], v[104:107]
    ds_read_b64_tr_b16 v[40:41], v6 offset:8192
    s_mov_b32 s48, s57
    s_cmp_eq_u32 s34, 1
    s_cbranch_scc0 L_147
    s_sub_u32 s48, s57, s47
    s_lshr_b32 s48, s48, 4
    v_add_u32 v45, s48, v15
    v_add_u32 v45, 123904, v45
    ds_write_b128 v45, v[116:119]
    s_mov_b32 s48, 0x40000000
L_147:
    buffer_store_dwordx4 v[116:119], v15, s[24:27], s48 offen offset:1024 sc1
    v_and_b32 v127, s53, v247
    v_mfma_f32_16x16x32_bf16 v[104:107], v[24:27], v[84:87], v[104:107]
    ds_read_b64_tr_b16 v[42:43], v6 offset:10240
    v_lshlrev_b32 v126, 16, v247
    s_waitcnt lgkmcnt(4)
    v_mfma_f32_16x16x32_bf16 v[108:111], v[32:35], v[52:55], v[108:111]
    ds_read_b64_tr_b16 v[24:25], v6 offset:12288
    v_and_b32 v125, s53, v246
    v_lshlrev_b32 v124, 16, v246
    s_waitcnt lgkmcnt(3)
    v_mfma_f32_16x16x32_bf16 v[108:111], v[36:39], v[60:63], v[108:111]
    ds_read_b64_tr_b16 v[26:27], v6 offset:14336
    v_and_b32 v123, s53, v245
    v_mfma_f32_16x16x32_bf16 v[100:103], v[36:39], v[56:59], v[100:103]
    ds_read_b64_tr_b16 v[28:29], v6 offset:16384
    v_lshlrev_b32 v122, 16, v245
    v_and_b32 v121, s53, v244
    v_mfma_f32_16x16x32_bf16 v[100:103], v[32:35], v[48:51], v[100:103]
    ds_read_b64_tr_b16 v[30:31], v6 offset:18432
    v_lshlrev_b32 v120, 16, v244
    s_waitcnt lgkmcnt(4)
    v_mfma_f32_16x16x32_bf16 v[100:103], v[40:43], v[64:67], v[100:103]
    ds_read_b64_tr_b16 v[32:33], v6 offset:20480
    v_and_b32 v119, s53, v243
    s_waitcnt lgkmcnt(3)
    v_mfma_f32_16x16x32_bf16 v[100:103], v[24:27], v[72:75], v[100:103]
    ds_read_b64_tr_b16 v[34:35], v6 offset:22528
    v_lshlrev_b32 v118, 16, v243
    v_and_b32 v117, s53, v242
    v_mfma_f32_16x16x32_bf16 v[108:111], v[24:27], v[76:79], v[108:111]
    v_add_u32 v5, 49152, v14
    v_xor_b32 v6, 32, v5
    ds_read_b64_tr_b16 v[36:37], v5 offset:0
    v_lshlrev_b32 v116, 16, v242
    v_mfma_f32_16x16x32_bf16 v[108:111], v[40:43], v[68:71], v[108:111]
    ds_read_b64_tr_b16 v[38:39], v5 offset:2048
    v_and_b32 v115, s53, v241
    v_lshlrev_b32 v114, 16, v241
    s_waitcnt lgkmcnt(4)
    v_mfma_f32_16x16x32_bf16 v[108:111], v[28:31], v[84:87], v[108:111]
    ds_read_b64_tr_b16 v[40:41], v5 offset:4096
    v_and_b32 v113, s53, v240
    s_waitcnt lgkmcnt(3)
    v_mfma_f32_16x16x32_bf16 v[108:111], v[32:35], v[92:95], v[108:111]
    ds_read_b64_tr_b16 v[42:43], v5 offset:6144
    v_lshlrev_b32 v112, 16, v240
    v_mfma_f32_16x16x32_bf16 v[100:103], v[32:35], v[88:91], v[100:103]
    ds_read_b64_tr_b16 v[24:25], v5 offset:8192
    v_mfma_f32_16x16x32_bf16 v[100:103], v[28:31], v[80:83], v[100:103]
    ds_read_b64_tr_b16 v[26:27], v5 offset:10240
    s_waitcnt lgkmcnt(4)
    v_mfma_f32_16x16x32_bf16 v[112:115], v[36:39], v[48:51], v[112:115]
    ds_read_b64_tr_b16 v[28:29], v5 offset:12288
    s_waitcnt lgkmcnt(3)
    v_mfma_f32_16x16x32_bf16 v[112:115], v[40:43], v[56:59], v[112:115]
    ds_read_b64_tr_b16 v[30:31], v5 offset:14336
    v_mfma_f32_16x16x32_bf16 v[120:123], v[40:43], v[60:63], v[120:123]
    ds_read_b64_tr_b16 v[32:33], v5 offset:16384
    v_mfma_f32_16x16x32_bf16 v[120:123], v[36:39], v[52:55], v[120:123]
    ds_read_b64_tr_b16 v[34:35], v5 offset:18432
    v_cvt_pk_bf16_f32 v96, v96, v97
    s_waitcnt lgkmcnt(4)
    v_mfma_f32_16x16x32_bf16 v[120:123], v[24:27], v[68:71], v[120:123]
    ds_read_b64_tr_b16 v[36:37], v5 offset:20480
    v_cvt_pk_bf16_f32 v97, v98, v99
    s_waitcnt lgkmcnt(3)
    v_mfma_f32_16x16x32_bf16 v[120:123], v[28:31], v[76:79], v[120:123]
    ds_read_b64_tr_b16 v[38:39], v5 offset:22528
    v_mfma_f32_16x16x32_bf16 v[112:115], v[28:31], v[72:75], v[112:115]
    ds_read_b64_tr_b16 v[40:41], v6 offset:0
    v_cvt_pk_bf16_f32 v98, v100, v101
    v_mfma_f32_16x16x32_bf16 v[112:115], v[24:27], v[64:67], v[112:115]
    ds_read_b64_tr_b16 v[42:43], v6 offset:2048
    s_waitcnt lgkmcnt(4)
    v_mfma_f32_16x16x32_bf16 v[112:115], v[32:35], v[80:83], v[112:115]
    ds_read_b64_tr_b16 v[24:25], v6 offset:4096
    s_add_u32 s57, s56, 7
    s_sub_u32 s48, s57, 10
    s_cmp_ge_u32 s57, 10
    s_cselect_b32 s57, s48, s57
    s_mul_i32 s57, s57, 16384
    s_add_u32 s57, s57, s47
    s_waitcnt lgkmcnt(3)
    v_mfma_f32_16x16x32_bf16 v[112:115], v[36:39], v[88:91], v[112:115]
    ds_read_b64_tr_b16 v[26:27], v6 offset:6144
    v_cvt_pk_bf16_f32 v99, v102, v103
    v_mfma_f32_16x16x32_bf16 v[120:123], v[36:39], v[92:95], v[120:123]
    ds_read_b64_tr_b16 v[28:29], v6 offset:8192
    v_mfma_f32_16x16x32_bf16 v[120:123], v[32:35], v[84:87], v[120:123]
    ds_read_b64_tr_b16 v[30:31], v6 offset:10240
    v_cvt_pk_bf16_f32 v100, v104, v105
    s_waitcnt lgkmcnt(4)
    v_mfma_f32_16x16x32_bf16 v[124:127], v[40:43], v[52:55], v[124:127]
    ds_read_b64_tr_b16 v[32:33], v6 offset:12288
    s_waitcnt lgkmcnt(3)
    v_mfma_f32_16x16x32_bf16 v[124:127], v[24:27], v[60:63], v[124:127]
    ds_read_b64_tr_b16 v[34:35], v6 offset:14336
    v_cvt_pk_bf16_f32 v101, v106, v107
    v_mfma_f32_16x16x32_bf16 v[116:119], v[24:27], v[56:59], v[116:119]
    ds_read_b64_tr_b16 v[36:37], v6 offset:16384
    v_mfma_f32_16x16x32_bf16 v[116:119], v[40:43], v[48:51], v[116:119]
    ds_read_b64_tr_b16 v[38:39], v6 offset:18432
    v_cvt_pk_bf16_f32 v102, v108, v109
    s_waitcnt lgkmcnt(4)
    v_mfma_f32_16x16x32_bf16 v[116:119], v[28:31], v[64:67], v[116:119]
    ds_read_b64_tr_b16 v[40:41], v6 offset:20480
    v_cvt_pk_bf16_f32 v103, v110, v111
    s_waitcnt lgkmcnt(3)
    v_mfma_f32_16x16x32_bf16 v[116:119], v[32:35], v[72:75], v[116:119]
    ds_read_b64_tr_b16 v[42:43], v6 offset:22528
    v_mfma_f32_16x16x32_bf16 v[124:127], v[32:35], v[76:79], v[124:127]
    s_mov_b32 s48, s57
    s_cmp_eq_u32 s34, 0
    s_cbranch_scc0 L_149
    s_sub_u32 s48, s57, s47
    s_lshr_b32 s48, s48, 4
    v_add_u32 v45, s48, v15
    v_add_u32 v45, 123904, v45
    ds_write_b128 v45, v[96:99]
    s_mov_b32 s48, 0x40000000
L_149:
    buffer_store_dwordx4 v[96:99], v15, s[24:27], s48 offen offset:0 sc1
    v_mfma_f32_16x16x32_bf16 v[124:127], v[28:31], v[68:71], v[124:127]
    s_waitcnt lgkmcnt(2)
    v_mfma_f32_16x16x32_bf16 v[124:127], v[36:39], v[84:87], v[124:127]
    s_mov_b32 s48, s57
    s_cmp_eq_u32 s34, 1
    s_cbranch_scc0 L_151
    s_sub_u32 s48, s57, s47
    s_lshr_b32 s48, s48, 4
    v_add_u32 v45, s48, v15
    v_add_u32 v45, 123904, v45
    ds_write_b128 v45, v[100:103]
    s_mov_b32 s48, 0x40000000
L_151:
    buffer_store_dwordx4 v[100:103], v15, s[24:27], s48 offen offset:1024 sc1
    s_waitcnt lgkmcnt(0)
    v_mfma_f32_16x16x32_bf16 v[124:127], v[40:43], v[92:95], v[124:127]
    v_mfma_f32_16x16x32_bf16 v[116:119], v[40:43], v[88:91], v[116:119]
    v_mfma_f32_16x16x32_bf16 v[116:119], v[36:39], v[80:83], v[116:119]
    v_cvt_pk_bf16_f32 v112, v112, v113
    v_cvt_pk_bf16_f32 v113, v114, v115
    s_nop 5
    v_cvt_pk_bf16_f32 v114, v116, v117
    s_add_u32 s57, s56, 8
    s_sub_u32 s48, s57, 10
    s_cmp_ge_u32 s57, 10
    s_cselect_b32 s57, s48, s57
    s_mul_i32 s57, s57, 16384
    s_add_u32 s57, s57, s47
    v_cvt_pk_bf16_f32 v115, v118, v119
    v_cvt_pk_bf16_f32 v116, v120, v121
    v_cvt_pk_bf16_f32 v117, v122, v123
    v_cvt_pk_bf16_f32 v118, v124, v125
    v_cvt_pk_bf16_f32 v119, v126, v127
    s_mov_b32 s48, s57
    s_cmp_eq_u32 s34, 0
    s_cbranch_scc0 L_153
    s_sub_u32 s48, s57, s47
    s_lshr_b32 s48, s48, 4
    v_add_u32 v45, s48, v15
    v_add_u32 v45, 123904, v45
    ds_write_b128 v45, v[112:115]
    s_mov_b32 s48, 0x40000000
L_153:
    buffer_store_dwordx4 v[112:115], v15, s[24:27], s48 offen offset:0 sc1
    s_mov_b32 s48, s57
    s_cmp_eq_u32 s34, 1
    s_cbranch_scc0 L_155
    s_sub_u32 s48, s57, s47
    s_lshr_b32 s48, s48, 4
    v_add_u32 v45, s48, v15
    v_add_u32 v45, 123904, v45
    ds_write_b128 v45, v[116:119]
    s_mov_b32 s48, 0x40000000
L_155:
    buffer_store_dwordx4 v[116:119], v15, s[24:27], s48 offen offset:1024 sc1
    s_branch L_RED
L_B3:
    s_mul_i32 s48, s41, 12288
    s_add_u32 s54, s48, 122880
    s_add_u32 s48, s48, 24576
    s_cmp_lt_u32 s41, 2
    s_cselect_b32 s48, s54, s48
    v_add_u32 v45, s48, v15
    v_add_f32 v248, v248, v249
    v_add_f32 v252, v252, v253
    v_mov_b32 v250, v248
    v_mov_b32 v254, v252
    s_nop 0
    v_permlane32_swap_b32 v248, v250
    v_permlane32_swap_b32 v252, v254
    v_add_f32 v248, v248, v250
    v_add_f32 v252, v252, v254
    v_mov_b32 v250, v248
    v_mov_b32 v254, v252
    s_nop 0
    v_permlane16_swap_b32 v248, v250
    v_permlane16_swap_b32 v252, v254
    v_add_f32 v248, v248, v250
    v_add_f32 v252, v252, v254
    v_mov_b32 v249, v248
    v_mov_b32 v253, v252
    v_rcp_f32 v248, v248
    v_rcp_f32 v249, v249
    v_rcp_f32 v252, v252
    v_rcp_f32 v253, v253
    v_pk_mul_f32 v[128:129], v[128:129], v[248:249]
    v_cvt_pk_bf16_f32 v48, v128, v129
    v_pk_mul_f32 v[130:131], v[130:131], v[248:249]
    v_cvt_pk_bf16_f32 v49, v130, v131
    v_pk_mul_f32 v[132:133], v[132:133], v[248:249]
    v_cvt_pk_bf16_f32 v50, v132, v133
    v_pk_mul_f32 v[134:135], v[134:135], v[248:249]
    v_cvt_pk_bf16_f32 v51, v134, v135
    ds_write_b128 v45, v[48:51] offset:0
    v_pk_mul_f32 v[136:137], v[136:137], v[252:253]
    v_cvt_pk_bf16_f32 v52, v136, v137
    v_pk_mul_f32 v[138:139], v[138:139], v[252:253]
    v_cvt_pk_bf16_f32 v53, v138, v139
    v_pk_mul_f32 v[140:141], v[140:141], v[252:253]
    v_cvt_pk_bf16_f32 v54, v140, v141
    v_pk_mul_f32 v[142:143], v[142:143], v[252:253]
    v_cvt_pk_bf16_f32 v55, v142, v143
    ds_write_b128 v45, v[52:55] offset:1024
    v_pk_mul_f32 v[144:145], v[144:145], v[248:249]
    v_cvt_pk_bf16_f32 v56, v144, v145
    v_pk_mul_f32 v[146:147], v[146:147], v[248:249]
    v_cvt_pk_bf16_f32 v57, v146, v147
    v_pk_mul_f32 v[148:149], v[148:149], v[248:249]
    v_cvt_pk_bf16_f32 v58, v148, v149
    v_pk_mul_f32 v[150:151], v[150:151], v[248:249]
    v_cvt_pk_bf16_f32 v59, v150, v151
    ds_write_b128 v45, v[56:59] offset:2048
    v_pk_mul_f32 v[152:153], v[152:153], v[252:253]
    v_cvt_pk_bf16_f32 v60, v152, v153
    v_pk_mul_f32 v[154:155], v[154:155], v[252:253]
    v_cvt_pk_bf16_f32 v61, v154, v155
    v_pk_mul_f32 v[156:157], v[156:157], v[252:253]
    v_cvt_pk_bf16_f32 v62, v156, v157
    v_pk_mul_f32 v[158:159], v[158:159], v[252:253]
    v_cvt_pk_bf16_f32 v63, v158, v159
    ds_write_b128 v45, v[60:63] offset:3072
    v_pk_mul_f32 v[160:161], v[160:161], v[248:249]
    v_cvt_pk_bf16_f32 v64, v160, v161
    v_pk_mul_f32 v[162:163], v[162:163], v[248:249]
    v_cvt_pk_bf16_f32 v65, v162, v163
    v_pk_mul_f32 v[164:165], v[164:165], v[248:249]
    v_cvt_pk_bf16_f32 v66, v164, v165
    v_pk_mul_f32 v[166:167], v[166:167], v[248:249]
    v_cvt_pk_bf16_f32 v67, v166, v167
    ds_write_b128 v45, v[64:67] offset:4096
    v_pk_mul_f32 v[168:169], v[168:169], v[252:253]
    v_cvt_pk_bf16_f32 v68, v168, v169
    v_pk_mul_f32 v[170:171], v[170:171], v[252:253]
    v_cvt_pk_bf16_f32 v69, v170, v171
    v_pk_mul_f32 v[172:173], v[172:173], v[252:253]
    v_cvt_pk_bf16_f32 v70, v172, v173
    v_pk_mul_f32 v[174:175], v[174:175], v[252:253]
    v_cvt_pk_bf16_f32 v71, v174, v175
    ds_write_b128 v45, v[68:71] offset:5120
    v_pk_mul_f32 v[176:177], v[176:177], v[248:249]
    v_cvt_pk_bf16_f32 v72, v176, v177
    v_pk_mul_f32 v[178:179], v[178:179], v[248:249]
    v_cvt_pk_bf16_f32 v73, v178, v179
    v_pk_mul_f32 v[180:181], v[180:181], v[248:249]
    v_cvt_pk_bf16_f32 v74, v180, v181
    v_pk_mul_f32 v[182:183], v[182:183], v[248:249]
    v_cvt_pk_bf16_f32 v75, v182, v183
    ds_write_b128 v45, v[72:75] offset:6144
    v_pk_mul_f32 v[184:185], v[184:185], v[252:253]
    v_cvt_pk_bf16_f32 v76, v184, v185
    v_pk_mul_f32 v[186:187], v[186:187], v[252:253]
    v_cvt_pk_bf16_f32 v77, v186, v187
    v_pk_mul_f32 v[188:189], v[188:189], v[252:253]
    v_cvt_pk_bf16_f32 v78, v188, v189
    v_pk_mul_f32 v[190:191], v[190:191], v[252:253]
    v_cvt_pk_bf16_f32 v79, v190, v191
    ds_write_b128 v45, v[76:79] offset:7168
    v_pk_mul_f32 v[192:193], v[192:193], v[248:249]
    v_cvt_pk_bf16_f32 v80, v192, v193
    v_pk_mul_f32 v[194:195], v[194:195], v[248:249]
    v_cvt_pk_bf16_f32 v81, v194, v195
    v_pk_mul_f32 v[196:197], v[196:197], v[248:249]
    v_cvt_pk_bf16_f32 v82, v196, v197
    v_pk_mul_f32 v[198:199], v[198:199], v[248:249]
    v_cvt_pk_bf16_f32 v83, v198, v199
    ds_write_b128 v45, v[80:83] offset:8192
    v_pk_mul_f32 v[200:201], v[200:201], v[252:253]
    v_cvt_pk_bf16_f32 v84, v200, v201
    v_pk_mul_f32 v[202:203], v[202:203], v[252:253]
    v_cvt_pk_bf16_f32 v85, v202, v203
    v_pk_mul_f32 v[204:205], v[204:205], v[252:253]
    v_cvt_pk_bf16_f32 v86, v204, v205
    v_pk_mul_f32 v[206:207], v[206:207], v[252:253]
    v_cvt_pk_bf16_f32 v87, v206, v207
    ds_write_b128 v45, v[84:87] offset:9216
    v_pk_mul_f32 v[208:209], v[208:209], v[248:249]
    v_cvt_pk_bf16_f32 v88, v208, v209
    v_pk_mul_f32 v[210:211], v[210:211], v[248:249]
    v_cvt_pk_bf16_f32 v89, v210, v211
    v_pk_mul_f32 v[212:213], v[212:213], v[248:249]
    v_cvt_pk_bf16_f32 v90, v212, v213
    v_pk_mul_f32 v[214:215], v[214:215], v[248:249]
    v_cvt_pk_bf16_f32 v91, v214, v215
    ds_write_b128 v45, v[88:91] offset:10240
    v_pk_mul_f32 v[216:217], v[216:217], v[252:253]
    v_cvt_pk_bf16_f32 v92, v216, v217
    v_pk_mul_f32 v[218:219], v[218:219], v[252:253]
    v_cvt_pk_bf16_f32 v93, v218, v219
    v_pk_mul_f32 v[220:221], v[220:221], v[252:253]
    v_cvt_pk_bf16_f32 v94, v220, v221
    v_pk_mul_f32 v[222:223], v[222:223], v[252:253]
    v_cvt_pk_bf16_f32 v95, v222, v223
    ds_write_b128 v45, v[92:95] offset:11264
    s_waitcnt lgkmcnt(0)
    s_barrier
    s_lshl_b32 s48, s41, 11
    s_add_u32 s48, s48, 147456
    v_add_u32 v44, s48, v15
    v_add_u32 v5, 73728, v14
    v_xor_b32 v5, 64, v5
    v_xor_b32 v6, 32, v5
    s_mov_b32 s42, 0
    s_lshr_b32 s48, s42, 7
    s_add_u32 s48, s48, 0
    v_lshrrev_b32 v24, 3, v0
    v_add_u32 v24, s48, v24
    v_mul_u32_u24 v25, 43, v24
    v_lshrrev_b32 v25, 7, v25
    v_mul_u32_u24 v26, 1280, v24
    v_lshrrev_b32 v25, 3, v0
    v_and_b32 v25, 6, v25
    v_xor_b32 v25, v25, v0
    v_and_b32 v25, 7, v25
    v_lshlrev_b32 v25, 4, v25
    v_add_u32 v26, v26, v25
    v_subrev_u32 v12, 0, v26
    s_lshr_b32 s48, s42, 7
    s_add_u32 s48, s48, 8
    v_lshrrev_b32 v24, 3, v0
    v_add_u32 v24, s48, v24
    v_mul_u32_u24 v25, 43, v24
    v_lshrrev_b32 v25, 7, v25
    v_mul_u32_u24 v26, 1280, v24
    v_lshrrev_b32 v25, 3, v0
    v_and_b32 v25, 6, v25
    v_xor_b32 v25, v25, v0
    v_and_b32 v25, 7, v25
    v_lshlrev_b32 v25, 4, v25
    v_add_u32 v26, v26, v25
    v_subrev_u32 v13, 1024, v26
    s_lshr_b32 s48, s42, 7
    s_add_u32 s48, s48, 16
    v_lshrrev_b32 v24, 3, v0
    v_add_u32 v24, s48, v24
    v_mul_u32_u24 v25, 43, v24
    v_lshrrev_b32 v25, 7, v25
    v_mul_u32_u24 v26, 1280, v24
    v_lshrrev_b32 v25, 3, v0
    v_and_b32 v25, 6, v25
    v_xor_b32 v25, v25, v0
    v_and_b32 v25, 7, v25
    v_lshlrev_b32 v25, 4, v25
    v_add_u32 v26, v26, v25
    v_subrev_u32 v4, 2048, v26
    s_mul_i32 s28, s40, 30720
    s_add_u32 s28, s28, 245760
    s_mul_i32 s29, s40, 3072
    s_lshl_b32 s34, s41, 2
    s_lshl_b32 s48, s52, 1
    s_add_u32 s34, s34, s48
    s_and_b32 s48, s55, 15
    s_sub_u32 s34, s48, s34
    ds_read_b128 v[128:131], v44 offset:0
    ds_read_b128 v[132:135], v44 offset:1024
    s_waitcnt lgkmcnt(0)
    v_and_b32 v111, s53, v135
    v_lshlrev_b32 v110, 16, v135
    v_and_b32 v109, s53, v134
    v_lshlrev_b32 v108, 16, v134
    v_and_b32 v107, s53, v133
    v_lshlrev_b32 v106, 16, v133
    v_and_b32 v105, s53, v132
    v_lshlrev_b32 v104, 16, v132
    v_and_b32 v103, s53, v131
    v_lshlrev_b32 v102, 16, v131
    v_and_b32 v101, s53, v130
    v_lshlrev_b32 v100, 16, v130
    v_and_b32 v99, s53, v129
    v_lshlrev_b32 v98, 16, v129
    v_and_b32 v97, s53, v128
    v_lshlrev_b32 v96, 16, v128
    ds_read_b64_tr_b16 v[24:25], v5 offset:0
    ds_read_b64_tr_b16 v[26:27], v5 offset:2048
    ds_read_b64_tr_b16 v[28:29], v5 offset:4096
    ds_read_b64_tr_b16 v[30:31], v5 offset:6144
    ds_read_b64_tr_b16 v[32:33], v5 offset:8192
    ds_read_b64_tr_b16 v[34:35], v5 offset:10240
    s_waitcnt lgkmcnt(4)
    v_mfma_f32_16x16x32_bf16 v[96:99], v[24:27], v[48:51], v[96:99]
    ds_read_b64_tr_b16 v[36:37], v5 offset:12288
    s_waitcnt lgkmcnt(3)
    v_mfma_f32_16x16x32_bf16 v[96:99], v[28:31], v[56:59], v[96:99]
    ds_read_b64_tr_b16 v[38:39], v5 offset:14336
    s_barrier
    ds_read_b128 v[128:131], v44 offset:8192
    ds_read_b128 v[132:135], v44 offset:9216
    s_add_u32 s57, s56, 3
    s_sub_u32 s48, s57, 10
    s_cmp_ge_u32 s57, 10
    s_cselect_b32 s57, s48, s57
    s_mul_i32 s57, s57, 128
    s_add_u32 s57, s57, s45
    s_add_u32 s30, s57, s28
    s_add_u32 m0, s29, 49152
    v_mfma_f32_16x16x32_bf16 v[104:107], v[28:31], v[60:63], v[104:107]
    ds_read_b64_tr_b16 v[40:41], v5 offset:16384
    buffer_load_dwordx4 v12, s[16:19], s30 offen offset:0 lds
    v_mfma_f32_16x16x32_bf16 v[104:107], v[24:27], v[52:55], v[104:107]
    ds_read_b64_tr_b16 v[42:43], v5 offset:18432
    s_waitcnt lgkmcnt(2)
    v_and_b32 v127, s53, v135
    v_mfma_f32_16x16x32_bf16 v[104:107], v[32:35], v[68:71], v[104:107]
    ds_read_b64_tr_b16 v[24:25], v5 offset:20480
    buffer_load_dwordx4 v13, s[16:19], s30 offen offset:1024 lds
    v_lshlrev_b32 v126, 16, v135
    v_mfma_f32_16x16x32_bf16 v[104:107], v[36:39], v[76:79], v[104:107]
    ds_read_b64_tr_b16 v[26:27], v5 offset:22528
    v_and_b32 v125, s53, v134
    v_mfma_f32_16x16x32_bf16 v[96:99], v[36:39], v[72:75], v[96:99]
    ds_read_b64_tr_b16 v[28:29], v6 offset:0
    buffer_load_dwordx4 v4, s[16:19], s30 offen offset:2048 lds
    v_lshlrev_b32 v124, 16, v134
    v_mfma_f32_16x16x32_bf16 v[96:99], v[32:35], v[64:67], v[96:99]
    ds_read_b64_tr_b16 v[30:31], v6 offset:2048
    v_and_b32 v123, s53, v133
    s_waitcnt lgkmcnt(4)
    v_mfma_f32_16x16x32_bf16 v[96:99], v[40:43], v[80:83], v[96:99]
    ds_read_b64_tr_b16 v[32:33], v6 offset:4096
    v_lshlrev_b32 v122, 16, v133
    s_waitcnt lgkmcnt(3)
    v_mfma_f32_16x16x32_bf16 v[96:99], v[24:27], v[88:91], v[96:99]
    ds_read_b64_tr_b16 v[34:35], v6 offset:6144
    v_mfma_f32_16x16x32_bf16 v[104:107], v[24:27], v[92:95], v[104:107]
    ds_read_b64_tr_b16 v[36:37], v6 offset:8192
    v_and_b32 v121, s53, v132
    v_mfma_f32_16x16x32_bf16 v[104:107], v[40:43], v[84:87], v[104:107]
    ds_read_b64_tr_b16 v[38:39], v6 offset:10240
    v_lshlrev_b32 v120, 16, v132
    s_waitcnt lgkmcnt(4)
    v_mfma_f32_16x16x32_bf16 v[108:111], v[28:31], v[52:55], v[108:111]
    ds_read_b64_tr_b16 v[40:41], v6 offset:12288
    v_and_b32 v119, s53, v131
    s_waitcnt lgkmcnt(3)
    v_mfma_f32_16x16x32_bf16 v[108:111], v[32:35], v[60:63], v[108:111]
    ds_read_b64_tr_b16 v[42:43], v6 offset:14336
    v_lshlrev_b32 v118, 16, v131
    v_mfma_f32_16x16x32_bf16 v[100:103], v[32:35], v[56:59], v[100:103]
    ds_read_b64_tr_b16 v[24:25], v6 offset:16384
    v_and_b32 v117, s53, v130
    v_mfma_f32_16x16x32_bf16 v[100:103], v[28:31], v[48:51], v[100:103]
    ds_read_b64_tr_b16 v[26:27], v6 offset:18432
    s_waitcnt lgkmcnt(4)
    v_mfma_f32_16x16x32_bf16 v[100:103], v[36:39], v[64:67], v[100:103]
    ds_read_b64_tr_b16 v[28:29], v6 offset:20480
    v_lshlrev_b32 v116, 16, v130
    s_waitcnt lgkmcnt(3)
    v_mfma_f32_16x16x32_bf16 v[100:103], v[40:43], v[72:75], v[100:103]
    ds_read_b64_tr_b16 v[30:31], v6 offset:22528
    v_and_b32 v115, s53, v129
    v_mfma_f32_16x16x32_bf16 v[108:111], v[40:43], v[76:79], v[108:111]
    v_add_u32 v5, 98304, v14
    v_xor_b32 v5, 64, v5
    v_xor_b32 v6, 32, v5
    ds_read_b64_tr_b16 v[32:33], v5 offset:0
    v_lshlrev_b32 v114, 16, v129
    v_mfma_f32_16x16x32_bf16 v[108:111], v[36:39], v[68:71], v[108:111]
    ds_read_b64_tr_b16 v[34:35], v5 offset:2048
    v_and_b32 v113, s53, v128
    s_waitcnt lgkmcnt(4)
    v_mfma_f32_16x16x32_bf16 v[108:111], v[24:27], v[84:87], v[108:111]
    ds_read_b64_tr_b16 v[36:37], v5 offset:4096
    v_lshlrev_b32 v112, 16, v128
    s_waitcnt lgkmcnt(3)
    v_mfma_f32_16x16x32_bf16 v[108:111], v[28:31], v[92:95], v[108:111]
    ds_read_b64_tr_b16 v[38:39], v5 offset:6144
    v_mfma_f32_16x16x32_bf16 v[100:103], v[28:31], v[88:91], v[100:103]
    ds_read_b64_tr_b16 v[40:41], v5 offset:8192
    v_mfma_f32_16x16x32_bf16 v[100:103], v[24:27], v[80:83], v[100:103]
    ds_read_b64_tr_b16 v[42:43], v5 offset:10240
    s_waitcnt lgkmcnt(4)
    v_mfma_f32_16x16x32_bf16 v[112:115], v[32:35], v[48:51], v[112:115]
    ds_read_b64_tr_b16 v[24:25], v5 offset:12288
    s_waitcnt lgkmcnt(3)
    v_mfma_f32_16x16x32_bf16 v[112:115], v[36:39], v[56:59], v[112:115]
    ds_read_b64_tr_b16 v[26:27], v5 offset:14336
    s_barrier
    ds_read_b128 v[128:131], v44 offset:0
    ds_read_b128 v[132:135], v44 offset:1024
    s_add_u32 s57, s56, 4
    s_sub_u32 s48, s57, 10
    s_cmp_ge_u32 s57, 10
    s_cselect_b32 s57, s48, s57
    s_mul_i32 s57, s57, 128
    s_add_u32 s57, s57, s45
    s_add_u32 s30, s57, s28
    s_add_u32 m0, s29, 73728
    v_mfma_f32_16x16x32_bf16 v[120:123], v[36:39], v[60:63], v[120:123]
    ds_read_b64_tr_b16 v[28:29], v5 offset:16384
    buffer_load_dwordx4 v12, s[16:19], s30 offen offset:0 lds
    v_mfma_f32_16x16x32_bf16 v[120:123], v[32:35], v[52:55], v[120:123]
    ds_read_b64_tr_b16 v[30:31], v5 offset:18432
    v_cvt_pk_bf16_f32 v96, v96, v97
    v_cvt_pk_bf16_f32 v97, v98, v99
    s_waitcnt lgkmcnt(6)
    v_mfma_f32_16x16x32_bf16 v[120:123], v[40:43], v[68:71], v[120:123]
    ds_read_b64_tr_b16 v[32:33], v5 offset:20480
    buffer_load_dwordx4 v13, s[16:19], s30 offen offset:1024 lds
    v_cvt_pk_bf16_f32 v98, v100, v101
    s_waitcnt lgkmcnt(5)
    v_mfma_f32_16x16x32_bf16 v[120:123], v[24:27], v[76:79], v[120:123]
    ds_read_b64_tr_b16 v[34:35], v5 offset:22528
    s_add_u32 s57, s56, 9
    s_sub_u32 s48, s57, 10
    s_cmp_ge_u32 s57, 10
    s_cselect_b32 s57, s48, s57
    s_mul_i32 s57, s57, 16384
    s_add_u32 s57, s57, s47
    v_cvt_pk_bf16_f32 v99, v102, v103
    v_mfma_f32_16x16x32_bf16 v[112:115], v[24:27], v[72:75], v[112:115]
    ds_read_b64_tr_b16 v[36:37], v6 offset:0
    buffer_load_dwordx4 v4, s[16:19], s30 offen offset:2048 lds
    v_cvt_pk_bf16_f32 v100, v104, v105
    v_mfma_f32_16x16x32_bf16 v[112:115], v[40:43], v[64:67], v[112:115]
    ds_read_b64_tr_b16 v[38:39], v6 offset:2048
    v_cvt_pk_bf16_f32 v101, v106, v107
    v_cvt_pk_bf16_f32 v102, v108, v109
    s_waitcnt lgkmcnt(4)
    v_mfma_f32_16x16x32_bf16 v[112:115], v[28:31], v[80:83], v[112:115]
    ds_read_b64_tr_b16 v[40:41], v6 offset:4096
    v_cvt_pk_bf16_f32 v103, v110, v111
    s_waitcnt lgkmcnt(3)
    v_mfma_f32_16x16x32_bf16 v[112:115], v[32:35], v[88:91], v[112:115]
    ds_read_b64_tr_b16 v[42:43], v6 offset:6144
    s_mov_b32 s48, s57
    s_cmp_eq_u32 s34, 0
    s_cbranch_scc0 L_157
    s_sub_u32 s48, s57, s47
    s_lshr_b32 s48, s48, 4
    v_add_u32 v45, s48, v15
    v_add_u32 v45, 123904, v45
    ds_write_b128 v45, v[96:99]
    s_mov_b32 s48, 0x40000000
L_157:
    buffer_store_dwordx4 v[96:99], v15, s[24:27], s48 offen offset:2048 sc1
    v_mfma_f32_16x16x32_bf16 v[120:123], v[32:35], v[92:95], v[120:123]
    ds_read_b64_tr_b16 v[24:25], v6 offset:8192
    s_mov_b32 s48, s57
    s_cmp_eq_u32 s34, 1
    s_cbranch_scc0 L_159
    s_sub_u32 s48, s57, s47
    s_lshr_b32 s48, s48, 4
    v_add_u32 v45, s48, v15
    v_add_u32 v45, 123904, v45
    ds_write_b128 v45, v[100:103]
    s_mov_b32 s48, 0x40000000
L_159:
    buffer_store_dwordx4 v[100:103], v15, s[24:27], s48 offen offset:3072 sc1
    v_and_b32 v111, s53, v135
    v_mfma_f32_16x16x32_bf16 v[120:123], v[28:31], v[84:87], v[120:123]
    ds_read_b64_tr_b16 v[26:27], v6 offset:10240
    v_lshlrev_b32 v110, 16, v135
    s_waitcnt lgkmcnt(4)
    v_mfma_f32_16x16x32_bf16 v[124:127], v[36:39], v[52:55], v[124:127]
    ds_read_b64_tr_b16 v[28:29], v6 offset:12288
    v_and_b32 v109, s53, v134
    v_lshlrev_b32 v108, 16, v134
    s_waitcnt lgkmcnt(3)
    v_mfma_f32_16x16x32_bf16 v[124:127], v[40:43], v[60:63], v[124:127]
    ds_read_b64_tr_b16 v[30:31], v6 offset:14336
    v_and_b32 v107, s53, v133
    v_mfma_f32_16x16x32_bf16 v[116:119], v[40:43], v[56:59], v[116:119]
    ds_read_b64_tr_b16 v[32:33], v6 offset:16384
    v_lshlrev_b32 v106, 16, v133
    v_and_b32 v105, s53, v132
    v_mfma_f32_16x16x32_bf16 v[116:119], v[36:39], v[48:51], v[116:119]
    ds_read_b64_tr_b16 v[34:35], v6 offset:18432
    v_lshlrev_b32 v104, 16, v132
    s_waitcnt lgkmcnt(4)
    v_mfma_f32_16x16x32_bf16 v[116:119], v[24:27], v[64:67], v[116:119]
    ds_read_b64_tr_b16 v[36:37], v6 offset:20480
    v_and_b32 v103, s53, v131
    s_waitcnt lgkmcnt(3)
    v_mfma_f32_16x16x32_bf16 v[116:119], v[28:31], v[72:75], v[116:119]
    ds_read_b64_tr_b16 v[38:39], v6 offset:22528
    v_lshlrev_b32 v102, 16, v131
    v_and_b32 v101, s53, v130
    v_mfma_f32_16x16x32_bf16 v[124:127], v[28:31], v[76:79], v[124:127]
    v_add_u32 v5, 0, v14
    v_xor_b32 v5, 64, v5
    v_xor_b32 v6, 32, v5
    ds_read_b64_tr_b16 v[40:41], v5 offset:0
    v_lshlrev_b32 v100, 16, v130
    v_mfma_f32_16x16x32_bf16 v[124:127], v[24:27], v[68:71], v[124:127]
    ds_read_b64_tr_b16 v[42:43], v5 offset:2048
    v_and_b32 v99, s53, v129
    v_lshlrev_b32 v98, 16, v129
    s_waitcnt lgkmcnt(4)
    v_mfma_f32_16x16x32_bf16 v[124:127], v[32:35], v[84:87], v[124:127]
    ds_read_b64_tr_b16 v[24:25], v5 offset:4096
    v_and_b32 v97, s53, v128
    s_waitcnt lgkmcnt(3)
    v_mfma_f32_16x16x32_bf16 v[124:127], v[36:39], v[92:95], v[124:127]
    ds_read_b64_tr_b16 v[26:27], v5 offset:6144
    v_lshlrev_b32 v96, 16, v128
    v_mfma_f32_16x16x32_bf16 v[116:119], v[36:39], v[88:91], v[116:119]
    ds_read_b64_tr_b16 v[28:29], v5 offset:8192
    v_mfma_f32_16x16x32_bf16 v[116:119], v[32:35], v[80:83], v[116:119]
    ds_read_b64_tr_b16 v[30:31], v5 offset:10240
    s_waitcnt lgkmcnt(4)
    v_mfma_f32_16x16x32_bf16 v[96:99], v[40:43], v[48:51], v[96:99]
    ds_read_b64_tr_b16 v[32:33], v5 offset:12288
    s_waitcnt lgkmcnt(3)
    v_mfma_f32_16x16x32_bf16 v[96:99], v[24:27], v[56:59], v[96:99]
    ds_read_b64_tr_b16 v[34:35], v5 offset:14336
    s_barrier
    ds_read_b128 v[128:131], v44 offset:8192
    ds_read_b128 v[132:135], v44 offset:9216
    s_add_u32 s57, s56, 5
    s_sub_u32 s48, s57, 10
    s_cmp_ge_u32 s57, 10
    s_cselect_b32 s57, s48, s57
    s_mul_i32 s57, s57, 128
    s_add_u32 s57, s57, s45
    s_add_u32 s30, s57, s28
    s_add_u32 m0, s29, 98304
    v_mfma_f32_16x16x32_bf16 v[104:107], v[24:27], v[60:63], v[104:107]
    ds_read_b64_tr_b16 v[36:37], v5 offset:16384
    buffer_load_dwordx4 v12, s[16:19], s30 offen offset:0 lds
    v_mfma_f32_16x16x32_bf16 v[104:107], v[40:43], v[52:55], v[104:107]
    ds_read_b64_tr_b16 v[38:39], v5 offset:18432
    v_cvt_pk_bf16_f32 v112, v112, v113
    v_cvt_pk_bf16_f32 v113, v114, v115
    s_waitcnt lgkmcnt(6)
    v_mfma_f32_16x16x32_bf16 v[104:107], v[28:31], v[68:71], v[104:107]
    ds_read_b64_tr_b16 v[40:41], v5 offset:20480
    buffer_load_dwordx4 v13, s[16:19], s30 offen offset:1024 lds
    v_cvt_pk_bf16_f32 v114, v116, v117
    s_waitcnt lgkmcnt(5)
    v_mfma_f32_16x16x32_bf16 v[104:107], v[32:35], v[76:79], v[104:107]
    ds_read_b64_tr_b16 v[42:43], v5 offset:22528
    s_add_u32 s57, s56, 0
    s_sub_u32 s48, s57, 10
    s_cmp_ge_u32 s57, 10
    s_cselect_b32 s57, s48, s57
    s_mul_i32 s57, s57, 16384
    s_add_u32 s57, s57, s47
    v_cvt_pk_bf16_f32 v115, v118, v119
    v_mfma_f32_16x16x32_bf16 v[96:99], v[32:35], v[72:75], v[96:99]
    ds_read_b64_tr_b16 v[24:25], v6 offset:0
    buffer_load_dwordx4 v4, s[16:19], s30 offen offset:2048 lds
    v_cvt_pk_bf16_f32 v116, v120, v121
    v_mfma_f32_16x16x32_bf16 v[96:99], v[28:31], v[64:67], v[96:99]
    ds_read_b64_tr_b16 v[26:27], v6 offset:2048
    v_cvt_pk_bf16_f32 v117, v122, v123
    v_cvt_pk_bf16_f32 v118, v124, v125
    s_waitcnt lgkmcnt(4)
    v_mfma_f32_16x16x32_bf16 v[96:99], v[36:39], v[80:83], v[96:99]
    ds_read_b64_tr_b16 v[28:29], v6 offset:4096
    v_cvt_pk_bf16_f32 v119, v126, v127
    s_waitcnt lgkmcnt(3)
    v_mfma_f32_16x16x32_bf16 v[96:99], v[40:43], v[88:91], v[96:99]
    ds_read_b64_tr_b16 v[30:31], v6 offset:6144
    s_mov_b32 s48, s57
    s_cmp_eq_u32 s34, 0
    s_cbranch_scc0 L_161
    s_sub_u32 s48, s57, s47
    s_lshr_b32 s48, s48, 4
    v_add_u32 v45, s48, v15
    v_add_u32 v45, 123904, v45
    ds_write_b128 v45, v[112:115]
    s_mov_b32 s48, 0x40000000
L_161:
    buffer_store_dwordx4 v[112:115], v15, s[24:27], s48 offen offset:2048 sc1
    v_mfma_f32_16x16x32_bf16 v[104:107], v[40:43], v[92:95], v[104:107]
    ds_read_b64_tr_b16 v[32:33], v6 offset:8192
    s_mov_b32 s48, s57
    s_cmp_eq_u32 s34, 1
    s_cbranch_scc0 L_163
    s_sub_u32 s48, s57, s47
    s_lshr_b32 s48, s48, 4
    v_add_u32 v45, s48, v15
    v_add_u32 v45, 123904, v45
    ds_write_b128 v45, v[116:119]
    s_mov_b32 s48, 0x40000000
L_163:
    buffer_store_dwordx4 v[116:119], v15, s[24:27], s48 offen offset:3072 sc1
    v_and_b32 v127, s53, v135
    v_mfma_f32_16x16x32_bf16 v[104:107], v[36:39], v[84:87], v[104:107]
    ds_read_b64_tr_b16 v[34:35], v6 offset:10240
    v_lshlrev_b32 v126, 16, v135
    s_waitcnt lgkmcnt(4)
    v_mfma_f32_16x16x32_bf16 v[108:111], v[24:27], v[52:55], v[108:111]
    ds_read_b64_tr_b16 v[36:37], v6 offset:12288
    v_and_b32 v125, s53, v134
    v_lshlrev_b32 v124, 16, v134
    s_waitcnt lgkmcnt(3)
    v_mfma_f32_16x16x32_bf16 v[108:111], v[28:31], v[60:63], v[108:111]
    ds_read_b64_tr_b16 v[38:39], v6 offset:14336
    v_and_b32 v123, s53, v133
    v_mfma_f32_16x16x32_bf16 v[100:103], v[28:31], v[56:59], v[100:103]
    ds_read_b64_tr_b16 v[40:41], v6 offset:16384
    v_lshlrev_b32 v122, 16, v133
    v_and_b32 v121, s53, v132
    v_mfma_f32_16x16x32_bf16 v[100:103], v[24:27], v[48:51], v[100:103]
    ds_read_b64_tr_b16 v[42:43], v6 offset:18432
    v_lshlrev_b32 v120, 16, v132
    s_waitcnt lgkmcnt(4)
    v_mfma_f32_16x16x32_bf16 v[100:103], v[32:35], v[64:67], v[100:103]
    ds_read_b64_tr_b16 v[24:25], v6 offset:20480
    v_and_b32 v119, s53, v131
    s_waitcnt lgkmcnt(3)
    v_mfma_f32_16x16x32_bf16 v[100:103], v[36:39], v[72:75], v[100:103]
    ds_read_b64_tr_b16 v[26:27], v6 offset:22528
    v_lshlrev_b32 v118, 16, v131
    v_and_b32 v117, s53, v130
    v_mfma_f32_16x16x32_bf16 v[108:111], v[36:39], v[76:79], v[108:111]
    v_add_u32 v5, 24576, v14
    v_xor_b32 v5, 64, v5
    v_xor_b32 v6, 32, v5
    ds_read_b64_tr_b16 v[28:29], v5 offset:0
    v_lshlrev_b32 v116, 16, v130
    v_mfma_f32_16x16x32_bf16 v[108:111], v[32:35], v[68:71], v[108:111]
    ds_read_b64_tr_b16 v[30:31], v5 offset:2048
    v_and_b32 v115, s53, v129
    v_lshlrev_b32 v114, 16, v129
    s_waitcnt lgkmcnt(4)
    v_mfma_f32_16x16x32_bf16 v[108:111], v[40:43], v[84:87], v[108:111]
    ds_read_b64_tr_b16 v[32:33], v5 offset:4096
    v_and_b32 v113, s53, v128
    s_waitcnt lgkmcnt(3)
    v_mfma_f32_16x16x32_bf16 v[108:111], v[24:27], v[92:95], v[108:111]
    ds_read_b64_tr_b16 v[34:35], v5 offset:6144
    v_lshlrev_b32 v112, 16, v128
    v_mfma_f32_16x16x32_bf16 v[100:103], v[24:27], v[88:91], v[100:103]
    ds_read_b64_tr_b16 v[36:37], v5 offset:8192
    v_mfma_f32_16x16x32_bf16 v[100:103], v[40:43], v[80:83], v[100:103]
    ds_read_b64_tr_b16 v[38:39], v5 offset:10240
    s_waitcnt lgkmcnt(4)
    v_mfma_f32_16x16x32_bf16 v[112:115], v[28:31], v[48:51], v[112:115]
    ds_read_b64_tr_b16 v[40:41], v5 offset:12288
    s_waitcnt lgkmcnt(3)
    v_mfma_f32_16x16x32_bf16 v[112:115], v[32:35], v[56:59], v[112:115]
    ds_read_b64_tr_b16 v[42:43], v5 offset:14336
    s_waitcnt vmcnt(10)
    s_barrier
    ds_read_b128 v[128:131], v44 offset:0
    ds_read_b128 v[132:135], v44 offset:1024
    s_add_u32 s57, s56, 6
    s_sub_u32 s48, s57, 10
    s_cmp_ge_u32 s57, 10
    s_cselect_b32 s57, s48, s57
    s_mul_i32 s57, s57, 128
    s_add_u32 s57, s57, s45
    s_add_u32 s30, s57, s28
    s_add_u32 m0, s29, 0
    v_mfma_f32_16x16x32_bf16 v[120:123], v[32:35], v[60:63], v[120:123]
    ds_read_b64_tr_b16 v[24:25], v5 offset:16384
    buffer_load_dwordx4 v12, s[16:19], s30 offen offset:0 lds
    v_mfma_f32_16x16x32_bf16 v[120:123], v[28:31], v[52:55], v[120:123]
    ds_read_b64_tr_b16 v[26:27], v5 offset:18432
    v_cvt_pk_bf16_f32 v96, v96, v97
    v_cvt_pk_bf16_f32 v97, v98, v99
    s_waitcnt lgkmcnt(6)
    v_mfma_f32_16x16x32_bf16 v[120:123], v[36:39], v[68:71], v[120:123]
    ds_read_b64_tr_b16 v[28:29], v5 offset:20480
    buffer_load_dwordx4 v13, s[16:19], s30 offen offset:1024 lds
    v_cvt_pk_bf16_f32 v98, v100, v101
    s_waitcnt lgkmcnt(5)
    v_mfma_f32_16x16x32_bf16 v[120:123], v[40:43], v[76:79], v[120:123]
    ds_read_b64_tr_b16 v[30:31], v5 offset:22528
    s_add_u32 s57, s56, 1
    s_sub_u32 s48, s57, 10
    s_cmp_ge_u32 s57, 10
    s_cselect_b32 s57, s48, s57
    s_mul_i32 s57, s57, 16384
    s_add_u32 s57, s57, s47
    v_cvt_pk_bf16_f32 v99, v102, v103
    v_mfma_f32_16x16x32_bf16 v[112:115], v[40:43], v[72:75], v[112:115]
    ds_read_b64_tr_b16 v[32:33], v6 offset:0
    buffer_load_dwordx4 v4, s[16:19], s30 offen offset:2048 lds
    v_cvt_pk_bf16_f32 v100, v104, v105
    v_mfma_f32_16x16x32_bf16 v[112:115], v[36:39], v[64:67], v[112:115]
    ds_read_b64_tr_b16 v[34:35], v6 offset:2048
    v_cvt_pk_bf16_f32 v101, v106, v107
    v_cvt_pk_bf16_f32 v102, v108, v109
    s_waitcnt lgkmcnt(4)
    v_mfma_f32_16x16x32_bf16 v[112:115], v[24:27], v[80:83], v[112:115]
    ds_read_b64_tr_b16 v[36:37], v6 offset:4096
    v_cvt_pk_bf16_f32 v103, v110, v111
    s_waitcnt lgkmcnt(3)
    v_mfma_f32_16x16x32_bf16 v[112:115], v[28:31], v[88:91], v[112:115]
    ds_read_b64_tr_b16 v[38:39], v6 offset:6144
    s_mov_b32 s48, s57
    s_cmp_eq_u32 s34, 0
    s_cbranch_scc0 L_165
    s_sub_u32 s48, s57, s47
    s_lshr_b32 s48, s48, 4
    v_add_u32 v45, s48, v15
    v_add_u32 v45, 123904, v45
    ds_write_b128 v45, v[96:99]
    s_mov_b32 s48, 0x40000000
L_165:
    buffer_store_dwordx4 v[96:99], v15, s[24:27], s48 offen offset:2048 sc1
    v_mfma_f32_16x16x32_bf16 v[120:123], v[28:31], v[92:95], v[120:123]
    ds_read_b64_tr_b16 v[40:41], v6 offset:8192
    s_mov_b32 s48, s57
    s_cmp_eq_u32 s34, 1
    s_cbranch_scc0 L_167
    s_sub_u32 s48, s57, s47
    s_lshr_b32 s48, s48, 4
    v_add_u32 v45, s48, v15
    v_add_u32 v45, 123904, v45
    ds_write_b128 v45, v[100:103]
    s_mov_b32 s48, 0x40000000
L_167:
    buffer_store_dwordx4 v[100:103], v15, s[24:27], s48 offen offset:3072 sc1
    v_and_b32 v111, s53, v135
    v_mfma_f32_16x16x32_bf16 v[120:123], v[24:27], v[84:87], v[120:123]
    ds_read_b64_tr_b16 v[42:43], v6 offset:10240
    v_lshlrev_b32 v110, 16, v135
    s_waitcnt lgkmcnt(4)
    v_mfma_f32_16x16x32_bf16 v[124:127], v[32:35], v[52:55], v[124:127]
    ds_read_b64_tr_b16 v[24:25], v6 offset:12288
    v_and_b32 v109, s53, v134
    v_lshlrev_b32 v108, 16, v134
    s_waitcnt lgkmcnt(3)
    v_mfma_f32_16x16x32_bf16 v[124:127], v[36:39], v[60:63], v[124:127]
    ds_read_b64_tr_b16 v[26:27], v6 offset:14336
    v_and_b32 v107, s53, v133
    v_mfma_f32_16x16x32_bf16 v[116:119], v[36:39], v[56:59], v[116:119]
    ds_read_b64_tr_b16 v[28:29], v6 offset:16384
    v_lshlrev_b32 v106, 16, v133
    v_and_b32 v105, s53, v132
    v_mfma_f32_16x16x32_bf16 v[116:119], v[32:35], v[48:51], v[116:119]
    ds_read_b64_tr_b16 v[30:31], v6 offset:18432
    v_lshlrev_b32 v104, 16, v132
    s_waitcnt lgkmcnt(4)
    v_mfma_f32_16x16x32_bf16 v[116:119], v[40:43], v[64:67], v[116:119]
    ds_read_b64_tr_b16 v[32:33], v6 offset:20480
    v_and_b32 v103, s53, v131
    s_waitcnt lgkmcnt(3)
    v_mfma_f32_16x16x32_bf16 v[116:119], v[24:27], v[72:75], v[116:119]
    ds_read_b64_tr_b16 v[34:35], v6 offset:22528
    v_lshlrev_b32 v102, 16, v131
    v_and_b32 v101, s53, v130
    v_mfma_f32_16x16x32_bf16 v[124:127], v[24:27], v[76:79], v[124:127]
    v_add_u32 v5, 49152, v14
    v_xor_b32 v5, 64, v5
    v_xor_b32 v6, 32, v5
    ds_read_b64_tr_b16 v[36:37], v5 offset:0
    v_lshlrev_b32 v100, 16, v130
    v_mfma_f32_16x16x32_bf16 v[124:127], v[40:43], v[68:71], v[124:127]
    ds_read_b64_tr_b16 v[38:39], v5 offset:2048
    v_and_b32 v99, s53, v129
    v_lshlrev_b32 v98, 16, v129
    s_waitcnt lgkmcnt(4)
    v_mfma_f32_16x16x32_bf16 v[124:127], v[28:31], v[84:87], v[124:127]
    ds_read_b64_tr_b16 v[40:41], v5 offset:4096
    v_and_b32 v97, s53, v128
    s_waitcnt lgkmcnt(3)
    v_mfma_f32_16x16x32_bf16 v[124:127], v[32:35], v[92:95], v[124:127]
    ds_read_b64_tr_b16 v[42:43], v5 offset:6144
    v_lshlrev_b32 v96, 16, v128
    v_mfma_f32_16x16x32_bf16 v[116:119], v[32:35], v[88:91], v[116:119]
    ds_read_b64_tr_b16 v[24:25], v5 offset:8192
    v_mfma_f32_16x16x32_bf16 v[116:119], v[28:31], v[80:83], v[116:119]
    ds_read_b64_tr_b16 v[26:27], v5 offset:10240
    s_waitcnt lgkmcnt(4)
    v_mfma_f32_16x16x32_bf16 v[96:99], v[36:39], v[48:51], v[96:99]
    ds_read_b64_tr_b16 v[28:29], v5 offset:12288
    s_waitcnt lgkmcnt(3)
    v_mfma_f32_16x16x32_bf16 v[96:99], v[40:43], v[56:59], v[96:99]
    ds_read_b64_tr_b16 v[30:31], v5 offset:14336
    s_waitcnt vmcnt(12)
    s_barrier
    ds_read_b128 v[128:131], v44 offset:8192
    ds_read_b128 v[132:135], v44 offset:9216
    s_add_u32 s57, s56, 7
    s_sub_u32 s48, s57, 10
    s_cmp_ge_u32 s57, 10
    s_cselect_b32 s57, s48, s57
    s_mul_i32 s57, s57, 128
    s_add_u32 s57, s57, s45
    s_add_u32 s30, s57, s28
    s_add_u32 m0, s29, 24576
    v_mfma_f32_16x16x32_bf16 v[104:107], v[40:43], v[60:63], v[104:107]
    ds_read_b64_tr_b16 v[32:33], v5 offset:16384
    buffer_load_dwordx4 v12, s[16:19], s30 offen offset:0 lds
    v_mfma_f32_16x16x32_bf16 v[104:107], v[36:39], v[52:55], v[104:107]
    ds_read_b64_tr_b16 v[34:35], v5 offset:18432
    v_cvt_pk_bf16_f32 v112, v112, v113
    v_cvt_pk_bf16_f32 v113, v114, v115
    s_waitcnt lgkmcnt(6)
    v_mfma_f32_16x16x32_bf16 v[104:107], v[24:27], v[68:71], v[104:107]
    ds_read_b64_tr_b16 v[36:37], v5 offset:20480
    buffer_load_dwordx4 v13, s[16:19], s30 offen offset:1024 lds
    v_cvt_pk_bf16_f32 v114, v116, v117
    s_waitcnt lgkmcnt(5)
    v_mfma_f32_16x16x32_bf16 v[104:107], v[28:31], v[76:79], v[104:107]
    ds_read_b64_tr_b16 v[38:39], v5 offset:22528
    s_add_u32 s57, s56, 2
    s_sub_u32 s48, s57, 10
    s_cmp_ge_u32 s57, 10
    s_cselect_b32 s57, s48, s57
    s_mul_i32 s57, s57, 16384
    s_add_u32 s57, s57, s47
    v_cvt_pk_bf16_f32 v115, v118, v119
    v_mfma_f32_16x16x32_bf16 v[96:99], v[28:31], v[72:75], v[96:99]
    ds_read_b64_tr_b16 v[40:41], v6 offset:0
    buffer_load_dwordx4 v4, s[16:19], s30 offen offset:2048 lds
    v_cvt_pk_bf16_f32 v116, v120, v121
    v_mfma_f32_16x16x32_bf16 v[96:99], v[24:27], v[64:67], v[96:99]
    ds_read_b64_tr_b16 v[42:43], v6 offset:2048
    v_cvt_pk_bf16_f32 v117, v122, v123
    v_cvt_pk_bf16_f32 v118, v124, v125
    s_waitcnt lgkmcnt(4)
    v_mfma_f32_16x16x32_bf16 v[96:99], v[32:35], v[80:83], v[96:99]
    ds_read_b64_tr_b16 v[24:25], v6 offset:4096
    v_cvt_pk_bf16_f32 v119, v126, v127
    s_waitcnt lgkmcnt(3)
    v_mfma_f32_16x16x32_bf16 v[96:99], v[36:39], v[88:91], v[96:99]
    ds_read_b64_tr_b16 v[26:27], v6 offset:6144
    s_mov_b32 s48, s57
    s_cmp_eq_u32 s34, 0
    s_cbranch_scc0 L_169
    s_sub_u32 s48, s57, s47
    s_lshr_b32 s48, s48, 4
    v_add_u32 v45, s48, v15
    v_add_u32 v45, 123904, v45
    ds_write_b128 v45, v[112:115]
    s_mov_b32 s48, 0x40000000
L_169:
    buffer_store_dwordx4 v[112:115], v15, s[24:27], s48 offen offset:2048 sc1
    v_mfma_f32_16x16x32_bf16 v[104:107], v[36:39], v[92:95], v[104:107]
    ds_read_b64_tr_b16 v[28:29], v6 offset:8192
    s_mov_b32 s48, s57
    s_cmp_eq_u32 s34, 1
    s_cbranch_scc0 L_171
    s_sub_u32 s48, s57, s47
    s_lshr_b32 s48, s48, 4
    v_add_u32 v45, s48, v15
    v_add_u32 v45, 123904, v45
    ds_write_b128 v45, v[116:119]
    s_mov_b32 s48, 0x40000000
L_171:
    buffer_store_dwordx4 v[116:119], v15, s[24:27], s48 offen offset:3072 sc1
    v_and_b32 v127, s53, v135
    v_mfma_f32_16x16x32_bf16 v[104:107], v[32:35], v[84:87], v[104:107]
    ds_read_b64_tr_b16 v[30:31], v6 offset:10240
    v_lshlrev_b32 v126, 16, v135
    s_waitcnt lgkmcnt(4)
    v_mfma_f32_16x16x32_bf16 v[108:111], v[40:43], v[52:55], v[108:111]
    ds_read_b64_tr_b16 v[32:33], v6 offset:12288
    v_and_b32 v125, s53, v134
    v_lshlrev_b32 v124, 16, v134
    s_waitcnt lgkmcnt(3)
    v_mfma_f32_16x16x32_bf16 v[108:111], v[24:27], v[60:63], v[108:111]
    ds_read_b64_tr_b16 v[34:35], v6 offset:14336
    v_and_b32 v123, s53, v133
    v_mfma_f32_16x16x32_bf16 v[100:103], v[24:27], v[56:59], v[100:103]
    ds_read_b64_tr_b16 v[36:37], v6 offset:16384
    v_lshlrev_b32 v122, 16, v133
    v_and_b32 v121, s53, v132
    v_mfma_f32_16x16x32_bf16 v[100:103], v[40:43], v[48:51], v[100:103]
    ds_read_b64_tr_b16 v[38:39], v6 offset:18432
    v_lshlrev_b32 v120, 16, v132
    s_waitcnt lgkmcnt(4)
    v_mfma_f32_16x16x32_bf16 v[100:103], v[28:31], v[64:67], v[100:103]
    ds_read_b64_tr_b16 v[40:41], v6 offset:20480
    v_and_b32 v119, s53, v131
    s_waitcnt lgkmcnt(3)
    v_mfma_f32_16x16x32_bf16 v[100:103], v[32:35], v[72:75], v[100:103]
    ds_read_b64_tr_b16 v[42:43], v6 offset:22528
    v_lshlrev_b32 v118, 16, v131
    v_and_b32 v117, s53, v130
    v_mfma_f32_16x16x32_bf16 v[108:111], v[32:35], v[76:79], v[108:111]
    v_add_u32 v5, 73728, v14
    v_xor_b32 v5, 64, v5
    v_xor_b32 v6, 32, v5
    ds_read_b64_tr_b16 v[24:25], v5 offset:0
    v_lshlrev_b32 v116, 16, v130
    v_mfma_f32_16x16x32_bf16 v[108:111], v[28:31], v[68:71], v[108:111]
    ds_read_b64_tr_b16 v[26:27], v5 offset:2048
    v_and_b32 v115, s53, v129
    v_lshlrev_b32 v114, 16, v129
    s_waitcnt lgkmcnt(4)
    v_mfma_f32_16x16x32_bf16 v[108:111], v[36:39], v[84:87], v[108:111]
    ds_read_b64_tr_b16 v[28:29], v5 offset:4096
    v_and_b32 v113, s53, v128
    s_waitcnt lgkmcnt(3)
    v_mfma_f32_16x16x32_bf16 v[108:111], v[40:43], v[92:95], v[108:111]
    ds_read_b64_tr_b16 v[30:31], v5 offset:6144
    v_lshlrev_b32 v112, 16, v128
    v_mfma_f32_16x16x32_bf16 v[100:103], v[40:43], v[88:91], v[100:103]
    ds_read_b64_tr_b16 v[32:33], v5 offset:8192
    v_mfma_f32_16x16x32_bf16 v[100:103], v[36:39], v[80:83], v[100:103]
    ds_read_b64_tr_b16 v[34:35], v5 offset:10240
    s_waitcnt lgkmcnt(4)
    v_mfma_f32_16x16x32_bf16 v[112:115], v[24:27], v[48:51], v[112:115]
    ds_read_b64_tr_b16 v[36:37], v5 offset:12288
    s_waitcnt lgkmcnt(3)
    v_mfma_f32_16x16x32_bf16 v[112:115], v[28:31], v[56:59], v[112:115]
    ds_read_b64_tr_b16 v[38:39], v5 offset:14336
    s_waitcnt vmcnt(12)
    s_barrier
    ds_read_b128 v[128:131], v44 offset:0
    ds_read_b128 v[132:135], v44 offset:1024
    s_add_u32 s57, s56, 8
    s_sub_u32 s48, s57, 10
    s_cmp_ge_u32 s57, 10
    s_cselect_b32 s57, s48, s57
    s_mul_i32 s57, s57, 128
    s_add_u32 s57, s57, s45
    s_add_u32 s30, s57, s28
    s_add_u32 m0, s29, 49152
    v_mfma_f32_16x16x32_bf16 v[120:123], v[28:31], v[60:63], v[120:123]
    ds_read_b64_tr_b16 v[40:41], v5 offset:16384
    buffer_load_dwordx4 v12, s[16:19], s30 offen offset:0 lds
    v_mfma_f32_16x16x32_bf16 v[120:123], v[24:27], v[52:55], v[120:123]
    ds_read_b64_tr_b16 v[42:43], v5 offset:18432
    v_cvt_pk_bf16_f32 v96, v96, v97
    v_cvt_pk_bf16_f32 v97, v98, v99
    s_waitcnt lgkmcnt(6)
    v_mfma_f32_16x16x32_bf16 v[120:123], v[32:35], v[68:71], v[120:123]
    ds_read_b64_tr_b16 v[24:25], v5 offset:20480
    buffer_load_dwordx4 v13, s[16:19], s30 offen offset:1024 lds
    v_cvt_pk_bf16_f32 v98, v100, v101
    s_waitcnt lgkmcnt(5)
    v_mfma_f32_16x16x32_bf16 v[120:123], v[36:39], v[76:79], v[120:123]
    ds_read_b64_tr_b16 v[26:27], v5 offset:22528
    s_add_u32 s57, s56, 3
    s_sub_u32 s48, s57, 10
    s_cmp_ge_u32 s57, 10
    s_cselect_b32 s57, s48, s57
    s_mul_i32 s57, s57, 16384
    s_add_u32 s57, s57, s47
    v_cvt_pk_bf16_f32 v99, v102, v103
    v_mfma_f32_16x16x32_bf16 v[112:115], v[36:39], v[72:75], v[112:115]
    ds_read_b64_tr_b16 v[28:29], v6 offset:0
    buffer_load_dwordx4 v4, s[16:19], s30 offen offset:2048 lds
    v_cvt_pk_bf16_f32 v100, v104, v105
    v_mfma_f32_16x16x32_bf16 v[112:115], v[32:35], v[64:67], v[112:115]
    ds_read_b64_tr_b16 v[30:31], v6 offset:2048
    v_cvt_pk_bf16_f32 v101, v106, v107
    v_cvt_pk_bf16_f32 v102, v108, v109
    s_waitcnt lgkmcnt(4)
    v_mfma_f32_16x16x32_bf16 v[112:115], v[40:43], v[80:83], v[112:115]
    ds_read_b64_tr_b16 v[32:33], v6 offset:4096
    v_cvt_pk_bf16_f32 v103, v110, v111
    s_waitcnt lgkmcnt(3)
    v_mfma_f32_16x16x32_bf16 v[112:115], v[24:27], v[88:91], v[112:115]
    ds_read_b64_tr_b16 v[34:35], v6 offset:6144
    s_mov_b32 s48, s57
    s_cmp_eq_u32 s34, 0
    s_cbranch_scc0 L_173
    s_sub_u32 s48, s57, s47
    s_lshr_b32 s48, s48, 4
    v_add_u32 v45, s48, v15
    v_add_u32 v45, 123904, v45
    ds_write_b128 v45, v[96:99]
    s_mov_b32 s48, 0x40000000
L_173:
    buffer_store_dwordx4 v[96:99], v15, s[24:27], s48 offen offset:2048 sc1
    v_mfma_f32_16x16x32_bf16 v[120:123], v[24:27], v[92:95], v[120:123]
    ds_read_b64_tr_b16 v[36:37], v6 offset:8192
    s_mov_b32 s48, s57
    s_cmp_eq_u32 s34, 1
    s_cbranch_scc0 L_175
    s_sub_u32 s48, s57, s47
    s_lshr_b32 s48, s48, 4
    v_add_u32 v45, s48, v15
    v_add_u32 v45, 123904, v45
    ds_write_b128 v45, v[100:103]
    s_mov_b32 s48, 0x40000000
L_175:
    buffer_store_dwordx4 v[100:103], v15, s[24:27], s48 offen offset:3072 sc1
    v_and_b32 v111, s53, v135
    v_mfma_f32_16x16x32_bf16 v[120:123], v[40:43], v[84:87], v[120:123]
    ds_read_b64_tr_b16 v[38:39], v6 offset:10240
    v_lshlrev_b32 v110, 16, v135
    s_waitcnt lgkmcnt(4)
    v_mfma_f32_16x16x32_bf16 v[124:127], v[28:31], v[52:55], v[124:127]
    ds_read_b64_tr_b16 v[40:41], v6 offset:12288
    v_and_b32 v109, s53, v134
    v_lshlrev_b32 v108, 16, v134
    s_waitcnt lgkmcnt(3)
    v_mfma_f32_16x16x32_bf16 v[124:127], v[32:35], v[60:63], v[124:127]
    ds_read_b64_tr_b16 v[42:43], v6 offset:14336
    v_and_b32 v107, s53, v133
    v_mfma_f32_16x16x32_bf16 v[116:119], v[32:35], v[56:59], v[116:119]
    ds_read_b64_tr_b16 v[24:25], v6 offset:16384
    v_lshlrev_b32 v106, 16, v133
    v_and_b32 v105, s53, v132
    v_mfma_f32_16x16x32_bf16 v[116:119], v[28:31], v[48:51], v[116:119]
    ds_read_b64_tr_b16 v[26:27], v6 offset:18432
    v_lshlrev_b32 v104, 16, v132
    s_waitcnt lgkmcnt(4)
    v_mfma_f32_16x16x32_bf16 v[116:119], v[36:39], v[64:67], v[116:119]
    ds_read_b64_tr_b16 v[28:29], v6 offset:20480
    v_and_b32 v103, s53, v131
    s_waitcnt lgkmcnt(3)
    v_mfma_f32_16x16x32_bf16 v[116:119], v[40:43], v[72:75], v[116:119]
    ds_read_b64_tr_b16 v[30:31], v6 offset:22528
    v_lshlrev_b32 v102, 16, v131
    v_and_b32 v101, s53, v130
    v_mfma_f32_16x16x32_bf16 v[124:127], v[40:43], v[76:79], v[124:127]
    v_add_u32 v5, 98304, v14
    v_xor_b32 v5, 64, v5
    v_xor_b32 v6, 32, v5
    ds_read_b64_tr_b16 v[32:33], v5 offset:0
    v_lshlrev_b32 v100, 16, v130
    v_mfma_f32_16x16x32_bf16 v[124:127], v[36:39], v[68:71], v[124:127]
    ds_read_b64_tr_b16 v[34:35], v5 offset:2048
    v_and_b32 v99, s53, v129
    v_lshlrev_b32 v98, 16, v129
    s_waitcnt lgkmcnt(4)
    v_mfma_f32_16x16x32_bf16 v[124:127], v[24:27], v[84:87], v[124:127]
    ds_read_b64_tr_b16 v[36:37], v5 offset:4096
    v_and_b32 v97, s53, v128
    s_waitcnt lgkmcnt(3)
    v_mfma_f32_16x16x32_bf16 v[124:127], v[28:31], v[92:95], v[124:127]
    ds_read_b64_tr_b16 v[38:39], v5 offset:6144
    v_lshlrev_b32 v96, 16, v128
    v_mfma_f32_16x16x32_bf16 v[116:119], v[28:31], v[88:91], v[116:119]
    ds_read_b64_tr_b16 v[40:41], v5 offset:8192
    v_mfma_f32_16x16x32_bf16 v[116:119], v[24:27], v[80:83], v[116:119]
    ds_read_b64_tr_b16 v[42:43], v5 offset:10240
    s_waitcnt lgkmcnt(4)
    v_mfma_f32_16x16x32_bf16 v[96:99], v[32:35], v[48:51], v[96:99]
    ds_read_b64_tr_b16 v[24:25], v5 offset:12288
    s_waitcnt lgkmcnt(3)
    v_mfma_f32_16x16x32_bf16 v[96:99], v[36:39], v[56:59], v[96:99]
    ds_read_b64_tr_b16 v[26:27], v5 offset:14336
    s_waitcnt vmcnt(12)
    s_barrier
    ds_read_b128 v[128:131], v44 offset:8192
    ds_read_b128 v[132:135], v44 offset:9216
    v_mfma_f32_16x16x32_bf16 v[104:107], v[36:39], v[60:63], v[104:107]
    ds_read_b64_tr_b16 v[28:29], v5 offset:16384
    v_mfma_f32_16x16x32_bf16 v[104:107], v[32:35], v[52:55], v[104:107]
    ds_read_b64_tr_b16 v[30:31], v5 offset:18432
    v_cvt_pk_bf16_f32 v112, v112, v113
    v_cvt_pk_bf16_f32 v113, v114, v115
    s_waitcnt lgkmcnt(6)
    v_mfma_f32_16x16x32_bf16 v[104:107], v[40:43], v[68:71], v[104:107]
    ds_read_b64_tr_b16 v[32:33], v5 offset:20480
    v_cvt_pk_bf16_f32 v114, v116, v117
    s_waitcnt lgkmcnt(5)
    v_mfma_f32_16x16x32_bf16 v[104:107], v[24:27], v[76:79], v[104:107]
    ds_read_b64_tr_b16 v[34:35], v5 offset:22528
    s_add_u32 s57, s56, 4
    s_sub_u32 s48, s57, 10
    s_cmp_ge_u32 s57, 10
    s_cselect_b32 s57, s48, s57
    s_mul_i32 s57, s57, 16384
    s_add_u32 s57, s57, s47
    v_cvt_pk_bf16_f32 v115, v118, v119
    v_mfma_f32_16x16x32_bf16 v[96:99], v[24:27], v[72:75], v[96:99]
    ds_read_b64_tr_b16 v[36:37], v6 offset:0
    v_cvt_pk_bf16_f32 v116, v120, v121
    v_mfma_f32_16x16x32_bf16 v[96:99], v[40:43], v[64:67], v[96:99]
    ds_read_b64_tr_b16 v[38:39], v6 offset:2048
    v_cvt_pk_bf16_f32 v117, v122, v123
    v_cvt_pk_bf16_f32 v118, v124, v125
    s_waitcnt lgkmcnt(4)
    v_mfma_f32_16x16x32_bf16 v[96:99], v[28:31], v[80:83], v[96:99]
    ds_read_b64_tr_b16 v[40:41], v6 offset:4096
    v_cvt_pk_bf16_f32 v119, v126, v127
    s_waitcnt lgkmcnt(3)
    v_mfma_f32_16x16x32_bf16 v[96:99], v[32:35], v[88:91], v[96:99]
    ds_read_b64_tr_b16 v[42:43], v6 offset:6144
    s_mov_b32 s48, s57
    s_cmp_eq_u32 s34, 0
    s_cbranch_scc0 L_177
    s_sub_u32 s48, s57, s47
    s_lshr_b32 s48, s48, 4
    v_add_u32 v45, s48, v15
    v_add_u32 v45, 123904, v45
    ds_write_b128 v45, v[112:115]
    s_mov_b32 s48, 0x40000000
L_177:
    buffer_store_dwordx4 v[112:115], v15, s[24:27], s48 offen offset:2048 sc1
    v_mfma_f32_16x16x32_bf16 v[104:107], v[32:35], v[92:95], v[104:107]
    ds_read_b64_tr_b16 v[24:25], v6 offset:8192
    s_mov_b32 s48, s57
    s_cmp_eq_u32 s34, 1
    s_cbranch_scc0 L_179
    s_sub_u32 s48, s57, s47
    s_lshr_b32 s48, s48, 4
    v_add_u32 v45, s48, v15
    v_add_u32 v45, 123904, v45
    ds_write_b128 v45, v[116:119]
    s_mov_b32 s48, 0x40000000
L_179:
    buffer_store_dwordx4 v[116:119], v15, s[24:27], s48 offen offset:3072 sc1
    v_and_b32 v127, s53, v135
    v_mfma_f32_16x16x32_bf16 v[104:107], v[28:31], v[84:87], v[104:107]
    ds_read_b64_tr_b16 v[26:27], v6 offset:10240
    v_lshlrev_b32 v126, 16, v135
    s_waitcnt lgkmcnt(4)
    v_mfma_f32_16x16x32_bf16 v[108:111], v[36:39], v[52:55], v[108:111]
    ds_read_b64_tr_b16 v[28:29], v6 offset:12288
    v_and_b32 v125, s53, v134
    v_lshlrev_b32 v124, 16, v134
    s_waitcnt lgkmcnt(3)
    v_mfma_f32_16x16x32_bf16 v[108:111], v[40:43], v[60:63], v[108:111]
    ds_read_b64_tr_b16 v[30:31], v6 offset:14336
    v_and_b32 v123, s53, v133
    v_mfma_f32_16x16x32_bf16 v[100:103], v[40:43], v[56:59], v[100:103]
    ds_read_b64_tr_b16 v[32:33], v6 offset:16384
    v_lshlrev_b32 v122, 16, v133
    v_and_b32 v121, s53, v132
    v_mfma_f32_16x16x32_bf16 v[100:103], v[36:39], v[48:51], v[100:103]
    ds_read_b64_tr_b16 v[34:35], v6 offset:18432
    v_lshlrev_b32 v120, 16, v132
    s_waitcnt lgkmcnt(4)
    v_mfma_f32_16x16x32_bf16 v[100:103], v[24:27], v[64:67], v[100:103]
    ds_read_b64_tr_b16 v[36:37], v6 offset:20480
    v_and_b32 v119, s53, v131
    s_waitcnt lgkmcnt(3)
    v_mfma_f32_16x16x32_bf16 v[100:103], v[28:31], v[72:75], v[100:103]
    ds_read_b64_tr_b16 v[38:39], v6 offset:22528
    v_lshlrev_b32 v118, 16, v131
    v_and_b32 v117, s53, v130
    v_mfma_f32_16x16x32_bf16 v[108:111], v[28:31], v[76:79], v[108:111]
    v_add_u32 v5, 0, v14
    v_xor_b32 v5, 64, v5
    v_xor_b32 v6, 32, v5
    ds_read_b64_tr_b16 v[40:41], v5 offset:0
    v_lshlrev_b32 v116, 16, v130
    v_mfma_f32_16x16x32_bf16 v[108:111], v[24:27], v[68:71], v[108:111]
    ds_read_b64_tr_b16 v[42:43], v5 offset:2048
    v_and_b32 v115, s53, v129
    v_lshlrev_b32 v114, 16, v129
    s_waitcnt lgkmcnt(4)
    v_mfma_f32_16x16x32_bf16 v[108:111], v[32:35], v[84:87], v[108:111]
    ds_read_b64_tr_b16 v[24:25], v5 offset:4096
    v_and_b32 v113, s53, v128
    s_waitcnt lgkmcnt(3)
    v_mfma_f32_16x16x32_bf16 v[108:111], v[36:39], v[92:95], v[108:111]
    ds_read_b64_tr_b16 v[26:27], v5 offset:6144
    v_lshlrev_b32 v112, 16, v128
    v_mfma_f32_16x16x32_bf16 v[100:103], v[36:39], v[88:91], v[100:103]
    ds_read_b64_tr_b16 v[28:29], v5 offset:8192
    v_mfma_f32_16x16x32_bf16 v[100:103], v[32:35], v[80:83], v[100:103]
    ds_read_b64_tr_b16 v[30:31], v5 offset:10240
    s_waitcnt lgkmcnt(4)
    v_mfma_f32_16x16x32_bf16 v[112:115], v[40:43], v[48:51], v[112:115]
    ds_read_b64_tr_b16 v[32:33], v5 offset:12288
    s_waitcnt lgkmcnt(3)
    v_mfma_f32_16x16x32_bf16 v[112:115], v[24:27], v[56:59], v[112:115]
    ds_read_b64_tr_b16 v[34:35], v5 offset:14336
    s_waitcnt vmcnt(9)
    s_barrier
    ds_read_b128 v[128:131], v44 offset:0
    ds_read_b128 v[132:135], v44 offset:1024
    v_mfma_f32_16x16x32_bf16 v[120:123], v[24:27], v[60:63], v[120:123]
    ds_read_b64_tr_b16 v[36:37], v5 offset:16384
    v_mfma_f32_16x16x32_bf16 v[120:123], v[40:43], v[52:55], v[120:123]
    ds_read_b64_tr_b16 v[38:39], v5 offset:18432
    v_cvt_pk_bf16_f32 v96, v96, v97
    v_cvt_pk_bf16_f32 v97, v98, v99
    s_waitcnt lgkmcnt(6)
    v_mfma_f32_16x16x32_bf16 v[120:123], v[28:31], v[68:71], v[120:123]
    ds_read_b64_tr_b16 v[40:41], v5 offset:20480
    v_cvt_pk_bf16_f32 v98, v100, v101
    s_waitcnt lgkmcnt(5)
    v_mfma_f32_16x16x32_bf16 v[120:123], v[32:35], v[76:79], v[120:123]
    ds_read_b64_tr_b16 v[42:43], v5 offset:22528
    s_add_u32 s57, s56, 5
    s_sub_u32 s48, s57, 10
    s_cmp_ge_u32 s57, 10
    s_cselect_b32 s57, s48, s57
    s_mul_i32 s57, s57, 16384
    s_add_u32 s57, s57, s47
    v_cvt_pk_bf16_f32 v99, v102, v103
    v_mfma_f32_16x16x32_bf16 v[112:115], v[32:35], v[72:75], v[112:115]
    ds_read_b64_tr_b16 v[24:25], v6 offset:0
    v_cvt_pk_bf16_f32 v100, v104, v105
    v_mfma_f32_16x16x32_bf16 v[112:115], v[28:31], v[64:67], v[112:115]
    ds_read_b64_tr_b16 v[26:27], v6 offset:2048
    v_cvt_pk_bf16_f32 v101, v106, v107
    v_cvt_pk_bf16_f32 v102, v108, v109
    s_waitcnt lgkmcnt(4)
    v_mfma_f32_16x16x32_bf16 v[112:115], v[36:39], v[80:83], v[112:115]
    ds_read_b64_tr_b16 v[28:29], v6 offset:4096
    v_cvt_pk_bf16_f32 v103, v110, v111
    s_waitcnt lgkmcnt(3)
    v_mfma_f32_16x16x32_bf16 v[112:115], v[40:43], v[88:91], v[112:115]
    ds_read_b64_tr_b16 v[30:31], v6 offset:6144
    s_mov_b32 s48, s57
    s_cmp_eq_u32 s34, 0
    s_cbranch_scc0 L_181
    s_sub_u32 s48, s57, s47
    s_lshr_b32 s48, s48, 4
    v_add_u32 v45, s48, v15
    v_add_u32 v45, 123904, v45
    ds_write_b128 v45, v[96:99]
    s_mov_b32 s48, 0x40000000
L_181:
    buffer_store_dwordx4 v[96:99], v15, s[24:27], s48 offen offset:2048 sc1
    v_mfma_f32_16x16x32_bf16 v[120:123], v[40:43], v[92:95], v[120:123]
    ds_read_b64_tr_b16 v[32:33], v6 offset:8192
    s_mov_b32 s48, s57
    s_cmp_eq_u32 s34, 1
    s_cbranch_scc0 L_183
    s_sub_u32 s48, s57, s47
    s_lshr_b32 s48, s48, 4
    v_add_u32 v45, s48, v15
    v_add_u32 v45, 123904, v45
    ds_write_b128 v45, v[100:103]
    s_mov_b32 s48, 0x40000000
L_183:
    buffer_store_dwordx4 v[100:103], v15, s[24:27], s48 offen offset:3072 sc1
    v_and_b32 v111, s53, v135
    v_mfma_f32_16x16x32_bf16 v[120:123], v[36:39], v[84:87], v[120:123]
    ds_read_b64_tr_b16 v[34:35], v6 offset:10240
    v_lshlrev_b32 v110, 16, v135
    s_waitcnt lgkmcnt(4)
    v_mfma_f32_16x16x32_bf16 v[124:127], v[24:27], v[52:55], v[124:127]
    ds_read_b64_tr_b16 v[36:37], v6 offset:12288
    v_and_b32 v109, s53, v134
    v_lshlrev_b32 v108, 16, v134
    s_waitcnt lgkmcnt(3)
    v_mfma_f32_16x16x32_bf16 v[124:127], v[28:31], v[60:63], v[124:127]
    ds_read_b64_tr_b16 v[38:39], v6 offset:14336
    v_and_b32 v107, s53, v133
    v_mfma_f32_16x16x32_bf16 v[116:119], v[28:31], v[56:59], v[116:119]
    ds_read_b64_tr_b16 v[40:41], v6 offset:16384
    v_lshlrev_b32 v106, 16, v133
    v_and_b32 v105, s53, v132
    v_mfma_f32_16x16x32_bf16 v[116:119], v[24:27], v[48:51], v[116:119]
    ds_read_b64_tr_b16 v[42:43], v6 offset:18432
    v_lshlrev_b32 v104, 16, v132
    s_waitcnt lgkmcnt(4)
    v_mfma_f32_16x16x32_bf16 v[116:119], v[32:35], v[64:67], v[116:119]
    ds_read_b64_tr_b16 v[24:25], v6 offset:20480
    v_and_b32 v103, s53, v131
    s_waitcnt lgkmcnt(3)
    v_mfma_f32_16x16x32_bf16 v[116:119], v[36:39], v[72:75], v[116:119]
    ds_read_b64_tr_b16 v[26:27], v6 offset:22528
    v_lshlrev_b32 v102, 16, v131
    v_and_b32 v101, s53, v130
    v_mfma_f32_16x16x32_bf16 v[124:127], v[36:39], v[76:79], v[124:127]
    v_add_u32 v5, 24576, v14
    v_xor_b32 v5, 64, v5
    v_xor_b32 v6, 32, v5
    ds_read_b64_tr_b16 v[28:29], v5 offset:0
    v_lshlrev_b32 v100, 16, v130
    v_mfma_f32_16x16x32_bf16 v[124:127], v[32:35], v[68:71], v[124:127]
    ds_read_b64_tr_b16 v[30:31], v5 offset:2048
    v_and_b32 v99, s53, v129
    v_lshlrev_b32 v98, 16, v129
    s_waitcnt lgkmcnt(4)
    v_mfma_f32_16x16x32_bf16 v[124:127], v[40:43], v[84:87], v[124:127]
    ds_read_b64_tr_b16 v[32:33], v5 offset:4096
    v_and_b32 v97, s53, v128
    s_waitcnt lgkmcnt(3)
    v_mfma_f32_16x16x32_bf16 v[124:127], v[24:27], v[92:95], v[124:127]
    ds_read_b64_tr_b16 v[34:35], v5 offset:6144
    v_lshlrev_b32 v96, 16, v128
    v_mfma_f32_16x16x32_bf16 v[116:119], v[24:27], v[88:91], v[116:119]
    ds_read_b64_tr_b16 v[36:37], v5 offset:8192
    v_mfma_f32_16x16x32_bf16 v[116:119], v[40:43], v[80:83], v[116:119]
    ds_read_b64_tr_b16 v[38:39], v5 offset:10240
    s_waitcnt lgkmcnt(4)
    v_mfma_f32_16x16x32_bf16 v[96:99], v[28:31], v[48:51], v[96:99]
    ds_read_b64_tr_b16 v[40:41], v5 offset:12288
    s_waitcnt lgkmcnt(3)
    v_mfma_f32_16x16x32_bf16 v[96:99], v[32:35], v[56:59], v[96:99]
    ds_read_b64_tr_b16 v[42:43], v5 offset:14336
    s_waitcnt vmcnt(6)
    s_barrier
    ds_read_b128 v[128:131], v44 offset:8192
    ds_read_b128 v[132:135], v44 offset:9216
    v_mfma_f32_16x16x32_bf16 v[104:107], v[32:35], v[60:63], v[104:107]
    ds_read_b64_tr_b16 v[24:25], v5 offset:16384
    v_mfma_f32_16x16x32_bf16 v[104:107], v[28:31], v[52:55], v[104:107]
    ds_read_b64_tr_b16 v[26:27], v5 offset:18432
    v_cvt_pk_bf16_f32 v112, v112, v113
    v_cvt_pk_bf16_f32 v113, v114, v115
    s_waitcnt lgkmcnt(6)
    v_mfma_f32_16x16x32_bf16 v[104:107], v[36:39], v[68:71], v[104:107]
    ds_read_b64_tr_b16 v[28:29], v5 offset:20480
    v_cvt_pk_bf16_f32 v114, v116, v117
    s_waitcnt lgkmcnt(5)
    v_mfma_f32_16x16x32_bf16 v[104:107], v[40:43], v[76:79], v[104:107]
    ds_read_b64_tr_b16 v[30:31], v5 offset:22528
    s_add_u32 s57, s56, 6
    s_sub_u32 s48, s57, 10
    s_cmp_ge_u32 s57, 10
    s_cselect_b32 s57, s48, s57
    s_mul_i32 s57, s57, 16384
    s_add_u32 s57, s57, s47
    v_cvt_pk_bf16_f32 v115, v118, v119
    v_mfma_f32_16x16x32_bf16 v[96:99], v[40:43], v[72:75], v[96:99]
    ds_read_b64_tr_b16 v[32:33], v6 offset:0
    v_cvt_pk_bf16_f32 v116, v120, v121
    v_mfma_f32_16x16x32_bf16 v[96:99], v[36:39], v[64:67], v[96:99]
    ds_read_b64_tr_b16 v[34:35], v6 offset:2048
    v_cvt_pk_bf16_f32 v117, v122, v123
    v_cvt_pk_bf16_f32 v118, v124, v125
    s_waitcnt lgkmcnt(4)
    v_mfma_f32_16x16x32_bf16 v[96:99], v[24:27], v[80:83], v[96:99]
    ds_read_b64_tr_b16 v[36:37], v6 offset:4096
    v_cvt_pk_bf16_f32 v119, v126, v127
    s_waitcnt lgkmcnt(3)
    v_mfma_f32_16x16x32_bf16 v[96:99], v[28:31], v[88:91], v[96:99]
    ds_read_b64_tr_b16 v[38:39], v6 offset:6144
    s_mov_b32 s48, s57
    s_cmp_eq_u32 s34, 0
    s_cbranch_scc0 L_185
    s_sub_u32 s48, s57, s47
    s_lshr_b32 s48, s48, 4
    v_add_u32 v45, s48, v15
    v_add_u32 v45, 123904, v45
    ds_write_b128 v45, v[112:115]
    s_mov_b32 s48, 0x40000000
L_185:
    buffer_store_dwordx4 v[112:115], v15, s[24:27], s48 offen offset:2048 sc1
    v_mfma_f32_16x16x32_bf16 v[104:107], v[28:31], v[92:95], v[104:107]
    ds_read_b64_tr_b16 v[40:41], v6 offset:8192
    s_mov_b32 s48, s57
    s_cmp_eq_u32 s34, 1
    s_cbranch_scc0 L_187
    s_sub_u32 s48, s57, s47
    s_lshr_b32 s48, s48, 4
    v_add_u32 v45, s48, v15
    v_add_u32 v45, 123904, v45
    ds_write_b128 v45, v[116:119]
    s_mov_b32 s48, 0x40000000
L_187:
    buffer_store_dwordx4 v[116:119], v15, s[24:27], s48 offen offset:3072 sc1
    v_and_b32 v127, s53, v135
    v_mfma_f32_16x16x32_bf16 v[104:107], v[24:27], v[84:87], v[104:107]
    ds_read_b64_tr_b16 v[42:43], v6 offset:10240
    v_lshlrev_b32 v126, 16, v135
    s_waitcnt lgkmcnt(4)
    v_mfma_f32_16x16x32_bf16 v[108:111], v[32:35], v[52:55], v[108:111]
    ds_read_b64_tr_b16 v[24:25], v6 offset:12288
    v_and_b32 v125, s53, v134
    v_lshlrev_b32 v124, 16, v134
    s_waitcnt lgkmcnt(3)
    v_mfma_f32_16x16x32_bf16 v[108:111], v[36:39], v[60:63], v[108:111]
    ds_read_b64_tr_b16 v[26:27], v6 offset:14336
    v_and_b32 v123, s53, v133
    v_mfma_f32_16x16x32_bf16 v[100:103], v[36:39], v[56:59], v[100:103]
    ds_read_b64_tr_b16 v[28:29], v6 offset:16384
    v_lshlrev_b32 v122, 16, v133
    v_and_b32 v121, s53, v132
    v_mfma_f32_16x16x32_bf16 v[100:103], v[32:35], v[48:51], v[100:103]
    ds_read_b64_tr_b16 v[30:31], v6 offset:18432
    v_lshlrev_b32 v120, 16, v132
    s_waitcnt lgkmcnt(4)
    v_mfma_f32_16x16x32_bf16 v[100:103], v[40:43], v[64:67], v[100:103]
    ds_read_b64_tr_b16 v[32:33], v6 offset:20480
    v_and_b32 v119, s53, v131
    s_waitcnt lgkmcnt(3)
    v_mfma_f32_16x16x32_bf16 v[100:103], v[24:27], v[72:75], v[100:103]
    ds_read_b64_tr_b16 v[34:35], v6 offset:22528
    v_lshlrev_b32 v118, 16, v131
    v_and_b32 v117, s53, v130
    v_mfma_f32_16x16x32_bf16 v[108:111], v[24:27], v[76:79], v[108:111]
    v_add_u32 v5, 49152, v14
    v_xor_b32 v5, 64, v5
    v_xor_b32 v6, 32, v5
    ds_read_b64_tr_b16 v[36:37], v5 offset:0
    v_lshlrev_b32 v116, 16, v130
    v_mfma_f32_16x16x32_bf16 v[108:111], v[40:43], v[68:71], v[108:111]
    ds_read_b64_tr_b16 v[38:39], v5 offset:2048
    v_and_b32 v115, s53, v129
    v_lshlrev_b32 v114, 16, v129
    s_waitcnt lgkmcnt(4)
    v_mfma_f32_16x16x32_bf16 v[108:111], v[28:31], v[84:87], v[108:111]
    ds_read_b64_tr_b16 v[40:41], v5 offset:4096
    v_and_b32 v113, s53, v128
    s_waitcnt lgkmcnt(3)
    v_mfma_f32_16x16x32_bf16 v[108:111], v[32:35], v[92:95], v[108:111]
    ds_read_b64_tr_b16 v[42:43], v5 offset:6144
    v_lshlrev_b32 v112, 16, v128
    v_mfma_f32_16x16x32_bf16 v[100:103], v[32:35], v[88:91], v[100:103]
    ds_read_b64_tr_b16 v[24:25], v5 offset:8192
    v_mfma_f32_16x16x32_bf16 v[100:103], v[28:31], v[80:83], v[100:103]
    ds_read_b64_tr_b16 v[26:27], v5 offset:10240
    s_waitcnt lgkmcnt(4)
    v_mfma_f32_16x16x32_bf16 v[112:115], v[36:39], v[48:51], v[112:115]
    ds_read_b64_tr_b16 v[28:29], v5 offset:12288
    s_waitcnt lgkmcnt(3)
    v_mfma_f32_16x16x32_bf16 v[112:115], v[40:43], v[56:59], v[112:115]
    ds_read_b64_tr_b16 v[30:31], v5 offset:14336
    v_mfma_f32_16x16x32_bf16 v[120:123], v[40:43], v[60:63], v[120:123]
    ds_read_b64_tr_b16 v[32:33], v5 offset:16384
    v_mfma_f32_16x16x32_bf16 v[120:123], v[36:39], v[52:55], v[120:123]
    ds_read_b64_tr_b16 v[34:35], v5 offset:18432
    v_cvt_pk_bf16_f32 v96, v96, v97
    s_waitcnt lgkmcnt(4)
    v_mfma_f32_16x16x32_bf16 v[120:123], v[24:27], v[68:71], v[120:123]
    ds_read_b64_tr_b16 v[36:37], v5 offset:20480
    v_cvt_pk_bf16_f32 v97, v98, v99
    s_waitcnt lgkmcnt(3)
    v_mfma_f32_16x16x32_bf16 v[120:123], v[28:31], v[76:79], v[120:123]
    ds_read_b64_tr_b16 v[38:39], v5 offset:22528
    v_mfma_f32_16x16x32_bf16 v[112:115], v[28:31], v[72:75], v[112:115]
    ds_read_b64_tr_b16 v[40:41], v6 offset:0
    v_cvt_pk_bf16_f32 v98, v100, v101
    v_mfma_f32_16x16x32_bf16 v[112:115], v[24:27], v[64:67], v[112:115]
    ds_read_b64_tr_b16 v[42:43], v6 offset:2048
    s_waitcnt lgkmcnt(4)
    v_mfma_f32_16x16x32_bf16 v[112:115], v[32:35], v[80:83], v[112:115]
    ds_read_b64_tr_b16 v[24:25], v6 offset:4096
    s_add_u32 s57, s56, 7
    s_sub_u32 s48, s57, 10
    s_cmp_ge_u32 s57, 10
    s_cselect_b32 s57, s48, s57
    s_mul_i32 s57, s57, 16384
    s_add_u32 s57, s57, s47
    s_waitcnt lgkmcnt(3)
    v_mfma_f32_16x16x32_bf16 v[112:115], v[36:39], v[88:91], v[112:115]
    ds_read_b64_tr_b16 v[26:27], v6 offset:6144
    v_cvt_pk_bf16_f32 v99, v102, v103
    v_mfma_f32_16x16x32_bf16 v[120:123], v[36:39], v[92:95], v[120:123]
    ds_read_b64_tr_b16 v[28:29], v6 offset:8192
    v_mfma_f32_16x16x32_bf16 v[120:123], v[32:35], v[84:87], v[120:123]
    ds_read_b64_tr_b16 v[30:31], v6 offset:10240
    v_cvt_pk_bf16_f32 v100, v104, v105
    s_waitcnt lgkmcnt(4)
    v_mfma_f32_16x16x32_bf16 v[124:127], v[40:43], v[52:55], v[124:127]
    ds_read_b64_tr_b16 v[32:33], v6 offset:12288
    s_waitcnt lgkmcnt(3)
    v_mfma_f32_16x16x32_bf16 v[124:127], v[24:27], v[60:63], v[124:127]
    ds_read_b64_tr_b16 v[34:35], v6 offset:14336
    v_cvt_pk_bf16_f32 v101, v106, v107
    v_mfma_f32_16x16x32_bf16 v[116:119], v[24:27], v[56:59], v[116:119]
    ds_read_b64_tr_b16 v[36:37], v6 offset:16384
    v_mfma_f32_16x16x32_bf16 v[116:119], v[40:43], v[48:51], v[116:119]
    ds_read_b64_tr_b16 v[38:39], v6 offset:18432
    v_cvt_pk_bf16_f32 v102, v108, v109
    s_waitcnt lgkmcnt(4)
    v_mfma_f32_16x16x32_bf16 v[116:119], v[28:31], v[64:67], v[116:119]
    ds_read_b64_tr_b16 v[40:41], v6 offset:20480
    v_cvt_pk_bf16_f32 v103, v110, v111
    s_waitcnt lgkmcnt(3)
    v_mfma_f32_16x16x32_bf16 v[116:119], v[32:35], v[72:75], v[116:119]
    ds_read_b64_tr_b16 v[42:43], v6 offset:22528
    v_mfma_f32_16x16x32_bf16 v[124:127], v[32:35], v[76:79], v[124:127]
    s_mov_b32 s48, s57
    s_cmp_eq_u32 s34, 0
    s_cbranch_scc0 L_189
    s_sub_u32 s48, s57, s47
    s_lshr_b32 s48, s48, 4
    v_add_u32 v45, s48, v15
    v_add_u32 v45, 123904, v45
    ds_write_b128 v45, v[96:99]
    s_mov_b32 s48, 0x40000000
L_189:
    buffer_store_dwordx4 v[96:99], v15, s[24:27], s48 offen offset:2048 sc1
    v_mfma_f32_16x16x32_bf16 v[124:127], v[28:31], v[68:71], v[124:127]
    s_waitcnt lgkmcnt(2)
    v_mfma_f32_16x16x32_bf16 v[124:127], v[36:39], v[84:87], v[124:127]
    s_mov_b32 s48, s57
    s_cmp_eq_u32 s34, 1
    s_cbranch_scc0 L_191
    s_sub_u32 s48, s57, s47
    s_lshr_b32 s48, s48, 4
    v_add_u32 v45, s48, v15
    v_add_u32 v45, 123904, v45
    ds_write_b128 v45, v[100:103]
    s_mov_b32 s48, 0x40000000
L_191:
    buffer_store_dwordx4 v[100:103], v15, s[24:27], s48 offen offset:3072 sc1
    s_waitcnt lgkmcnt(0)
    v_mfma_f32_16x16x32_bf16 v[124:127], v[40:43], v[92:95], v[124:127]
    v_mfma_f32_16x16x32_bf16 v[116:119], v[40:43], v[88:91], v[116:119]
    v_mfma_f32_16x16x32_bf16 v[116:119], v[36:39], v[80:83], v[116:119]
    v_cvt_pk_bf16_f32 v112, v112, v113
    v_cvt_pk_bf16_f32 v113, v114, v115
    s_nop 5
    v_cvt_pk_bf16_f32 v114, v116, v117
    s_add_u32 s57, s56, 8
    s_sub_u32 s48, s57, 10
    s_cmp_ge_u32 s57, 10
    s_cselect_b32 s57, s48, s57
    s_mul_i32 s57, s57, 16384
    s_add_u32 s57, s57, s47
    v_cvt_pk_bf16_f32 v115, v118, v119
    v_cvt_pk_bf16_f32 v116, v120, v121
    v_cvt_pk_bf16_f32 v117, v122, v123
    v_cvt_pk_bf16_f32 v118, v124, v125
    v_cvt_pk_bf16_f32 v119, v126, v127
    s_mov_b32 s48, s57
    s_cmp_eq_u32 s34, 0
    s_cbranch_scc0 L_193
    s_sub_u32 s48, s57, s47
    s_lshr_b32 s48, s48, 4
    v_add_u32 v45, s48, v15
    v_add_u32 v45, 123904, v45
    ds_write_b128 v45, v[112:115]
    s_mov_b32 s48, 0x40000000
L_193:
    buffer_store_dwordx4 v[112:115], v15, s[24:27], s48 offen offset:2048 sc1
    s_mov_b32 s48, s57
    s_cmp_eq_u32 s34, 1
    s_cbranch_scc0 L_195
    s_sub_u32 s48, s57, s47
    s_lshr_b32 s48, s48, 4
    v_add_u32 v45, s48, v15
    v_add_u32 v45, 123904, v45
    ds_write_b128 v45, v[116:119]
    s_mov_b32 s48, 0x40000000
L_195:
    buffer_store_dwordx4 v[116:119], v15, s[24:27], s48 offen offset:3072 sc1
L_RED:
    v_mov_b32 v9, 122880
    ds_read_b32 v14, v9
    s_load_dwordx2 s[38:39], s[0:1], 40
    s_lshr_b32 s54, s55, 4
    s_and_b32 s36, s55, 15
    s_sub_u32 s48, s40, 1
    s_cmp_lt_u32 s40, 3
    s_cselect_b32 s35, s40, s48
    s_mul_i32 s28, s54, 2621440
    s_lshl_b32 s48, s36, 10
    s_add_u32 s28, s28, s48
    s_lshl_b32 s48, s35, 14
    s_add_u32 s28, s28, s48
    s_waitcnt lgkmcnt(0)
    v_readfirstlane_b32 s31, v14
    s_cmp_eq_u32 s40, 3
    s_cbranch_scc1 L_PUB
    s_cmp_lt_u32 s35, 3
    s_cbranch_scc1 L_RED2
    s_lshl_b32 s30, s54, 3
    s_lshr_b32 s48, s36, 2
    s_lshl_b32 s48, s48, 1
    s_add_u32 s30, s30, s48
    s_and_b32 s48, s36, 1
    s_add_u32 s30, s30, s48
    s_mul_i32 s30, s30, 20480
    s_and_b32 s48, s36, 2
    s_lshl_b32 s48, s48, 5
    s_add_u32 s30, s30, s48
    s_lshl_b32 s48, s35, 7
    s_add_u32 s30, s30, s48
    v_and_b32 v5, 15, v0
    v_mul_u32_u24 v5, 1280, v5
    v_lshrrev_b32 v6, 4, v0
    v_lshl_add_u32 v5, v6, 4, v5
    s_mov_b32 s4, s38
    s_and_b32 s5, s39, 0xffff
    s_mov_b32 s6, 2621440
    s_mov_b32 s7, 0x20000
    v_mov_b64 v[24:25], 0
    v_mov_b64 v[26:27], 0
    v_mov_b64 v[28:29], 0
    v_mov_b64 v[30:31], 0
    v_mov_b64 v[32:33], 0
    v_mov_b64 v[34:35], 0
    v_mov_b64 v[36:37], 0
    v_mov_b64 v[38:39], 0
    v_bfe_u32 v40, v0, 2, 2
    v_lshlrev_b32 v40, 3, v40
    v_and_b32 v41, 3, v0
    v_add_u32 v40, v40, v41
    v_lshrrev_b32 v41, 4, v0
    v_lshlrev_b32 v41, 2, v41
    v_sub_u32 v40, v40, v41
    v_mov_b32 v42, 0x3f80
    v_mov_b32 v43, 0x3f800000
    v_cmp_eq_i32 vcc, 0, v40
    s_nop 1
    v_cndmask_b32 v16, 0, v42, vcc
    v_cmp_eq_i32 vcc, 1, v40
    s_nop 1
    v_cndmask_b32 v16, v16, v43, vcc
    v_cmp_eq_i32 vcc, 2, v40
    s_nop 1
    v_cndmask_b32 v17, 0, v42, vcc
    v_cmp_eq_i32 vcc, 3, v40
    s_nop 1
    v_cndmask_b32 v17, v17, v43, vcc
    v_cmp_eq_i32 vcc, 16, v40
    s_nop 1
    v_cndmask_b32 v18, 0, v42, vcc
    v_cmp_eq_i32 vcc, 17, v40
    s_nop 1
    v_cndmask_b32 v18, v18, v43, vcc
    v_cmp_eq_i32 vcc, 18, v40
    s_nop 1
    v_cndmask_b32 v19, 0, v42, vcc
    v_cmp_eq_i32 vcc, 19, v40
    s_nop 1
    v_cndmask_b32 v19, v19, v43, vcc
    v_cmp_eq_i32 vcc, -4, v40
    s_nop 1
    v_cndmask_b32 v20, 0, v42, vcc
    v_cmp_eq_i32 vcc, -3, v40
    s_nop 1
    v_cndmask_b32 v20, v20, v43, vcc
    v_cmp_eq_i32 vcc, -2, v40
    s_nop 1
    v_cndmask_b32 v21, 0, v42, vcc
    v_cmp_eq_i32 vcc, -1, v40
    s_nop 1
    v_cndmask_b32 v21, v21, v43, vcc
    v_cmp_eq_i32 vcc, 12, v40
    s_nop 1
    v_cndmask_b32 v22, 0, v42, vcc
    v_cmp_eq_i32 vcc, 13, v40
    s_nop 1
    v_cndmask_b32 v22, v22, v43, vcc
    v_cmp_eq_i32 vcc, 14, v40
    s_nop 1
    v_cndmask_b32 v23, 0, v42, vcc
    v_cmp_eq_i32 vcc, 15, v40
    s_nop 1
    v_cndmask_b32 v23, v23, v43, vcc
    s_mov_b32 s31, 0
    s_bitset1_b32 s31, s36
    s_lshl_b32 s48, s35, 10
    s_add_u32 s48, s48, 123904
    v_add_u32 v44, s48, v15
    s_waitcnt vmcnt(0)
    s_barrier
    ds_read_b128 v[112:115], v44 offset:0
    s_waitcnt lgkmcnt(0)
    v_mfma_f32_16x16x32_bf16 v[24:27], v[16:19], v[112:115], v[24:27]
    v_mfma_f32_16x16x32_bf16 v[28:31], v[20:23], v[112:115], v[28:31]
    s_mov_b32 s34, s31
L_RLA:
    ds_read_b32 v14, v9
    s_waitcnt lgkmcnt(0)
    v_readfirstlane_b32 s37, v14
    s_nop 0
    s_andn2_b32 s32, s37, s31
    s_cbranch_scc0 L_RADDA
    s_or_b32 s31, s31, s37
    s_bitcmp1_b32 s32, 0
    s_cbranch_scc0 L_197
    s_add_u32 s48, s28, 0
    buffer_load_dwordx4 v[48:51], v15, s[24:27], s48 offen sc1
L_197:
    s_bitcmp1_b32 s32, 1
    s_cbranch_scc0 L_198
    s_add_u32 s48, s28, 163840
    buffer_load_dwordx4 v[52:55], v15, s[24:27], s48 offen sc1
L_198:
    s_bitcmp1_b32 s32, 2
    s_cbranch_scc0 L_199
    s_add_u32 s48, s28, 327680
    buffer_load_dwordx4 v[56:59], v15, s[24:27], s48 offen sc1
L_199:
    s_bitcmp1_b32 s32, 3
    s_cbranch_scc0 L_200
    s_add_u32 s48, s28, 491520
    buffer_load_dwordx4 v[60:63], v15, s[24:27], s48 offen sc1
L_200:
    s_bitcmp1_b32 s32, 4
    s_cbranch_scc0 L_201
    s_add_u32 s48, s28, 655360
    buffer_load_dwordx4 v[64:67], v15, s[24:27], s48 offen sc1
L_201:
    s_bitcmp1_b32 s32, 5
    s_cbranch_scc0 L_202
    s_add_u32 s48, s28, 819200
    buffer_load_dwordx4 v[68:71], v15, s[24:27], s48 offen sc1
L_202:
    s_bitcmp1_b32 s32, 6
    s_cbranch_scc0 L_203
    s_add_u32 s48, s28, 983040
    buffer_load_dwordx4 v[72:75], v15, s[24:27], s48 offen sc1
L_203:
    s_bitcmp1_b32 s32, 7
    s_cbranch_scc0 L_204
    s_add_u32 s48, s28, 1146880
    buffer_load_dwordx4 v[76:79], v15, s[24:27], s48 offen sc1
L_204:
    s_bitcmp1_b32 s32, 8
    s_cbranch_scc0 L_205
    s_add_u32 s48, s28, 1310720
    buffer_load_dwordx4 v[80:83], v15, s[24:27], s48 offen sc1
L_205:
    s_bitcmp1_b32 s32, 9
    s_cbranch_scc0 L_206
    s_add_u32 s48, s28, 1474560
    buffer_load_dwordx4 v[84:87], v15, s[24:27], s48 offen sc1
L_206:
    s_bitcmp1_b32 s32, 10
    s_cbranch_scc0 L_207
    s_add_u32 s48, s28, 1638400
    buffer_load_dwordx4 v[88:91], v15, s[24:27], s48 offen sc1
L_207:
    s_bitcmp1_b32 s32, 11
    s_cbranch_scc0 L_208
    s_add_u32 s48, s28, 1802240
    buffer_load_dwordx4 v[92:95], v15, s[24:27], s48 offen sc1
L_208:
    s_bitcmp1_b32 s32, 12
    s_cbranch_scc0 L_209
    s_add_u32 s48, s28, 1966080
    buffer_load_dwordx4 v[96:99], v15, s[24:27], s48 offen sc1
L_209:
    s_bitcmp1_b32 s32, 13
    s_cbranch_scc0 L_210
    s_add_u32 s48, s28, 2129920
    buffer_load_dwordx4 v[100:103], v15, s[24:27], s48 offen sc1
L_210:
    s_bitcmp1_b32 s32, 14
    s_cbranch_scc0 L_211
    s_add_u32 s48, s28, 2293760
    buffer_load_dwordx4 v[104:107], v15, s[24:27], s48 offen sc1
L_211:
    s_bitcmp1_b32 s32, 15
    s_cbranch_scc0 L_212
    s_add_u32 s48, s28, 2457600
    buffer_load_dwordx4 v[108:111], v15, s[24:27], s48 offen sc1
L_212:
    s_or_b32 s34, s34, s32
    s_mov_b32 s32, 0
    s_cmp_eq_u32 s31, 0xffff
    s_cbranch_scc0 L_RLA
L_RADDA:
    s_cmp_eq_u32 s31, 0xffff
    s_cbranch_scc0 L_RSLPA
    s_cmp_eq_u32 s34, 0
    s_cbranch_scc1 L_RADDEDA
    s_waitcnt vmcnt(0)
    s_cmp_eq_u32 s36, 0
    s_cbranch_scc1 L_213
    v_mfma_f32_16x16x32_bf16 v[24:27], v[16:19], v[48:51], v[24:27]
    v_mfma_f32_16x16x32_bf16 v[28:31], v[20:23], v[48:51], v[28:31]
L_213:
    s_cmp_eq_u32 s36, 1
    s_cbranch_scc1 L_214
    v_mfma_f32_16x16x32_bf16 v[24:27], v[16:19], v[52:55], v[24:27]
    v_mfma_f32_16x16x32_bf16 v[28:31], v[20:23], v[52:55], v[28:31]
L_214:
    s_cmp_eq_u32 s36, 2
    s_cbranch_scc1 L_215
    v_mfma_f32_16x16x32_bf16 v[24:27], v[16:19], v[56:59], v[24:27]
    v_mfma_f32_16x16x32_bf16 v[28:31], v[20:23], v[56:59], v[28:31]
L_215:
    s_cmp_eq_u32 s36, 3
    s_cbranch_scc1 L_216
    v_mfma_f32_16x16x32_bf16 v[24:27], v[16:19], v[60:63], v[24:27]
    v_mfma_f32_16x16x32_bf16 v[28:31], v[20:23], v[60:63], v[28:31]
L_216:
    s_cmp_eq_u32 s36, 4
    s_cbranch_scc1 L_217
    v_mfma_f32_16x16x32_bf16 v[24:27], v[16:19], v[64:67], v[24:27]
    v_mfma_f32_16x16x32_bf16 v[28:31], v[20:23], v[64:67], v[28:31]
L_217:
    s_cmp_eq_u32 s36, 5
    s_cbranch_scc1 L_218
    v_mfma_f32_16x16x32_bf16 v[24:27], v[16:19], v[68:71], v[24:27]
    v_mfma_f32_16x16x32_bf16 v[28:31], v[20:23], v[68:71], v[28:31]
L_218:
    s_cmp_eq_u32 s36, 6
    s_cbranch_scc1 L_219
    v_mfma_f32_16x16x32_bf16 v[24:27], v[16:19], v[72:75], v[24:27]
    v_mfma_f32_16x16x32_bf16 v[28:31], v[20:23], v[72:75], v[28:31]
L_219:
    s_cmp_eq_u32 s36, 7
    s_cbranch_scc1 L_220
    v_mfma_f32_16x16x32_bf16 v[24:27], v[16:19], v[76:79], v[24:27]
    v_mfma_f32_16x16x32_bf16 v[28:31], v[20:23], v[76:79], v[28:31]
L_220:
    s_cmp_eq_u32 s36, 8
    s_cbranch_scc1 L_221
    v_mfma_f32_16x16x32_bf16 v[24:27], v[16:19], v[80:83], v[24:27]
    v_mfma_f32_16x16x32_bf16 v[28:31], v[20:23], v[80:83], v[28:31]
L_221:
    s_cmp_eq_u32 s36, 9
    s_cbranch_scc1 L_222
    v_mfma_f32_16x16x32_bf16 v[24:27], v[16:19], v[84:87], v[24:27]
    v_mfma_f32_16x16x32_bf16 v[28:31], v[20:23], v[84:87], v[28:31]
L_222:
    s_cmp_eq_u32 s36, 10
    s_cbranch_scc1 L_223
    v_mfma_f32_16x16x32_bf16 v[24:27], v[16:19], v[88:91], v[24:27]
    v_mfma_f32_16x16x32_bf16 v[28:31], v[20:23], v[88:91], v[28:31]
L_223:
    s_cmp_eq_u32 s36, 11
    s_cbranch_scc1 L_224
    v_mfma_f32_16x16x32_bf16 v[24:27], v[16:19], v[92:95], v[24:27]
    v_mfma_f32_16x16x32_bf16 v[28:31], v[20:23], v[92:95], v[28:31]
L_224:
    s_cmp_eq_u32 s36, 12
    s_cbranch_scc1 L_225
    v_mfma_f32_16x16x32_bf16 v[24:27], v[16:19], v[96:99], v[24:27]
    v_mfma_f32_16x16x32_bf16 v[28:31], v[20:23], v[96:99], v[28:31]
L_225:
    s_cmp_eq_u32 s36, 13
    s_cbranch_scc1 L_226
    v_mfma_f32_16x16x32_bf16 v[24:27], v[16:19], v[100:103], v[24:27]
    v_mfma_f32_16x16x32_bf16 v[28:31], v[20:23], v[100:103], v[28:31]
L_226:
    s_cmp_eq_u32 s36, 14
    s_cbranch_scc1 L_227
    v_mfma_f32_16x16x32_bf16 v[24:27], v[16:19], v[104:107], v[24:27]
    v_mfma_f32_16x16x32_bf16 v[28:31], v[20:23], v[104:107], v[28:31]
L_227:
    s_cmp_eq_u32 s36, 15
    s_cbranch_scc1 L_228
    v_mfma_f32_16x16x32_bf16 v[24:27], v[16:19], v[108:111], v[24:27]
    v_mfma_f32_16x16x32_bf16 v[28:31], v[20:23], v[108:111], v[28:31]
L_228:
L_RADDEDA:
    s_mov_b32 s34, s32
    s_cmp_lg_u32 s32, 0
    s_cbranch_scc1 L_RLA
    s_cmp_eq_u32 s31, 0xffff
    s_cbranch_scc1 L_RDONEA
L_RSLPA:
    s_sleep 1
    s_branch L_RLA
L_RDONEA:
    s_nop 1
    v_cvt_pk_bf16_f32 v48, v24, v25
    v_cvt_pk_bf16_f32 v49, v26, v27
    v_cvt_pk_bf16_f32 v50, v28, v29
    v_cvt_pk_bf16_f32 v51, v30, v31
    buffer_store_dwordx4 v[48:51], v5, s[4:7], s30 offen offset:0
    s_branch L_FIN
L_RED2:
    s_lshl_b32 s30, s54, 3
    s_lshr_b32 s48, s36, 2
    s_lshl_b32 s48, s48, 1
    s_add_u32 s30, s30, s48
    s_and_b32 s48, s36, 1
    s_add_u32 s30, s30, s48
    s_mul_i32 s30, s30, 20480
    s_and_b32 s48, s36, 2
    s_lshl_b32 s48, s48, 5
    s_add_u32 s30, s30, s48
    s_lshl_b32 s48, s35, 7
    s_add_u32 s30, s30, s48
    v_and_b32 v5, 15, v0
    v_mul_u32_u24 v5, 1280, v5
    v_lshrrev_b32 v6, 4, v0
    v_lshl_add_u32 v5, v6, 4, v5
    s_mov_b32 s4, s38
    s_and_b32 s5, s39, 0xffff
    s_mov_b32 s6, 2621440
    s_mov_b32 s7, 0x20000
    v_mov_b64 v[24:25], 0
    v_mov_b64 v[26:27], 0
    v_mov_b64 v[28:29], 0
    v_mov_b64 v[30:31], 0
    v_mov_b64 v[32:33], 0
    v_mov_b64 v[34:35], 0
    v_mov_b64 v[36:37], 0
    v_mov_b64 v[38:39], 0
    v_bfe_u32 v40, v0, 2, 2
    v_lshlrev_b32 v40, 3, v40
    v_and_b32 v41, 3, v0
    v_add_u32 v40, v40, v41
    v_lshrrev_b32 v41, 4, v0
    v_lshlrev_b32 v41, 2, v41
    v_sub_u32 v40, v40, v41
    v_mov_b32 v42, 0x3f80
    v_mov_b32 v43, 0x3f800000
    v_cmp_eq_i32 vcc, 0, v40
    s_nop 1
    v_cndmask_b32 v16, 0, v42, vcc
    v_cmp_eq_i32 vcc, 1, v40
    s_nop 1
    v_cndmask_b32 v16, v16, v43, vcc
    v_cmp_eq_i32 vcc, 2, v40
    s_nop 1
    v_cndmask_b32 v17, 0, v42, vcc
    v_cmp_eq_i32 vcc, 3, v40
    s_nop 1
    v_cndmask_b32 v17, v17, v43, vcc
    v_cmp_eq_i32 vcc, 16, v40
    s_nop 1
    v_cndmask_b32 v18, 0, v42, vcc
    v_cmp_eq_i32 vcc, 17, v40
    s_nop 1
    v_cndmask_b32 v18, v18, v43, vcc
    v_cmp_eq_i32 vcc, 18, v40
    s_nop 1
    v_cndmask_b32 v19, 0, v42, vcc
    v_cmp_eq_i32 vcc, 19, v40
    s_nop 1
    v_cndmask_b32 v19, v19, v43, vcc
    v_cmp_eq_i32 vcc, -4, v40
    s_nop 1
    v_cndmask_b32 v20, 0, v42, vcc
    v_cmp_eq_i32 vcc, -3, v40
    s_nop 1
    v_cndmask_b32 v20, v20, v43, vcc
    v_cmp_eq_i32 vcc, -2, v40
    s_nop 1
    v_cndmask_b32 v21, 0, v42, vcc
    v_cmp_eq_i32 vcc, -1, v40
    s_nop 1
    v_cndmask_b32 v21, v21, v43, vcc
    v_cmp_eq_i32 vcc, 12, v40
    s_nop 1
    v_cndmask_b32 v22, 0, v42, vcc
    v_cmp_eq_i32 vcc, 13, v40
    s_nop 1
    v_cndmask_b32 v22, v22, v43, vcc
    v_cmp_eq_i32 vcc, 14, v40
    s_nop 1
    v_cndmask_b32 v23, 0, v42, vcc
    v_cmp_eq_i32 vcc, 15, v40
    s_nop 1
    v_cndmask_b32 v23, v23, v43, vcc
    s_mov_b32 s31, 0
    s_bitset1_b32 s31, s36
    s_lshl_b32 s48, s35, 10
    s_add_u32 s48, s48, 123904
    v_add_u32 v44, s48, v15
    s_waitcnt vmcnt(0)
    s_barrier
    ds_read_b128 v[112:115], v44 offset:0
    ds_read_b128 v[116:119], v44 offset:7168
    s_waitcnt lgkmcnt(1)
    v_mfma_f32_16x16x32_bf16 v[24:27], v[16:19], v[112:115], v[24:27]
    v_mfma_f32_16x16x32_bf16 v[28:31], v[20:23], v[112:115], v[28:31]
    s_waitcnt lgkmcnt(0)
    v_mfma_f32_16x16x32_bf16 v[32:35], v[16:19], v[116:119], v[32:35]
    v_mfma_f32_16x16x32_bf16 v[36:39], v[20:23], v[116:119], v[36:39]
    s_mov_b32 s34, s31
L_RLB:
    ds_read_b32 v14, v9
    s_waitcnt lgkmcnt(0)
    v_readfirstlane_b32 s37, v14
    s_nop 0
    s_andn2_b32 s32, s37, s31
    s_cbranch_scc0 L_RADDB
    s_or_b32 s31, s31, s37
    s_bitcmp1_b32 s32, 0
    s_cbranch_scc0 L_229
    s_add_u32 s48, s28, 0
    buffer_load_dwordx4 v[48:51], v15, s[24:27], s48 offen sc1
    s_add_u32 s48, s48, 114688
    buffer_load_dwordx4 v[192:195], v15, s[24:27], s48 offen sc1
L_229:
    s_bitcmp1_b32 s32, 1
    s_cbranch_scc0 L_230
    s_add_u32 s48, s28, 163840
    buffer_load_dwordx4 v[52:55], v15, s[24:27], s48 offen sc1
    s_add_u32 s48, s48, 114688
    buffer_load_dwordx4 v[196:199], v15, s[24:27], s48 offen sc1
L_230:
    s_bitcmp1_b32 s32, 2
    s_cbranch_scc0 L_231
    s_add_u32 s48, s28, 327680
    buffer_load_dwordx4 v[56:59], v15, s[24:27], s48 offen sc1
    s_add_u32 s48, s48, 114688
    buffer_load_dwordx4 v[200:203], v15, s[24:27], s48 offen sc1
L_231:
    s_bitcmp1_b32 s32, 3
    s_cbranch_scc0 L_232
    s_add_u32 s48, s28, 491520
    buffer_load_dwordx4 v[60:63], v15, s[24:27], s48 offen sc1
    s_add_u32 s48, s48, 114688
    buffer_load_dwordx4 v[204:207], v15, s[24:27], s48 offen sc1
L_232:
    s_bitcmp1_b32 s32, 4
    s_cbranch_scc0 L_233
    s_add_u32 s48, s28, 655360
    buffer_load_dwordx4 v[64:67], v15, s[24:27], s48 offen sc1
    s_add_u32 s48, s48, 114688
    buffer_load_dwordx4 v[208:211], v15, s[24:27], s48 offen sc1
L_233:
    s_bitcmp1_b32 s32, 5
    s_cbranch_scc0 L_234
    s_add_u32 s48, s28, 819200
    buffer_load_dwordx4 v[68:71], v15, s[24:27], s48 offen sc1
    s_add_u32 s48, s48, 114688
    buffer_load_dwordx4 v[212:215], v15, s[24:27], s48 offen sc1
L_234:
    s_bitcmp1_b32 s32, 6
    s_cbranch_scc0 L_235
    s_add_u32 s48, s28, 983040
    buffer_load_dwordx4 v[72:75], v15, s[24:27], s48 offen sc1
    s_add_u32 s48, s48, 114688
    buffer_load_dwordx4 v[216:219], v15, s[24:27], s48 offen sc1
L_235:
    s_bitcmp1_b32 s32, 7
    s_cbranch_scc0 L_236
    s_add_u32 s48, s28, 1146880
    buffer_load_dwordx4 v[76:79], v15, s[24:27], s48 offen sc1
    s_add_u32 s48, s48, 114688
    buffer_load_dwordx4 v[220:223], v15, s[24:27], s48 offen sc1
L_236:
    s_bitcmp1_b32 s32, 8
    s_cbranch_scc0 L_237
    s_add_u32 s48, s28, 1310720
    buffer_load_dwordx4 v[80:83], v15, s[24:27], s48 offen sc1
    s_add_u32 s48, s48, 114688
    buffer_load_dwordx4 v[224:227], v15, s[24:27], s48 offen sc1
L_237:
    s_bitcmp1_b32 s32, 9
    s_cbranch_scc0 L_238
    s_add_u32 s48, s28, 1474560
    buffer_load_dwordx4 v[84:87], v15, s[24:27], s48 offen sc1
    s_add_u32 s48, s48, 114688
    buffer_load_dwordx4 v[228:231], v15, s[24:27], s48 offen sc1
L_238:
    s_bitcmp1_b32 s32, 10
    s_cbranch_scc0 L_239
    s_add_u32 s48, s28, 1638400
    buffer_load_dwordx4 v[88:91], v15, s[24:27], s48 offen sc1
    s_add_u32 s48, s48, 114688
    buffer_load_dwordx4 v[232:235], v15, s[24:27], s48 offen sc1
L_239:
    s_bitcmp1_b32 s32, 11
    s_cbranch_scc0 L_240
    s_add_u32 s48, s28, 1802240
    buffer_load_dwordx4 v[92:95], v15, s[24:27], s48 offen sc1
    s_add_u32 s48, s48, 114688
    buffer_load_dwordx4 v[236:239], v15, s[24:27], s48 offen sc1
L_240:
    s_bitcmp1_b32 s32, 12
    s_cbranch_scc0 L_241
    s_add_u32 s48, s28, 1966080
    buffer_load_dwordx4 v[96:99], v15, s[24:27], s48 offen sc1
    s_add_u32 s48, s48, 114688
    buffer_load_dwordx4 v[240:243], v15, s[24:27], s48 offen sc1
L_241:
    s_bitcmp1_b32 s32, 13
    s_cbranch_scc0 L_242
    s_add_u32 s48, s28, 2129920
    buffer_load_dwordx4 v[100:103], v15, s[24:27], s48 offen sc1
    s_add_u32 s48, s48, 114688
    buffer_load_dwordx4 v[244:247], v15, s[24:27], s48 offen sc1
L_242:
    s_bitcmp1_b32 s32, 14
    s_cbranch_scc0 L_243
    s_add_u32 s48, s28, 2293760
    buffer_load_dwordx4 v[104:107], v15, s[24:27], s48 offen sc1
    s_add_u32 s48, s48, 114688
    buffer_load_dwordx4 v[248:251], v15, s[24:27], s48 offen sc1
L_243:
    s_bitcmp1_b32 s32, 15
    s_cbranch_scc0 L_244
    s_add_u32 s48, s28, 2457600
    buffer_load_dwordx4 v[108:111], v15, s[24:27], s48 offen sc1
    s_add_u32 s48, s48, 114688
    buffer_load_dwordx4 v[252:255], v15, s[24:27], s48 offen sc1
L_244:
    s_or_b32 s34, s34, s32
    s_mov_b32 s32, 0
    s_cmp_eq_u32 s31, 0xffff
    s_cbranch_scc0 L_RLB
L_RADDB:
    s_cmp_eq_u32 s31, 0xffff
    s_cbranch_scc0 L_RSLPB
    s_cmp_eq_u32 s34, 0
    s_cbranch_scc1 L_RADDEDB
    s_waitcnt vmcnt(0)
    s_cmp_eq_u32 s36, 0
    s_cbranch_scc1 L_245
    v_mfma_f32_16x16x32_bf16 v[24:27], v[16:19], v[48:51], v[24:27]
    v_mfma_f32_16x16x32_bf16 v[28:31], v[20:23], v[48:51], v[28:31]
    v_mfma_f32_16x16x32_bf16 v[32:35], v[16:19], v[192:195], v[32:35]
    v_mfma_f32_16x16x32_bf16 v[36:39], v[20:23], v[192:195], v[36:39]
L_245:
    s_cmp_eq_u32 s36, 1
    s_cbranch_scc1 L_246
    v_mfma_f32_16x16x32_bf16 v[24:27], v[16:19], v[52:55], v[24:27]
    v_mfma_f32_16x16x32_bf16 v[28:31], v[20:23], v[52:55], v[28:31]
    v_mfma_f32_16x16x32_bf16 v[32:35], v[16:19], v[196:199], v[32:35]
    v_mfma_f32_16x16x32_bf16 v[36:39], v[20:23], v[196:199], v[36:39]
L_246:
    s_cmp_eq_u32 s36, 2
    s_cbranch_scc1 L_247
    v_mfma_f32_16x16x32_bf16 v[24:27], v[16:19], v[56:59], v[24:27]
    v_mfma_f32_16x16x32_bf16 v[28:31], v[20:23], v[56:59], v[28:31]
    v_mfma_f32_16x16x32_bf16 v[32:35], v[16:19], v[200:203], v[32:35]
    v_mfma_f32_16x16x32_bf16 v[36:39], v[20:23], v[200:203], v[36:39]
L_247:
    s_cmp_eq_u32 s36, 3
    s_cbranch_scc1 L_248
    v_mfma_f32_16x16x32_bf16 v[24:27], v[16:19], v[60:63], v[24:27]
    v_mfma_f32_16x16x32_bf16 v[28:31], v[20:23], v[60:63], v[28:31]
    v_mfma_f32_16x16x32_bf16 v[32:35], v[16:19], v[204:207], v[32:35]
    v_mfma_f32_16x16x32_bf16 v[36:39], v[20:23], v[204:207], v[36:39]
L_248:
    s_cmp_eq_u32 s36, 4
    s_cbranch_scc1 L_249
    v_mfma_f32_16x16x32_bf16 v[24:27], v[16:19], v[64:67], v[24:27]
    v_mfma_f32_16x16x32_bf16 v[28:31], v[20:23], v[64:67], v[28:31]
    v_mfma_f32_16x16x32_bf16 v[32:35], v[16:19], v[208:211], v[32:35]
    v_mfma_f32_16x16x32_bf16 v[36:39], v[20:23], v[208:211], v[36:39]
L_249:
    s_cmp_eq_u32 s36, 5
    s_cbranch_scc1 L_250
    v_mfma_f32_16x16x32_bf16 v[24:27], v[16:19], v[68:71], v[24:27]
    v_mfma_f32_16x16x32_bf16 v[28:31], v[20:23], v[68:71], v[28:31]
    v_mfma_f32_16x16x32_bf16 v[32:35], v[16:19], v[212:215], v[32:35]
    v_mfma_f32_16x16x32_bf16 v[36:39], v[20:23], v[212:215], v[36:39]
L_250:
    s_cmp_eq_u32 s36, 6
    s_cbranch_scc1 L_251
    v_mfma_f32_16x16x32_bf16 v[24:27], v[16:19], v[72:75], v[24:27]
    v_mfma_f32_16x16x32_bf16 v[28:31], v[20:23], v[72:75], v[28:31]
    v_mfma_f32_16x16x32_bf16 v[32:35], v[16:19], v[216:219], v[32:35]
    v_mfma_f32_16x16x32_bf16 v[36:39], v[20:23], v[216:219], v[36:39]
L_251:
    s_cmp_eq_u32 s36, 7
    s_cbranch_scc1 L_252
    v_mfma_f32_16x16x32_bf16 v[24:27], v[16:19], v[76:79], v[24:27]
    v_mfma_f32_16x16x32_bf16 v[28:31], v[20:23], v[76:79], v[28:31]
    v_mfma_f32_16x16x32_bf16 v[32:35], v[16:19], v[220:223], v[32:35]
    v_mfma_f32_16x16x32_bf16 v[36:39], v[20:23], v[220:223], v[36:39]
L_252:
    s_cmp_eq_u32 s36, 8
    s_cbranch_scc1 L_253
    v_mfma_f32_16x16x32_bf16 v[24:27], v[16:19], v[80:83], v[24:27]
    v_mfma_f32_16x16x32_bf16 v[28:31], v[20:23], v[80:83], v[28:31]
    v_mfma_f32_16x16x32_bf16 v[32:35], v[16:19], v[224:227], v[32:35]
    v_mfma_f32_16x16x32_bf16 v[36:39], v[20:23], v[224:227], v[36:39]
L_253:
    s_cmp_eq_u32 s36, 9
    s_cbranch_scc1 L_254
    v_mfma_f32_16x16x32_bf16 v[24:27], v[16:19], v[84:87], v[24:27]
    v_mfma_f32_16x16x32_bf16 v[28:31], v[20:23], v[84:87], v[28:31]
    v_mfma_f32_16x16x32_bf16 v[32:35], v[16:19], v[228:231], v[32:35]
    v_mfma_f32_16x16x32_bf16 v[36:39], v[20:23], v[228:231], v[36:39]
L_254:
    s_cmp_eq_u32 s36, 10
    s_cbranch_scc1 L_255
    v_mfma_f32_16x16x32_bf16 v[24:27], v[16:19], v[88:91], v[24:27]
    v_mfma_f32_16x16x32_bf16 v[28:31], v[20:23], v[88:91], v[28:31]
    v_mfma_f32_16x16x32_bf16 v[32:35], v[16:19], v[232:235], v[32:35]
    v_mfma_f32_16x16x32_bf16 v[36:39], v[20:23], v[232:235], v[36:39]
L_255:
    s_cmp_eq_u32 s36, 11
    s_cbranch_scc1 L_256
    v_mfma_f32_16x16x32_bf16 v[24:27], v[16:19], v[92:95], v[24:27]
    v_mfma_f32_16x16x32_bf16 v[28:31], v[20:23], v[92:95], v[28:31]
    v_mfma_f32_16x16x32_bf16 v[32:35], v[16:19], v[236:239], v[32:35]
    v_mfma_f32_16x16x32_bf16 v[36:39], v[20:23], v[236:239], v[36:39]
L_256:
    s_cmp_eq_u32 s36, 12
    s_cbranch_scc1 L_257
    v_mfma_f32_16x16x32_bf16 v[24:27], v[16:19], v[96:99], v[24:27]
    v_mfma_f32_16x16x32_bf16 v[28:31], v[20:23], v[96:99], v[28:31]
    v_mfma_f32_16x16x32_bf16 v[32:35], v[16:19], v[240:243], v[32:35]
    v_mfma_f32_16x16x32_bf16 v[36:39], v[20:23], v[240:243], v[36:39]
L_257:
    s_cmp_eq_u32 s36, 13
    s_cbranch_scc1 L_258
    v_mfma_f32_16x16x32_bf16 v[24:27], v[16:19], v[100:103], v[24:27]
    v_mfma_f32_16x16x32_bf16 v[28:31], v[20:23], v[100:103], v[28:31]
    v_mfma_f32_16x16x32_bf16 v[32:35], v[16:19], v[244:247], v[32:35]
    v_mfma_f32_16x16x32_bf16 v[36:39], v[20:23], v[244:247], v[36:39]
L_258:
    s_cmp_eq_u32 s36, 14
    s_cbranch_scc1 L_259
    v_mfma_f32_16x16x32_bf16 v[24:27], v[16:19], v[104:107], v[24:27]
    v_mfma_f32_16x16x32_bf16 v[28:31], v[20:23], v[104:107], v[28:31]
    v_mfma_f32_16x16x32_bf16 v[32:35], v[16:19], v[248:251], v[32:35]
    v_mfma_f32_16x16x32_bf16 v[36:39], v[20:23], v[248:251], v[36:39]
L_259:
    s_cmp_eq_u32 s36, 15
    s_cbranch_scc1 L_260
    v_mfma_f32_16x16x32_bf16 v[24:27], v[16:19], v[108:111], v[24:27]
    v_mfma_f32_16x16x32_bf16 v[28:31], v[20:23], v[108:111], v[28:31]
    v_mfma_f32_16x16x32_bf16 v[32:35], v[16:19], v[252:255], v[32:35]
    v_mfma_f32_16x16x32_bf16 v[36:39], v[20:23], v[252:255], v[36:39]
L_260:
L_RADDEDB:
    s_mov_b32 s34, s32
    s_cmp_lg_u32 s32, 0
    s_cbranch_scc1 L_RLB
    s_cmp_eq_u32 s31, 0xffff
    s_cbranch_scc1 L_RDONEB
L_RSLPB:
    s_sleep 1
    s_branch L_RLB
L_RDONEB:
    v_cvt_pk_bf16_f32 v48, v24, v25
    v_cvt_pk_bf16_f32 v49, v26, v27
    v_cvt_pk_bf16_f32 v50, v28, v29
    v_cvt_pk_bf16_f32 v51, v30, v31
    buffer_store_dwordx4 v[48:51], v5, s[4:7], s30 offen offset:0
    v_cvt_pk_bf16_f32 v52, v32, v33
    v_cvt_pk_bf16_f32 v53, v34, v35
    v_cvt_pk_bf16_f32 v54, v36, v37
    v_cvt_pk_bf16_f32 v55, v38, v39
    buffer_store_dwordx4 v[52:55], v5, s[4:7], s30 offen offset:896
    s_branch L_FIN
L_PUB:
    s_mov_b32 s51, 0
    v_and_b32 v8, 15, v0
    v_lshlrev_b32 v8, 3, v8
L_NONCE:
    v_readfirstlane_b32 s100, v10
    s_add_u32 s51, s51, 1
    s_cmp_lg_u32 s100, 0
    s_cbranch_scc1 L_NONCED
    s_lshr_b32 s48, s55, 4
    s_lshl_b32 s48, s48, 2
    v_mov_b32 v11, 0
    buffer_load_dword v10, v11, s[20:23], s48 offen offset:0 sc1
    s_waitcnt vmcnt(0)
    s_cmp_lt_u32 s51, 0x40000
    s_cbranch_scc1 L_NONCE
L_NONCED:
    s_not_b32 s101, s100
    s_lshl_b32 s48, s55, 3
    s_add_u32 s48, s48, 50331648
    v_mov_b32 v2, s100
    v_mov_b32 v3, s101
    v_mov_b32 v4, 0
    s_waitcnt vmcnt(0)
    s_barrier
    s_mov_b64 exec, 1
    buffer_store_dwordx2 v[2:3], v4, s[24:27], s48 offen sc1
    s_mov_b64 exec, -1
    s_lshl_b32 s48, s54, 7
    s_add_u32 s48, s48, 50331648
    s_bitset1_b32 s31, s36
    v_mov_b32 v14, s31
    ds_write_b32 v9, v14
    s_waitcnt lgkmcnt(0)
L_POLL:
    s_cmp_eq_u32 s31, 0xffff
    s_cbranch_scc1 L_POLLED
    buffer_load_dwordx2 v[12:13], v8, s[24:27], s48 offen sc1
    s_add_u32 s51, s51, 1
    s_waitcnt vmcnt(0)
    v_cmp_eq_u64 vcc, s[100:101], v[12:13]
    s_nop 0
    s_and_b32 s37, vcc_lo, 0xffff
    s_or_b32 s31, s31, s37
    s_cmp_lt_u32 s51, 0x40000
    s_cselect_b32 s31, s31, 0xffff
    v_mov_b32 v14, s31
    ds_write_b32 v9, v14
    s_waitcnt lgkmcnt(0)
    s_branch L_POLL
L_POLLED:
L_FIN:
L_END:
    s_endpgm
.section .rodata,"a"
.p2align 6
.amdhsa_kernel standalone__gqa_block_cached__near_ridge_kernel
  .amdhsa_next_free_vgpr 256
  .amdhsa_next_free_sgpr 102
  .amdhsa_accum_offset 256
  .amdhsa_group_segment_fixed_size 0
  .amdhsa_kernarg_size 64
  .amdhsa_user_sgpr_count 2
  .amdhsa_user_sgpr_kernarg_segment_ptr 1
  .amdhsa_system_sgpr_workgroup_id_x 1
  .amdhsa_float_denorm_mode_32 3
.end_amdhsa_kernel
```
